```python
import torch

def _softmax(x, axis=-1):
    return torch.softmax(x, dim=axis)
def _gelu(x):
    return torch.nn.functional.gelu(x, approximate="tanh")
def _silu(x):
    return torch.nn.functional.silu(x)
def _sigmoid(x):
    return torch.sigmoid(x)
def _layernorm(x, axis=-1, eps=1e-5):
    m = x.mean(dim=axis, keepdim=True)
    v = x.var(dim=axis, keepdim=True, unbiased=False)
    return (x - m) / torch.sqrt(v + eps)
def _scatter_add(tgt, idx, src, axis=0):
    return tgt.clone().index_add_(axis, idx, src)
def _segment_sum(src, seg, n):
    out = torch.zeros((n,) + src.shape[1:], dtype=src.dtype)
    return out.index_add_(0, seg, src)
def _pad(x, pw):
    flat = tuple(v for pair in reversed(pw) for v in pair)
    return torch.nn.functional.pad(x, flat)

kernel_name = 'parallel_sum__linear_attn_block__mixer_token_mlp__prompt'

def setup_inputs():

    _w = (lambda a: (lambda t: t.to(torch.bfloat16) if t.is_floating_point() else t)(torch.as_tensor(a)))
    def _A_setup():
        B, S, D = 1, 2048, 576
        return {
            "x": _w((lambda *s: torch.randn(*s, dtype=torch.bfloat16) * 0.05)(B, S, D)),
            "wqkv": _w((lambda *s: torch.randn(*s, dtype=torch.bfloat16) * 0.05)(D, 3 * D)),
            "wo": _w((lambda *s: torch.randn(*s, dtype=torch.bfloat16) * 0.05)(D, D)),
        }
    _A_in = _A_setup()

    def _B_setup():
        B, S, D, F = 1, 2048, 576, 4608
        return {
            "x": _w((lambda *s: torch.randn(*s, dtype=torch.bfloat16) * 0.05)(B, S, D)),
            "w1": _w((lambda *s: torch.randn(*s, dtype=torch.bfloat16) * 0.4)(S, F) * (S ** -0.5)),
            "b1": _w((lambda *s: torch.randn(*s, dtype=torch.bfloat16) * 3.2)(F) * 0.02),
            "w2": _w((lambda *s: torch.randn(*s, dtype=torch.bfloat16) * 0.2)(F, S) * (F ** -0.5)),
            "b2": _w((lambda *s: torch.randn(*s, dtype=torch.bfloat16) * 0.4)(S) * 0.02),
        }
    _B_in = _B_setup()

    return {
        "A_x": _A_in["x"],
        "A_wqkv": _A_in["wqkv"],
        "A_wo": _A_in["wo"],
        "B_x": _B_in["x"],
        "B_w1": _B_in["w1"],
        "B_b1": _B_in["b1"],
        "B_w2": _B_in["w2"],
        "B_b2": _B_in["b2"],
    }

def reference(A_x, A_wqkv, A_wo, B_x, B_w1, B_b1, B_w2, B_b2):
    def _A_ref(x, wqkv, wo):
        B, S, D = x.shape
        H = 32; Dh = D // H
        qkv = (lambda x, *d: x.permute(*d))((x @ wqkv).reshape(B, S, 3, H, Dh), 2, 0, 3, 1, 4)
        q, k, v = qkv[0], qkv[1], qkv[2]
        phi = lambda t: torch.where(t > 0, t + 1, torch.exp(t)) + 1e-6
        pq, pk = phi(q), phi(k)
        kv = torch.einsum("bhsd,bhse->bhde", pk, v)
        z = torch.einsum("bhsd->bhd", pk)
        num = torch.einsum("bhqd,bhde->bhqe", pq, kv)
        den = torch.einsum("bhqd,bhd->bhq", pq, z)[..., None] + 1e-6
        o = num / den
        return (lambda x, *d: x.permute(*d))(o, 0, 2, 1, 3).reshape(B, S, D) @ wo

    def _B_ref(x, w1, b1, w2, b2):
        B, S, D = x.shape
        h = _layernorm(x, axis=-1)
        u = torch.einsum("bsd,sf->bdf", h, w1) + b1
        u = _gelu(u)
        y = torch.einsum("bdf,fs->bds", u, w2) + b2
        return (lambda x, *d: x.permute(*d))(y, 0, 2, 1)

    x = A_x
    xn = _layernorm(x, axis=-1)
    return x + _A_ref(xn, A_wqkv, A_wo) + _B_ref(xn, B_w1, B_b1, B_w2, B_b2)
```

```asm
; @launch grid=(256,1,1) block=(512,1,1) lds=163840
.amdgcn_target "amdgcn-amd-amdhsa--gfx950"
.text
.globl parallel_sum__linear_attn_block__mixer_token_mlp__prompt_kernel
.p2align 8
.type parallel_sum__linear_attn_block__mixer_token_mlp__prompt_kernel,@function
parallel_sum__linear_attn_block__mixer_token_mlp__prompt_kernel:
  s_cmp_ge_u32 s2, 256
  s_cbranch_scc1 L_done_1_x
  s_load_dwordx2 s[4:5], s[0:1], 0
  s_load_dwordx2 s[76:77], s[0:1], 80
  s_mov_b32 s99, s2
  v_lshrrev_b32 v2, 6, v0
  v_and_b32 v1, 63, v0
  v_readfirstlane_b32 s100, v2
  s_mov_b32 s79, 0
  s_cmp_ge_u32 s100, 4
  s_cbranch_scc1 L_hiw_5
  v_and_b32 v2, 31, v0
  v_lshrrev_b32 v3, 5, v0
  v_mul_u32_u24 v5, 1152, v3
  v_lshl_add_u32 v5, v2, 2, v5
  s_mul_i32 s28, s99, 9216
  s_waitcnt lgkmcnt(0)
  s_mov_b32 s8, s4
  s_and_b32 s9, s5, 0xffff
  s_mov_b32 s10, 2359296
  s_mov_b32 s11, 0x20000
  buffer_load_dword v10, v5, s[8:11], s28 offen offset:0
  buffer_load_dword v11, v5, s[8:11], s28 offen offset:128
  buffer_load_dword v12, v5, s[8:11], s28 offen offset:256
  buffer_load_dword v13, v5, s[8:11], s28 offen offset:384
  buffer_load_dword v14, v5, s[8:11], s28 offen offset:512
  buffer_load_dword v15, v5, s[8:11], s28 offen offset:640
  buffer_load_dword v16, v5, s[8:11], s28 offen offset:768
  buffer_load_dword v17, v5, s[8:11], s28 offen offset:896
  buffer_load_dword v18, v5, s[8:11], s28 offen offset:1024
  s_mov_b64 s[6:7], s[76:77]
  s_add_u32 s2, s76, 10162176
  s_addc_u32 s3, s77, 0
  s_load_dword s98, s[2:3], 0
  s_add_u32 s72, s76, 10092544
  s_addc_u32 s73, s77, 0
  s_and_b32 s73, s73, 0xffff
  s_mov_b32 s74, 131072
  s_mov_b32 s75, 0x20000
  s_add_u32 s12, s6, 0
  s_addc_u32 s13, s7, 0
  s_and_b32 s13, s13, 0xffff
  s_mov_b32 s14, 2359296
  s_mov_b32 s15, 0x20000
  s_add_u32 s16, s6, 2359296
  s_addc_u32 s17, s7, 0
  s_and_b32 s17, s17, 0xffff
  s_mov_b32 s18, 2359296
  s_mov_b32 s19, 0x20000
  s_add_u32 s20, s6, 10027008
  s_addc_u32 s21, s7, 0
  s_and_b32 s21, s21, 0xffff
  s_mov_b32 s22, 51200
  s_mov_b32 s23, 0x20000
  v_mul_u32_u24 v9, 1216, v3
  v_lshl_add_u32 v9, v2, 2, v9
  v_mov_b32 v40, 0
  v_lshlrev_b32 v44, 2, v0
  v_mov_b32 v45, 2147483632
  v_cmp_gt_u32 vcc, 50, v0
  s_mul_i32 s30, s99, 200
  s_nop 0
  v_cndmask_b32 v44, v45, v44, vcc
  buffer_store_dword v40, v44, s[20:23], s30 offen sc1
  v_add_u32 v9, 143360, v9
  s_waitcnt vmcnt(1)
  v_lshlrev_b32 v20, 16, v10
  v_and_b32 v21, 0xffff0000, v10
  v_lshlrev_b32 v22, 16, v11
  v_and_b32 v23, 0xffff0000, v11
  v_lshlrev_b32 v24, 16, v12
  v_and_b32 v25, 0xffff0000, v12
  v_lshlrev_b32 v26, 16, v13
  v_and_b32 v27, 0xffff0000, v13
  v_lshlrev_b32 v28, 16, v14
  v_and_b32 v29, 0xffff0000, v14
  v_lshlrev_b32 v30, 16, v15
  v_and_b32 v31, 0xffff0000, v15
  v_lshlrev_b32 v32, 16, v16
  v_and_b32 v33, 0xffff0000, v16
  v_lshlrev_b32 v34, 16, v17
  v_and_b32 v35, 0xffff0000, v17
  v_lshlrev_b32 v36, 16, v18
  v_and_b32 v37, 0xffff0000, v18
  v_pk_add_f32 v[40:41], v[20:21], v[22:23]
  v_pk_add_f32 v[42:43], v[24:25], v[26:27]
  v_pk_add_f32 v[40:41], v[40:41], v[28:29]
  v_pk_add_f32 v[42:43], v[42:43], v[30:31]
  v_pk_add_f32 v[40:41], v[40:41], v[32:33]
  v_pk_add_f32 v[42:43], v[42:43], v[34:35]
  v_pk_add_f32 v[40:41], v[40:41], v[36:37]
  v_pk_add_f32 v[40:41], v[40:41], v[42:43]
  v_add_f32 v40, v40, v41
  s_nop 1
  v_add_f32_dpp v40, v40, v40 row_ror:8 row_mask:0xf bank_mask:0xf
  s_nop 1
  v_add_f32_dpp v40, v40, v40 row_ror:4 row_mask:0xf bank_mask:0xf
  s_nop 1
  v_add_f32_dpp v40, v40, v40 row_ror:2 row_mask:0xf bank_mask:0xf
  s_nop 1
  v_add_f32_dpp v40, v40, v40 row_ror:1 row_mask:0xf bank_mask:0xf
  v_mov_b32 v41, v40
  s_nop 1
  v_permlane16_swap_b32 v40, v41
  s_nop 1
  v_add_f32 v40, v40, v41
  v_mul_f32 v40, 0xbae38e39, v40
  v_mov_b32 v41, v40
  v_pk_add_f32 v[44:45], v[20:21], v[40:41]
  v_pk_mul_f32 v[42:43], v[44:45], v[44:45]
  v_pk_add_f32 v[44:45], v[22:23], v[40:41]
  v_pk_fma_f32 v[42:43], v[44:45], v[44:45], v[42:43]
  v_pk_add_f32 v[44:45], v[24:25], v[40:41]
  v_pk_fma_f32 v[42:43], v[44:45], v[44:45], v[42:43]
  v_pk_add_f32 v[44:45], v[26:27], v[40:41]
  v_pk_fma_f32 v[42:43], v[44:45], v[44:45], v[42:43]
  v_pk_add_f32 v[44:45], v[28:29], v[40:41]
  v_pk_fma_f32 v[42:43], v[44:45], v[44:45], v[42:43]
  v_pk_add_f32 v[44:45], v[30:31], v[40:41]
  v_pk_fma_f32 v[42:43], v[44:45], v[44:45], v[42:43]
  v_pk_add_f32 v[44:45], v[32:33], v[40:41]
  v_pk_fma_f32 v[42:43], v[44:45], v[44:45], v[42:43]
  v_pk_add_f32 v[44:45], v[34:35], v[40:41]
  v_pk_fma_f32 v[42:43], v[44:45], v[44:45], v[42:43]
  v_pk_add_f32 v[44:45], v[36:37], v[40:41]
  v_pk_fma_f32 v[42:43], v[44:45], v[44:45], v[42:43]
  v_add_f32 v42, v42, v43
  s_nop 1
  v_add_f32_dpp v42, v42, v42 row_ror:8 row_mask:0xf bank_mask:0xf
  s_nop 1
  v_add_f32_dpp v42, v42, v42 row_ror:4 row_mask:0xf bank_mask:0xf
  s_nop 1
  v_add_f32_dpp v42, v42, v42 row_ror:2 row_mask:0xf bank_mask:0xf
  s_nop 1
  v_add_f32_dpp v42, v42, v42 row_ror:1 row_mask:0xf bank_mask:0xf
  v_mov_b32 v43, v42
  s_nop 1
  v_permlane16_swap_b32 v42, v43
  s_nop 1
  v_add_f32 v42, v42, v43
  v_mul_f32 v42, 0x3ae38e39, v42
  v_cvt_pk_bf16_f32 v44, v40, v42
  v_lshlrev_b32 v40, 16, v44
  v_lshlrev_b32 v41, 16, v44
  v_and_b32 v42, 0xffff0000, v44
  v_add_f32 v42, 0x3727c5ac, v42
  v_cvt_pk_bf16_f32 v42, v42, v42
  v_and_b32 v42, 0xffff0000, v42
  v_sqrt_f32 v42, v42
  v_pk_add_f32 v[20:21], v[20:21], v[40:41]
  v_pk_add_f32 v[22:23], v[22:23], v[40:41]
  v_pk_add_f32 v[24:25], v[24:25], v[40:41]
  v_pk_add_f32 v[26:27], v[26:27], v[40:41]
  v_pk_add_f32 v[28:29], v[28:29], v[40:41]
  v_pk_add_f32 v[30:31], v[30:31], v[40:41]
  v_pk_add_f32 v[32:33], v[32:33], v[40:41]
  v_pk_add_f32 v[34:35], v[34:35], v[40:41]
  v_pk_add_f32 v[36:37], v[36:37], v[40:41]
  v_cvt_pk_bf16_f32 v42, v42, v42
  v_and_b32 v42, 0xffff0000, v42
  v_rcp_f32 v42, v42
  v_cvt_pk_bf16_f32 v10, v20, v21
  v_cvt_pk_bf16_f32 v11, v22, v23
  v_cvt_pk_bf16_f32 v12, v24, v25
  v_cvt_pk_bf16_f32 v13, v26, v27
  v_cvt_pk_bf16_f32 v14, v28, v29
  v_cvt_pk_bf16_f32 v15, v30, v31
  v_cvt_pk_bf16_f32 v16, v32, v33
  v_cvt_pk_bf16_f32 v17, v34, v35
  v_cvt_pk_bf16_f32 v18, v36, v37
  v_mov_b32 v43, v42
  v_lshlrev_b32 v20, 16, v10
  v_and_b32 v21, 0xffff0000, v10
  v_lshlrev_b32 v22, 16, v11
  v_and_b32 v23, 0xffff0000, v11
  v_lshlrev_b32 v24, 16, v12
  v_and_b32 v25, 0xffff0000, v12
  v_lshlrev_b32 v26, 16, v13
  v_and_b32 v27, 0xffff0000, v13
  v_lshlrev_b32 v28, 16, v14
  v_and_b32 v29, 0xffff0000, v14
  v_lshlrev_b32 v30, 16, v15
  v_and_b32 v31, 0xffff0000, v15
  v_lshlrev_b32 v32, 16, v16
  v_and_b32 v33, 0xffff0000, v16
  v_lshlrev_b32 v34, 16, v17
  v_and_b32 v35, 0xffff0000, v17
  v_lshlrev_b32 v36, 16, v18
  v_and_b32 v37, 0xffff0000, v18
  v_pk_mul_f32 v[20:21], v[20:21], v[42:43]
  v_pk_mul_f32 v[22:23], v[22:23], v[42:43]
  v_pk_mul_f32 v[24:25], v[24:25], v[42:43]
  v_pk_mul_f32 v[26:27], v[26:27], v[42:43]
  v_pk_mul_f32 v[28:29], v[28:29], v[42:43]
  v_pk_mul_f32 v[30:31], v[30:31], v[42:43]
  v_pk_mul_f32 v[32:33], v[32:33], v[42:43]
  v_pk_mul_f32 v[34:35], v[34:35], v[42:43]
  v_pk_mul_f32 v[36:37], v[36:37], v[42:43]
  v_cvt_pk_bf16_f32 v10, v20, v21
  v_cvt_pk_bf16_f32 v11, v22, v23
  v_cvt_pk_bf16_f32 v12, v24, v25
  v_cvt_pk_bf16_f32 v13, v26, v27
  v_cvt_pk_bf16_f32 v14, v28, v29
  v_cvt_pk_bf16_f32 v15, v30, v31
  v_cvt_pk_bf16_f32 v16, v32, v33
  v_cvt_pk_bf16_f32 v17, v34, v35
  v_cvt_pk_bf16_f32 v18, v36, v37
  v_lshlrev_b32 v20, 16, v10
  v_and_b32 v21, 0xffff0000, v10
  v_lshlrev_b32 v22, 16, v11
  v_and_b32 v23, 0xffff0000, v11
  v_lshlrev_b32 v24, 16, v12
  v_and_b32 v25, 0xffff0000, v12
  v_lshlrev_b32 v26, 16, v13
  v_and_b32 v27, 0xffff0000, v13
  v_lshlrev_b32 v28, 16, v14
  v_and_b32 v29, 0xffff0000, v14
  v_lshlrev_b32 v30, 16, v15
  v_and_b32 v31, 0xffff0000, v15
  v_lshlrev_b32 v32, 16, v16
  v_and_b32 v33, 0xffff0000, v16
  v_lshlrev_b32 v34, 16, v17
  v_and_b32 v35, 0xffff0000, v17
  v_lshlrev_b32 v36, 16, v18
  v_and_b32 v37, 0xffff0000, v18
  ds_write_b32 v9, v10 offset:9728
  ds_write_b32 v9, v11 offset:9856
  ds_write_b32 v9, v12 offset:9984
  ds_write_b32 v9, v13 offset:10112
  ds_write_b32 v9, v14 offset:10240
  ds_write_b32 v9, v15 offset:10368
  ds_write_b32 v9, v16 offset:10496
  ds_write_b32 v9, v17 offset:10624
  ds_write_b32 v9, v18 offset:10752
  v_pk_add_f32 v[40:41], v[20:21], v[22:23]
  v_pk_add_f32 v[42:43], v[24:25], v[26:27]
  v_pk_add_f32 v[40:41], v[40:41], v[28:29]
  v_pk_add_f32 v[42:43], v[42:43], v[30:31]
  v_pk_add_f32 v[40:41], v[40:41], v[32:33]
  v_pk_add_f32 v[42:43], v[42:43], v[34:35]
  v_pk_add_f32 v[40:41], v[40:41], v[36:37]
  v_pk_add_f32 v[40:41], v[40:41], v[42:43]
  v_add_f32 v40, v40, v41
  s_nop 1
  v_add_f32_dpp v40, v40, v40 row_ror:8 row_mask:0xf bank_mask:0xf
  s_nop 1
  v_add_f32_dpp v40, v40, v40 row_ror:4 row_mask:0xf bank_mask:0xf
  s_nop 1
  v_add_f32_dpp v40, v40, v40 row_ror:2 row_mask:0xf bank_mask:0xf
  s_nop 1
  v_add_f32_dpp v40, v40, v40 row_ror:1 row_mask:0xf bank_mask:0xf
  v_mov_b32 v41, v40
  s_nop 1
  v_permlane16_swap_b32 v40, v41
  s_nop 1
  v_add_f32 v40, v40, v41
  v_mul_f32 v40, 0xbae38e39, v40
  v_mov_b32 v41, v40
  v_pk_add_f32 v[44:45], v[20:21], v[40:41]
  v_pk_mul_f32 v[42:43], v[44:45], v[44:45]
  v_pk_add_f32 v[44:45], v[22:23], v[40:41]
  v_pk_fma_f32 v[42:43], v[44:45], v[44:45], v[42:43]
  v_pk_add_f32 v[44:45], v[24:25], v[40:41]
  v_pk_fma_f32 v[42:43], v[44:45], v[44:45], v[42:43]
  v_pk_add_f32 v[44:45], v[26:27], v[40:41]
  v_pk_fma_f32 v[42:43], v[44:45], v[44:45], v[42:43]
  v_pk_add_f32 v[44:45], v[28:29], v[40:41]
  v_pk_fma_f32 v[42:43], v[44:45], v[44:45], v[42:43]
  v_pk_add_f32 v[44:45], v[30:31], v[40:41]
  v_pk_fma_f32 v[42:43], v[44:45], v[44:45], v[42:43]
  v_pk_add_f32 v[44:45], v[32:33], v[40:41]
  v_pk_fma_f32 v[42:43], v[44:45], v[44:45], v[42:43]
  v_pk_add_f32 v[44:45], v[34:35], v[40:41]
  v_pk_fma_f32 v[42:43], v[44:45], v[44:45], v[42:43]
  v_pk_add_f32 v[44:45], v[36:37], v[40:41]
  v_pk_fma_f32 v[42:43], v[44:45], v[44:45], v[42:43]
  v_add_f32 v42, v42, v43
  s_nop 1
  v_add_f32_dpp v42, v42, v42 row_ror:8 row_mask:0xf bank_mask:0xf
  s_nop 1
  v_add_f32_dpp v42, v42, v42 row_ror:4 row_mask:0xf bank_mask:0xf
  s_nop 1
  v_add_f32_dpp v42, v42, v42 row_ror:2 row_mask:0xf bank_mask:0xf
  s_nop 1
  v_add_f32_dpp v42, v42, v42 row_ror:1 row_mask:0xf bank_mask:0xf
  v_mov_b32 v43, v42
  s_nop 1
  v_permlane16_swap_b32 v42, v43
  s_nop 1
  v_add_f32 v42, v42, v43
  v_mul_f32 v42, 0x3ae38e39, v42
  v_cvt_pk_bf16_f32 v44, v40, v42
  v_lshlrev_b32 v40, 16, v44
  v_lshlrev_b32 v41, 16, v44
  v_and_b32 v42, 0xffff0000, v44
  v_add_f32 v42, 0x3727c5ac, v42
  v_cvt_pk_bf16_f32 v42, v42, v42
  v_and_b32 v42, 0xffff0000, v42
  v_sqrt_f32 v42, v42
  v_pk_add_f32 v[20:21], v[20:21], v[40:41]
  v_pk_add_f32 v[22:23], v[22:23], v[40:41]
  v_pk_add_f32 v[24:25], v[24:25], v[40:41]
  v_pk_add_f32 v[26:27], v[26:27], v[40:41]
  v_pk_add_f32 v[28:29], v[28:29], v[40:41]
  v_pk_add_f32 v[30:31], v[30:31], v[40:41]
  v_pk_add_f32 v[32:33], v[32:33], v[40:41]
  v_pk_add_f32 v[34:35], v[34:35], v[40:41]
  v_pk_add_f32 v[36:37], v[36:37], v[40:41]
  v_cvt_pk_bf16_f32 v42, v42, v42
  v_and_b32 v42, 0xffff0000, v42
  v_rcp_f32 v42, v42
  v_cvt_pk_bf16_f32 v46, v20, v21
  v_cvt_pk_bf16_f32 v47, v22, v23
  v_cvt_pk_bf16_f32 v48, v24, v25
  v_cvt_pk_bf16_f32 v49, v26, v27
  v_cvt_pk_bf16_f32 v50, v28, v29
  v_cvt_pk_bf16_f32 v51, v30, v31
  v_cvt_pk_bf16_f32 v52, v32, v33
  v_cvt_pk_bf16_f32 v53, v34, v35
  v_cvt_pk_bf16_f32 v54, v36, v37
  v_mov_b32 v43, v42
  v_lshlrev_b32 v20, 16, v46
  v_and_b32 v21, 0xffff0000, v46
  v_lshlrev_b32 v22, 16, v47
  v_and_b32 v23, 0xffff0000, v47
  v_lshlrev_b32 v24, 16, v48
  v_and_b32 v25, 0xffff0000, v48
  v_lshlrev_b32 v26, 16, v49
  v_and_b32 v27, 0xffff0000, v49
  v_lshlrev_b32 v28, 16, v50
  v_and_b32 v29, 0xffff0000, v50
  v_lshlrev_b32 v30, 16, v51
  v_and_b32 v31, 0xffff0000, v51
  v_lshlrev_b32 v32, 16, v52
  v_and_b32 v33, 0xffff0000, v52
  v_lshlrev_b32 v34, 16, v53
  v_and_b32 v35, 0xffff0000, v53
  v_lshlrev_b32 v36, 16, v54
  v_and_b32 v37, 0xffff0000, v54
  v_pk_mul_f32 v[20:21], v[20:21], v[42:43]
  v_pk_mul_f32 v[22:23], v[22:23], v[42:43]
  v_pk_mul_f32 v[24:25], v[24:25], v[42:43]
  v_pk_mul_f32 v[26:27], v[26:27], v[42:43]
  v_pk_mul_f32 v[28:29], v[28:29], v[42:43]
  v_pk_mul_f32 v[30:31], v[30:31], v[42:43]
  v_pk_mul_f32 v[32:33], v[32:33], v[42:43]
  v_pk_mul_f32 v[34:35], v[34:35], v[42:43]
  v_pk_mul_f32 v[36:37], v[36:37], v[42:43]
  v_cvt_pk_bf16_f32 v46, v20, v21
  v_cvt_pk_bf16_f32 v47, v22, v23
  v_cvt_pk_bf16_f32 v48, v24, v25
  v_cvt_pk_bf16_f32 v49, v26, v27
  v_cvt_pk_bf16_f32 v50, v28, v29
  v_cvt_pk_bf16_f32 v51, v30, v31
  v_cvt_pk_bf16_f32 v52, v32, v33
  v_cvt_pk_bf16_f32 v53, v34, v35
  v_cvt_pk_bf16_f32 v54, v36, v37
  ds_write_b32 v9, v46 offset:0
  ds_write_b32 v9, v47 offset:128
  ds_write_b32 v9, v48 offset:256
  ds_write_b32 v9, v49 offset:384
  ds_write_b32 v9, v50 offset:512
  ds_write_b32 v9, v51 offset:640
  ds_write_b32 v9, v52 offset:768
  ds_write_b32 v9, v53 offset:896
  ds_write_b32 v9, v54 offset:1024
  v_bfe_u32 v7, v0, 2, 2
  v_mul_u32_u24 v7, 1216, v7
  v_lshrrev_b32 v8, 4, v0
  v_lshl_add_u32 v7, v8, 5, v7
  v_and_b32 v8, 3, v0
  v_lshl_add_u32 v7, v8, 3, v7
  v_and_b32 v8, 7, v0
  v_mul_u32_u24 v6, 1216, v8
  v_lshlrev_b32 v4, 4, v8
  v_lshrrev_b32 v8, 5, v0
  v_lshl_add_u32 v6, v8, 6, v6
  v_bfe_u32 v8, v0, 3, 2
  v_lshl_add_u32 v6, v8, 3, v6
  v_lshrrev_b32 v8, 3, v0
  v_lshl_add_u32 v4, v8, 15, v4
  v_lshlrev_b32 v5, 4, v0
  v_lshrrev_b32 v8, 6, v0
  s_lshl_b32 s32, s99, 7
  v_readfirstlane_b32 s31, v8
  v_add_u32 v6, 143360, v6
  v_add_u32 v7, 143360, v7
  s_waitcnt lgkmcnt(0)
  s_barrier
  ds_read_b64_tr_b16 v[20:21], v7 offset:0
  ds_read_b64_tr_b16 v[22:23], v7 offset:4864
  ds_read_b64 v[24:25], v6 offset:9728
  ds_read_b64 v[26:27], v6 offset:9760
  s_add_u32 s33, s28, 0
  s_add_u32 s30, s32, 0
  s_waitcnt lgkmcnt(2)
  buffer_store_dwordx4 v[20:23], v5, s[16:19], s33 offen sc1
  s_waitcnt lgkmcnt(0)
  buffer_store_dwordx4 v[24:27], v4, s[12:15], s30 offen sc1
  ds_read_b64_tr_b16 v[28:29], v7 offset:512
  ds_read_b64_tr_b16 v[30:31], v7 offset:5376
  ds_read_b64 v[32:33], v6 offset:10240
  ds_read_b64 v[34:35], v6 offset:10272
  s_add_u32 s33, s28, 4096
  s_add_u32 s30, s32, 1048576
  s_waitcnt lgkmcnt(2)
  buffer_store_dwordx4 v[28:31], v5, s[16:19], s33 offen sc1
  s_waitcnt lgkmcnt(0)
  buffer_store_dwordx4 v[32:35], v4, s[12:15], s30 offen sc1
  s_cmp_lg_u32 s31, 0
  s_cbranch_scc1 L_k1skip_6
  ds_read_b64_tr_b16 v[36:37], v7 offset:1024
  ds_read_b64_tr_b16 v[38:39], v7 offset:5888
  ds_read_b64 v[40:41], v6 offset:10752
  ds_read_b64 v[42:43], v6 offset:10784
  s_add_u32 s33, s28, 8192
  s_add_u32 s30, s32, 2097152
  s_waitcnt lgkmcnt(2)
  buffer_store_dwordx4 v[36:39], v5, s[16:19], s33 offen sc1
  s_waitcnt lgkmcnt(0)
  buffer_store_dwordx4 v[40:43], v4, s[12:15], s30 offen sc1
L_k1skip_6:
  s_add_u32 s98, s98, 1
  s_waitcnt vmcnt(0)
  s_barrier
  s_cmp_lg_u32 s100, 0
  s_cbranch_scc1 L_lnf_7
  s_lshr_b32 s33, s99, 3
  s_lshl_b32 s33, s33, 7
  s_and_b32 s34, s99, 7
  s_lshl_b32 s34, s34, 2
  s_add_u32 s33, s33, s34
  s_add_u32 s33, s33, 57344
  v_mov_b32 v3, s33
  v_mov_b32 v4, s98
  s_mov_b64 exec, 1
  buffer_store_dword v4, v3, s[72:75], 0 offen sc1
  s_mov_b64 exec, -1
L_lnf_7:
  s_cmp_lt_u32 s99, 64
  s_cbranch_scc1 L_a_cons
  s_branch L_g_cons
L_hiw_5:
  v_subrev_u32 v31, 256, v0
  v_min_u32 v31, 63, v31
  s_getpc_b64 s[34:35]
L_pc_8:
  s_sub_u32 s34, s34, L_pc_8-parallel_sum__linear_attn_block__mixer_token_mlp__prompt_kernel
  s_subb_u32 s35, s35, 0
  v_lshlrev_b32 v31, 7, v31
  v_min_u32 v31, L_text_end-parallel_sum__linear_attn_block__mixer_token_mlp__prompt_kernel-4, v31
  global_load_dword v31, v31, s[34:35]
  s_waitcnt lgkmcnt(0)
  s_add_u32 s2, s76, 10162176
  s_addc_u32 s3, s77, 0
  s_load_dword s98, s[2:3], 0
  s_add_u32 s72, s76, 10092544
  s_addc_u32 s73, s77, 0
  s_and_b32 s73, s73, 0xffff
  s_mov_b32 s74, 131072
  s_mov_b32 s75, 0x20000
  s_cmp_lt_u32 s99, 64
  s_cbranch_scc1 L_a_load
L_g_load:
  s_load_dwordx2 s[6:7], s[0:1], 32
  s_and_b32 s28, s99, 7
  s_lshr_b32 s29, s99, 3
  s_mov_b32 s30, s100
  v_and_b32 v1, 63, v0
  s_sub_u32 s29, s29, 8
  s_lshr_b32 s31, s29, 2
  s_lshr_b32 s32, s28, 1
  s_mul_i32 s32, s32, 6
  s_add_u32 s31, s31, s32
  s_and_b32 s32, s29, 3
  s_and_b32 s57, s28, 1
  s_add_u32 s12, s76, 2359296
  s_addc_u32 s13, s77, 0
  s_and_b32 s13, s13, 0xffff
  s_mov_b32 s14, 2359296
  s_mov_b32 s15, 0x20000
  s_mul_i32 s48, s32, 2304
  s_mul_i32 s33, s57, 1179648
  s_add_u32 s48, s48, s33
  s_mul_i32 s49, s31, 384
  s_mul_i32 s33, s57, 9437184
  s_add_u32 s49, s49, s33
  s_lshr_b32 s33, s29, 2
  s_add_u32 s33, s33, s32
  s_and_b32 s33, s33, 1
  s_mul_i32 s40, s33, 1
  s_sub_u32 s33, s30, 4
  s_lshl_b32 s34, s33, 8
  v_add_u32 v7, s34, v1
  s_mul_i32 s50, s33, 6144
  s_add_u32 s50, s50, 18432
  s_add_u32 s54, s50, 4096
  s_lshl_b32 s51, s33, 12
  s_lshl_b32 s52, s33, 10
  s_add_u32 s52, s52, 16384
  s_cmp_lt_u32 s33, 2
  s_cselect_b32 s53, 1, 0
  s_mul_i32 s36, s33, 147456
  s_mov_b32 s34, 178956971
  s_mov_b32 s35, 29826162
  v_add_u32 v3, 0, v1
  v_mul_hi_u32 v4, v3, s34
  v_mul_u32_u24 v5, 24, v4
  v_sub_u32 v5, v3, v5
  v_and_b32 v6, 2, v4
  v_xor_b32 v5, v5, v6
  v_bfe_u32 v6, v4, 3, 1
  v_lshlrev_b32 v6, 2, v6
  v_xor_b32 v5, v5, v6
  v_mul_u32_u24 v4, 9216, v4
  v_lshl_add_u32 v4, v5, 4, v4
  v_subrev_u32 v4, 0, v4
  v_add_u32 v10, s36, v4
  v_add_u32 v3, 64, v1
  v_mul_hi_u32 v4, v3, s34
  v_mul_u32_u24 v5, 24, v4
  v_sub_u32 v5, v3, v5
  v_and_b32 v6, 2, v4
  v_xor_b32 v5, v5, v6
  v_bfe_u32 v6, v4, 3, 1
  v_lshlrev_b32 v6, 2, v6
  v_xor_b32 v5, v5, v6
  v_mul_u32_u24 v4, 9216, v4
  v_lshl_add_u32 v4, v5, 4, v4
  v_subrev_u32 v4, 1024, v4
  v_add_u32 v11, s36, v4
  v_add_u32 v3, 128, v1
  v_mul_hi_u32 v4, v3, s34
  v_mul_u32_u24 v5, 24, v4
  v_sub_u32 v5, v3, v5
  v_and_b32 v6, 2, v4
  v_xor_b32 v5, v5, v6
  v_bfe_u32 v6, v4, 3, 1
  v_lshlrev_b32 v6, 2, v6
  v_xor_b32 v5, v5, v6
  v_mul_u32_u24 v4, 9216, v4
  v_lshl_add_u32 v4, v5, 4, v4
  v_subrev_u32 v4, 2048, v4
  v_add_u32 v12, s36, v4
  v_add_u32 v3, 192, v1
  v_mul_hi_u32 v4, v3, s34
  v_mul_u32_u24 v5, 24, v4
  v_sub_u32 v5, v3, v5
  v_and_b32 v6, 2, v4
  v_xor_b32 v5, v5, v6
  v_bfe_u32 v6, v4, 3, 1
  v_lshlrev_b32 v6, 2, v6
  v_xor_b32 v5, v5, v6
  v_mul_u32_u24 v4, 9216, v4
  v_lshl_add_u32 v4, v5, 4, v4
  v_subrev_u32 v4, 3072, v4
  v_add_u32 v13, s36, v4
  v_add_u32 v3, 256, v1
  v_mul_hi_u32 v4, v3, s34
  v_mul_u32_u24 v5, 24, v4
  v_sub_u32 v5, v3, v5
  v_and_b32 v6, 2, v4
  v_xor_b32 v5, v5, v6
  v_bfe_u32 v6, v4, 3, 1
  v_lshlrev_b32 v6, 2, v6
  v_xor_b32 v5, v5, v6
  v_mul_u32_u24 v4, 9216, v4
  v_lshl_add_u32 v4, v5, 4, v4
  v_subrev_u32 v4, 0, v4
  v_add_u32 v14, s36, v4
  v_add_u32 v3, 320, v1
  v_mul_hi_u32 v4, v3, s34
  v_mul_u32_u24 v5, 24, v4
  v_sub_u32 v5, v3, v5
  v_and_b32 v6, 2, v4
  v_xor_b32 v5, v5, v6
  v_bfe_u32 v6, v4, 3, 1
  v_lshlrev_b32 v6, 2, v6
  v_xor_b32 v5, v5, v6
  v_mul_u32_u24 v4, 9216, v4
  v_lshl_add_u32 v4, v5, 4, v4
  v_subrev_u32 v4, 1024, v4
  v_add_u32 v15, s36, v4
  v_add_u32 v3, 0, v7
  v_mul_hi_u32 v4, v3, s35
  v_mul_u32_u24 v4, 6912, v4
  v_lshl_add_u32 v16, v7, 4, v4
  v_add_u32 v3, 64, v7
  v_mul_hi_u32 v4, v3, s35
  v_mul_u32_u24 v4, 6912, v4
  v_lshl_add_u32 v17, v7, 4, v4
  v_add_u32 v3, 128, v7
  v_mul_hi_u32 v4, v3, s35
  v_mul_u32_u24 v4, 6912, v4
  v_lshl_add_u32 v18, v7, 4, v4
  v_add_u32 v3, 192, v7
  v_mul_hi_u32 v4, v3, s35
  v_mul_u32_u24 v4, 6912, v4
  v_lshl_add_u32 v19, v7, 4, v4
  s_lshl_b32 s36, s33, 6
  s_add_u32 s36, s36, 1024
  v_add_u32 v3, s36, v1
  v_lshlrev_b32 v3, 4, v3
  v_add_u32 v20, 48384, v3
  s_waitcnt lgkmcnt(0)
  s_add_u32 s98, s98, 1
  s_mov_b32 s16, s6
  s_and_b32 s17, s7, 0xffff
  s_mov_b32 s18, 18874368
  s_mov_b32 s19, 0x20000
  s_mov_b32 s44, 0
  s_mov_b32 s41, 0
  s_mov_b32 s42, 0
  s_mov_b32 s43, 2
  s_mul_i32 s60, s40, 73728
  s_add_u32 s60, s60, s48
  s_mul_i32 s46, s40, 589824
  s_add_u32 s46, s46, s49
  s_add_u32 m0, s44, s50
  s_nop 0
  buffer_load_dwordx4 v10, s[16:19], s46 offen lds
  buffer_load_dwordx4 v11, s[16:19], s46 offen offset:1024 lds
  buffer_load_dwordx4 v12, s[16:19], s46 offen offset:2048 lds
  buffer_load_dwordx4 v13, s[16:19], s46 offen offset:3072 lds
  s_add_u32 m0, s44, s54
  s_nop 0
  buffer_load_dwordx4 v14, s[16:19], s46 offen lds
  buffer_load_dwordx4 v15, s[16:19], s46 offen offset:1024 lds
  s_add_u32 s44, s44, 43008
  s_cmp_eq_u32 s44, 129024
  s_cselect_b32 s44, 0, s44
  s_add_u32 s40, s40, 1
  s_cmp_eq_u32 s40, s43
  s_cselect_b32 s40, s42, s40
  s_add_u32 s41, s41, 1
  s_cmp_eq_u32 s41, 2
  s_cselect_b32 s41, 0, s41
  s_cselect_b32 s45, 2, 0
  s_add_u32 s40, s40, s45
  s_add_u32 s42, s42, s45
  s_add_u32 s43, s43, s45
  s_mul_i32 s61, s40, 73728
  s_add_u32 s61, s61, s48
  s_mul_i32 s46, s40, 589824
  s_add_u32 s46, s46, s49
  s_add_u32 m0, s44, s50
  s_nop 0
  buffer_load_dwordx4 v10, s[16:19], s46 offen lds
  buffer_load_dwordx4 v11, s[16:19], s46 offen offset:1024 lds
  buffer_load_dwordx4 v12, s[16:19], s46 offen offset:2048 lds
  buffer_load_dwordx4 v13, s[16:19], s46 offen offset:3072 lds
  s_add_u32 m0, s44, s54
  s_nop 0
  buffer_load_dwordx4 v14, s[16:19], s46 offen lds
  buffer_load_dwordx4 v15, s[16:19], s46 offen offset:1024 lds
  s_add_u32 s44, s44, 43008
  s_cmp_eq_u32 s44, 129024
  s_cselect_b32 s44, 0, s44
  s_add_u32 s40, s40, 1
  s_cmp_eq_u32 s40, s43
  s_cselect_b32 s40, s42, s40
  s_add_u32 s41, s41, 1
  s_cmp_eq_u32 s41, 2
  s_cselect_b32 s41, 0, s41
  s_cselect_b32 s45, 2, 0
  s_add_u32 s40, s40, s45
  s_add_u32 s42, s42, s45
  s_add_u32 s43, s43, s45
  s_barrier
  s_barrier
  s_load_dwordx2 s[8:9], s[0:1], 8
  s_mul_i32 s34, s29, 216
  s_sub_u32 s34, s34, 256
  s_lshr_b32 s36, s28, 1
  s_mul_i32 s36, s36, 288
  s_and_b32 s36, s36, 0xffffff80
  s_mov_b32 s37, 477218589
  s_mov_b32 s39, 1431655766
  v_add_u32 v3, s34, v0
  v_mul_hi_u32 v4, v3, s37
  v_mul_u32_u24 v5, 9, v4
  v_sub_u32 v5, v3, v5
  v_mul_hi_u32 v6, v5, s39
  v_mul_u32_u24 v4, 3456, v4
  v_lshl_add_u32 v4, v5, 7, v4
  v_mul_u32_u24 v6, 768, v6
  v_cmp_gt_u32 vcc, 472, v0
  v_add_u32 v4, v4, v6
  v_mov_b32 v5, 2147483632
  v_cndmask_b32 v4, v5, v4, vcc
  s_waitcnt lgkmcnt(0)
  s_mov_b32 s24, s8
  s_and_b32 s25, s9, 0xffff
  s_mov_b32 s26, 1990656
  s_mov_b32 s27, 0x20000
  buffer_load_dword v22, v4, s[24:27], s36 offen
  s_cmp_lg_u32 s30, 7
  s_cbranch_scc1 L_gnc_14
  s_mul_i32 s34, s29, 40
  v_min_u32 v21, 39, v1
  v_add_u32 v21, s34, v21
  s_getpc_b64 s[34:35]
L_pc_15:
  s_sub_u32 s34, s34, L_pc_15-parallel_sum__linear_attn_block__mixer_token_mlp__prompt_kernel
  s_subb_u32 s35, s35, 0
  v_lshlrev_b32 v21, 7, v21
  v_min_u32 v21, L_text_end-parallel_sum__linear_attn_block__mixer_token_mlp__prompt_kernel-4, v21
  global_load_dword v21, v21, s[34:35]
L_gnc_14:
  s_lshr_b32 s33, s28, 1
  s_mul_i32 s33, s33, 2304
  s_mul_i32 s34, s57, 9437184
  s_add_u32 s33, s33, s34
  s_mul_i32 s34, s29, 9216
  s_add_u32 s33, s33, s34
  s_mov_b32 s34, 238609295
  v_mov_b32 v23, 2147483632
  v_add_u32 v3, -256, v0
  v_mul_hi_u32 v4, v3, s34
  v_mul_u32_u24 v5, 18, v4
  v_sub_u32 v5, v3, v5
  v_mul_u32_u24 v4, 221184, v4
  v_cmp_gt_u32 vcc, 198, v3
  v_lshl_add_u32 v4, v5, 7, v4
  s_nop 0
  v_cndmask_b32 v4, v23, v4, vcc
  buffer_load_dword v22, v4, s[16:19], s33 offen
  s_cmp_lg_u32 s30, 4
  s_cbranch_scc1 L_g1np_16
  v_lshrrev_b32 v3, 2, v1
  v_and_b32 v8, 3, v1
  v_lshlrev_b32 v3, 7, v3
  v_lshl_add_u32 v3, v8, 3, v3
  s_lshl_b32 s33, s57, 11
  s_add_u32 s33, s33, 57344
  v_add_u32 v8, s33, v3
  s_mov_b32 exec_lo, -1
  s_mov_b32 exec_hi, -1
  s_mov_b32 s78, 0
L_poll_17:
  buffer_load_dwordx2 v[4:5], v8, s[72:75], 0 offen sc1
  s_add_u32 s78, s78, 1
  s_waitcnt vmcnt(0)
  v_xor_b32 v4, s98, v4
  v_xor_b32 v5, s98, v5
  v_or_b32 v4, v4, v5
  v_cmp_ne_u32 vcc, 0, v4
  s_cmp_gt_u32 s78, 60000
  s_cbranch_scc1 L_poll_17_x
  s_cmp_eq_u64 vcc, 0
  s_cbranch_scc1 L_poll_17_x
  s_sleep 1
  s_branch L_poll_17
L_poll_17_x:
  s_mov_b64 exec, -1
L_g1np_16:
  s_barrier
  s_add_u32 m0, 0, s51
  s_nop 0
  buffer_load_dwordx4 v16, s[12:15], s60 offen sc1 lds
  buffer_load_dwordx4 v17, s[12:15], s60 offen offset:1024 sc1 lds
  buffer_load_dwordx4 v18, s[12:15], s60 offen offset:2048 sc1 lds
  buffer_load_dwordx4 v19, s[12:15], s60 offen offset:3072 sc1 lds
  s_cmp_eq_u32 s53, 0
  s_cbranch_scc1 L_nobig_18
  s_add_u32 m0, 0, s52
  s_nop 0
  buffer_load_dwordx4 v20, s[12:15], s60 offen sc1 lds
L_nobig_18:
  s_add_u32 m0, 43008, s51
  s_nop 0
  buffer_load_dwordx4 v16, s[12:15], s61 offen sc1 lds
  buffer_load_dwordx4 v17, s[12:15], s61 offen offset:1024 sc1 lds
  buffer_load_dwordx4 v18, s[12:15], s61 offen offset:2048 sc1 lds
  buffer_load_dwordx4 v19, s[12:15], s61 offen offset:3072 sc1 lds
  s_cmp_eq_u32 s53, 0
  s_cbranch_scc1 L_nobig_19
  s_add_u32 m0, 43008, s52
  s_nop 0
  buffer_load_dwordx4 v20, s[12:15], s61 offen sc1 lds
L_nobig_19:
  s_cmp_eq_u32 s53, 0
  s_cbranch_scc1 L_wb_20
  s_waitcnt vmcnt(5)
  s_branch L_wj_21
L_wb_20:
  s_waitcnt vmcnt(4)
L_wj_21:
  s_barrier
  s_mul_i32 s45, s40, 73728
  s_add_u32 s45, s45, s48
  s_mul_i32 s46, s40, 589824
  s_add_u32 s46, s46, s49
  s_add_u32 m0, s44, s50
  s_nop 0
  buffer_load_dwordx4 v10, s[16:19], s46 offen lds
  buffer_load_dwordx4 v11, s[16:19], s46 offen offset:1024 lds
  buffer_load_dwordx4 v12, s[16:19], s46 offen offset:2048 lds
  buffer_load_dwordx4 v13, s[16:19], s46 offen offset:3072 lds
  s_add_u32 m0, s44, s54
  s_nop 0
  buffer_load_dwordx4 v14, s[16:19], s46 offen lds
  buffer_load_dwordx4 v15, s[16:19], s46 offen offset:1024 lds
  s_add_u32 m0, s44, s51
  s_nop 0
  buffer_load_dwordx4 v16, s[12:15], s45 offen sc1 lds
  buffer_load_dwordx4 v17, s[12:15], s45 offen offset:1024 sc1 lds
  buffer_load_dwordx4 v18, s[12:15], s45 offen offset:2048 sc1 lds
  buffer_load_dwordx4 v19, s[12:15], s45 offen offset:3072 sc1 lds
  s_cmp_eq_u32 s53, 0
  s_cbranch_scc1 L_nobig_22
  s_add_u32 m0, s44, s52
  s_nop 0
  buffer_load_dwordx4 v20, s[12:15], s45 offen sc1 lds
L_nobig_22:
  s_add_u32 s44, s44, 43008
  s_cmp_eq_u32 s44, 129024
  s_cselect_b32 s44, 0, s44
  s_add_u32 s40, s40, 1
  s_cmp_eq_u32 s40, s43
  s_cselect_b32 s40, s42, s40
  s_add_u32 s41, s41, 1
  s_cmp_eq_u32 s41, 2
  s_cselect_b32 s41, 0, s41
  s_cselect_b32 s45, 2, 0
  s_add_u32 s40, s40, s45
  s_add_u32 s42, s42, s45
  s_add_u32 s43, s43, s45
  s_mov_b32 s47, 3
L_g1_ld_11:
  s_cmp_eq_u32 s53, 0
  s_cbranch_scc1 L_wb_23
  s_waitcnt vmcnt(11)
  s_branch L_wj_24
L_wb_23:
  s_waitcnt vmcnt(10)
L_wj_24:
  s_barrier
L_g1_sk_12:
  s_mul_i32 s45, s40, 73728
  s_add_u32 s45, s45, s48
  s_mul_i32 s46, s40, 589824
  s_add_u32 s46, s46, s49
  s_add_u32 m0, s44, s50
  s_nop 0
  buffer_load_dwordx4 v10, s[16:19], s46 offen lds
  buffer_load_dwordx4 v11, s[16:19], s46 offen offset:1024 lds
  buffer_load_dwordx4 v12, s[16:19], s46 offen offset:2048 lds
  buffer_load_dwordx4 v13, s[16:19], s46 offen offset:3072 lds
  s_add_u32 m0, s44, s54
  s_nop 0
  buffer_load_dwordx4 v14, s[16:19], s46 offen lds
  buffer_load_dwordx4 v15, s[16:19], s46 offen offset:1024 lds
  s_add_u32 m0, s44, s51
  s_nop 0
  buffer_load_dwordx4 v16, s[12:15], s45 offen sc1 lds
  buffer_load_dwordx4 v17, s[12:15], s45 offen offset:1024 sc1 lds
  buffer_load_dwordx4 v18, s[12:15], s45 offen offset:2048 sc1 lds
  buffer_load_dwordx4 v19, s[12:15], s45 offen offset:3072 sc1 lds
  s_cmp_eq_u32 s53, 0
  s_cbranch_scc1 L_nobig_25
  s_add_u32 m0, s44, s52
  s_nop 0
  buffer_load_dwordx4 v20, s[12:15], s45 offen sc1 lds
L_nobig_25:
  s_add_u32 s44, s44, 43008
  s_cmp_eq_u32 s44, 129024
  s_cselect_b32 s44, 0, s44
  s_add_u32 s40, s40, 1
  s_cmp_eq_u32 s40, s43
  s_cselect_b32 s40, s42, s40
  s_add_u32 s41, s41, 1
  s_cmp_eq_u32 s41, 2
  s_cselect_b32 s41, 0, s41
  s_cselect_b32 s45, 2, 0
  s_add_u32 s40, s40, s45
  s_add_u32 s42, s42, s45
  s_add_u32 s43, s43, s45
  s_add_u32 s47, s47, 1
  s_cmp_lt_u32 s47, 16
  s_cbranch_scc1 L_g1_ld_11
  s_cmp_eq_u32 s53, 0
  s_cbranch_scc1 L_wb_26
  s_waitcnt vmcnt(11)
  s_branch L_wj_27
L_wb_26:
  s_waitcnt vmcnt(10)
L_wj_27:
  s_barrier
  s_waitcnt vmcnt(0)
  s_barrier
  s_barrier
  s_load_dwordx2 s[6:7], s[0:1], 48
  s_mov_b32 s34, 1431655766
  s_mul_hi_u32 s36, s29, s34
  s_mul_i32 s34, s36, 3
  s_sub_u32 s35, s29, s34
  s_and_b32 s34, s28, 1
  s_lshl_b32 s34, s34, 3
  s_add_u32 s34, s34, s36
  s_lshr_b32 s37, s28, 1
  s_mul_i32 s48, s35, 3072
  s_mul_i32 s33, s37, 1327104
  s_add_u32 s48, s48, s33
  s_lshl_b32 s49, s34, 8
  s_mul_i32 s33, s37, 4718592
  s_add_u32 s49, s49, s33
  s_add_u32 s33, s36, s35
  s_mov_b32 s35, 1431655766
  s_mul_hi_u32 s34, s33, s35
  s_mul_i32 s34, s34, 3
  s_sub_u32 s33, s33, s34
  s_mul_i32 s40, s33, 1
  s_add_u32 s12, s76, 4718592
  s_addc_u32 s13, s77, 0
  s_and_b32 s13, s13, 0xffff
  s_mov_b32 s14, 5308416
  s_mov_b32 s15, 0x20000
  s_sub_u32 s33, s30, 4
  v_lshrrev_b32 v3, 4, v1
  v_and_b32 v4, 15, v1
  v_lshlrev_b32 v5, 1, v3
  v_xor_b32 v4, v4, v5
  v_lshlrev_b32 v3, 12, v3
  v_lshl_add_u32 v3, v4, 4, v3
  s_lshl_b32 s35, s33, 16
  v_add_u32 v10, s35, v3
  v_xor_b32 v11, 128, v10
  v_add_u32 v11, 15360, v11
  v_add_u32 v12, 30720, v10
  v_add_u32 v13, 30720, v11
  s_mul_i32 s34, s33, 18432
  v_lshlrev_b32 v14, 4, v1
  v_add_u32 v14, s34, v14
  v_add_u32 v15, 9216, v14
  s_lshl_b32 s2, s33, 12
  s_add_u32 s2, s2, 24576
  s_mul_i32 s3, s33, 6144
  s_add_u32 s10, s3, 3072
  s_waitcnt lgkmcnt(0)
  s_mov_b32 s16, s6
  s_and_b32 s17, s7, 0xffff
  s_mov_b32 s18, 18874368
  s_mov_b32 s19, 0x20000
  s_barrier
  s_add_u32 s20, s76, 4718592
  s_addc_u32 s21, s77, 0
  s_and_b32 s21, s21, 0xffff
  s_mov_b32 s22, 5308416
  s_mov_b32 s23, 0x20000
  s_add_u32 s68, s76, 19660800
  s_addc_u32 s69, s77, 0
  s_and_b32 s69, s69, 0xffff
  s_mov_b32 s70, 5308416
  s_mov_b32 s71, 0x20000
  s_lshl_b32 s58, s31, 1
  s_add_u32 s58, s58, s57
  s_lshl_b32 s59, s31, 2
  s_add_u32 s59, s59, s32
  s_lshl_b32 s59, s59, 1
  s_add_u32 s59, s59, s57
  v_lshlrev_b32 v239, 4, v1
  s_add_u32 s33, s30, 0
  s_mov_b32 s35, 477218589
  s_mul_hi_u32 s34, s33, s35
  s_mul_i32 s35, s34, 9
  s_sub_u32 s35, s33, s35
  s_mul_i32 s36, s34, 18432
  s_lshl_b32 s37, s35, 10
  s_add_u32 s60, s36, s37
  s_mul_i32 s36, s58, 3
  s_add_u32 s36, s36, s34
  s_mul_i32 s36, s36, 36864
  s_mul_i32 s37, s32, 2304
  s_add_u32 s36, s36, s37
  s_lshl_b32 s37, s35, 8
  s_add_u32 s64, s36, s37
  s_add_u32 s33, s30, 8
  s_mov_b32 s35, 477218589
  s_mul_hi_u32 s34, s33, s35
  s_mul_i32 s35, s34, 9
  s_sub_u32 s35, s33, s35
  s_mul_i32 s36, s34, 18432
  s_lshl_b32 s37, s35, 10
  s_add_u32 s61, s36, s37
  s_mul_i32 s36, s58, 3
  s_add_u32 s36, s36, s34
  s_mul_i32 s36, s36, 36864
  s_mul_i32 s37, s32, 2304
  s_add_u32 s36, s36, s37
  s_lshl_b32 s37, s35, 8
  s_add_u32 s65, s36, s37
  s_add_u32 s33, s30, 16
  s_mov_b32 s35, 477218589
  s_mul_hi_u32 s34, s33, s35
  s_mul_i32 s35, s34, 9
  s_sub_u32 s35, s33, s35
  s_mul_i32 s36, s34, 18432
  s_lshl_b32 s37, s35, 10
  s_add_u32 s62, s36, s37
  s_mul_i32 s36, s58, 3
  s_add_u32 s36, s36, s34
  s_mul_i32 s36, s36, 36864
  s_mul_i32 s37, s32, 2304
  s_add_u32 s36, s36, s37
  s_lshl_b32 s37, s35, 8
  s_add_u32 s66, s36, s37
  s_add_u32 s33, s30, 24
  s_mov_b32 s35, 477218589
  s_mul_hi_u32 s34, s33, s35
  s_mul_i32 s35, s34, 9
  s_sub_u32 s35, s33, s35
  s_mul_i32 s36, s34, 18432
  s_lshl_b32 s37, s35, 10
  s_add_u32 s63, s36, s37
  s_mul_i32 s36, s58, 3
  s_add_u32 s36, s36, s34
  s_mul_i32 s36, s36, 36864
  s_mul_i32 s37, s32, 2304
  s_add_u32 s36, s36, s37
  s_lshl_b32 s37, s35, 8
  s_add_u32 s67, s36, s37
  s_cmp_lg_u32 s30, 4
  s_cbranch_scc1 L_g1epi_9
  s_add_u32 s33, s59, 256
  s_lshl_b32 s33, s33, 7
  v_lshlrev_b32 v8, 2, v1
  v_add_u32 v8, s33, v8
  s_mov_b32 exec_lo, 3
  s_mov_b32 exec_hi, 0
  s_mov_b32 s78, 0
L_poll_29:
  buffer_load_dword v4, v8, s[72:75], 0 offen sc1
  s_add_u32 s78, s78, 1
  s_waitcnt vmcnt(0)
  v_xor_b32 v4, s98, v4
  v_cmp_ne_u32 vcc, 0, v4
  s_cmp_gt_u32 s78, 60000
  s_cbranch_scc1 L_poll_29_x
  s_cmp_eq_u64 vcc, 0
  s_cbranch_scc1 L_poll_29_x
  s_sleep 1
  s_branch L_poll_29
L_poll_29_x:
  s_mov_b64 exec, -1
  s_branch L_g1epi_9
L_g1back_10:
  s_mov_b32 s44, 40960
  s_mov_b32 s41, 0
  s_mov_b32 s42, 0
  s_mov_b32 s43, 3
  s_mul_i32 s53, s40, 73728
  s_add_u32 s53, s53, s48
  s_mul_i32 s46, s40, 262144
  s_add_u32 s46, s46, s49
  s_add_u32 m0, s44, s2
  s_nop 0
  buffer_load_dwordx4 v10, s[16:19], s46 offen lds
  buffer_load_dwordx4 v11, s[16:19], s46 offen offset:1024 lds
  buffer_load_dwordx4 v12, s[16:19], s46 offen offset:2048 lds
  buffer_load_dwordx4 v13, s[16:19], s46 offen offset:3072 lds
  s_add_u32 s44, s44, 40960
  s_cmp_eq_u32 s44, 163840
  s_cselect_b32 s44, 0, s44
  s_add_u32 s40, s40, 1
  s_cmp_eq_u32 s40, s43
  s_cselect_b32 s40, s42, s40
  s_add_u32 s41, s41, 1
  s_cmp_eq_u32 s41, 3
  s_cselect_b32 s41, 0, s41
  s_cselect_b32 s45, 3, 0
  s_add_u32 s40, s40, s45
  s_add_u32 s42, s42, s45
  s_add_u32 s43, s43, s45
  s_mul_i32 s54, s40, 73728
  s_add_u32 s54, s54, s48
  s_mul_i32 s46, s40, 262144
  s_add_u32 s46, s46, s49
  s_add_u32 m0, s44, s2
  s_nop 0
  buffer_load_dwordx4 v10, s[16:19], s46 offen lds
  buffer_load_dwordx4 v11, s[16:19], s46 offen offset:1024 lds
  buffer_load_dwordx4 v12, s[16:19], s46 offen offset:2048 lds
  buffer_load_dwordx4 v13, s[16:19], s46 offen offset:3072 lds
  s_add_u32 s44, s44, 40960
  s_cmp_eq_u32 s44, 163840
  s_cselect_b32 s44, 0, s44
  s_add_u32 s40, s40, 1
  s_cmp_eq_u32 s40, s43
  s_cselect_b32 s40, s42, s40
  s_add_u32 s41, s41, 1
  s_cmp_eq_u32 s41, 3
  s_cselect_b32 s41, 0, s41
  s_cselect_b32 s45, 3, 0
  s_add_u32 s40, s40, s45
  s_add_u32 s42, s42, s45
  s_add_u32 s43, s43, s45
  s_mul_i32 s55, s40, 73728
  s_add_u32 s55, s55, s48
  s_mul_i32 s46, s40, 262144
  s_add_u32 s46, s46, s49
  s_add_u32 m0, s44, s2
  s_nop 0
  buffer_load_dwordx4 v10, s[16:19], s46 offen lds
  buffer_load_dwordx4 v11, s[16:19], s46 offen offset:1024 lds
  buffer_load_dwordx4 v12, s[16:19], s46 offen offset:2048 lds
  buffer_load_dwordx4 v13, s[16:19], s46 offen offset:3072 lds
  s_add_u32 s44, s44, 40960
  s_cmp_eq_u32 s44, 163840
  s_cselect_b32 s44, 0, s44
  s_add_u32 s40, s40, 1
  s_cmp_eq_u32 s40, s43
  s_cselect_b32 s40, s42, s40
  s_add_u32 s41, s41, 1
  s_cmp_eq_u32 s41, 3
  s_cselect_b32 s41, 0, s41
  s_cselect_b32 s45, 3, 0
  s_add_u32 s40, s40, s45
  s_add_u32 s42, s42, s45
  s_add_u32 s43, s43, s45
  s_cmp_lg_u32 s30, 4
  s_cbranch_scc1 L_g2np_33
  v_lshrrev_b32 v3, 2, v1
  v_and_b32 v8, 3, v1
  v_lshlrev_b32 v3, 7, v3
  v_lshl_add_u32 v3, v8, 2, v3
  s_lshr_b32 s33, s28, 1
  s_mul_i32 s33, s33, 1536
  s_add_u32 s33, s33, 61440
  v_add_u32 v8, s33, v3
  s_mov_b32 exec_lo, -1
  s_mov_b32 exec_hi, 65535
  s_mov_b32 s78, 0
L_poll_34:
  buffer_load_dword v4, v8, s[72:75], 0 offen sc1
  s_add_u32 s78, s78, 1
  s_waitcnt vmcnt(0)
  v_xor_b32 v4, s98, v4
  v_cmp_ne_u32 vcc, 0, v4
  s_cmp_gt_u32 s78, 60000
  s_cbranch_scc1 L_poll_34_x
  s_cmp_eq_u64 vcc, 0
  s_cbranch_scc1 L_poll_34_x
  s_sleep 1
  s_branch L_poll_34
L_poll_34_x:
  s_mov_b64 exec, -1
L_g2np_33:
  s_barrier
  s_add_u32 m0, 40960, s3
  s_nop 0
  buffer_load_dwordx4 v14, s[12:15], s53 offen sc1 lds
  buffer_load_dwordx4 v14, s[12:15], s53 offen offset:1024 sc1 lds
  buffer_load_dwordx4 v14, s[12:15], s53 offen offset:2048 sc1 lds
  s_add_u32 m0, 40960, s10
  s_nop 0
  buffer_load_dwordx4 v15, s[12:15], s53 offen sc1 lds
  buffer_load_dwordx4 v15, s[12:15], s53 offen offset:1024 sc1 lds
  buffer_load_dwordx4 v15, s[12:15], s53 offen offset:2048 sc1 lds
  s_add_u32 m0, 81920, s3
  s_nop 0
  buffer_load_dwordx4 v14, s[12:15], s54 offen sc1 lds
  buffer_load_dwordx4 v14, s[12:15], s54 offen offset:1024 sc1 lds
  buffer_load_dwordx4 v14, s[12:15], s54 offen offset:2048 sc1 lds
  s_add_u32 m0, 81920, s10
  s_nop 0
  buffer_load_dwordx4 v15, s[12:15], s54 offen sc1 lds
  buffer_load_dwordx4 v15, s[12:15], s54 offen offset:1024 sc1 lds
  buffer_load_dwordx4 v15, s[12:15], s54 offen offset:2048 sc1 lds
  s_add_u32 m0, 122880, s3
  s_nop 0
  buffer_load_dwordx4 v14, s[12:15], s55 offen sc1 lds
  buffer_load_dwordx4 v14, s[12:15], s55 offen offset:1024 sc1 lds
  buffer_load_dwordx4 v14, s[12:15], s55 offen offset:2048 sc1 lds
  s_add_u32 m0, 122880, s10
  s_nop 0
  buffer_load_dwordx4 v15, s[12:15], s55 offen sc1 lds
  buffer_load_dwordx4 v15, s[12:15], s55 offen offset:1024 sc1 lds
  buffer_load_dwordx4 v15, s[12:15], s55 offen offset:2048 sc1 lds
  s_waitcnt vmcnt(12)
  s_barrier
  s_mul_i32 s45, s40, 73728
  s_add_u32 s45, s45, s48
  s_mul_i32 s46, s40, 262144
  s_add_u32 s46, s46, s49
  s_add_u32 m0, s44, s2
  s_nop 0
  buffer_load_dwordx4 v10, s[16:19], s46 offen lds
  buffer_load_dwordx4 v11, s[16:19], s46 offen offset:1024 lds
  buffer_load_dwordx4 v12, s[16:19], s46 offen offset:2048 lds
  buffer_load_dwordx4 v13, s[16:19], s46 offen offset:3072 lds
  s_add_u32 m0, s44, s3
  s_nop 0
  buffer_load_dwordx4 v14, s[12:15], s45 offen sc1 lds
  buffer_load_dwordx4 v14, s[12:15], s45 offen offset:1024 sc1 lds
  buffer_load_dwordx4 v14, s[12:15], s45 offen offset:2048 sc1 lds
  s_add_u32 m0, s44, s10
  s_nop 0
  buffer_load_dwordx4 v15, s[12:15], s45 offen sc1 lds
  buffer_load_dwordx4 v15, s[12:15], s45 offen offset:1024 sc1 lds
  buffer_load_dwordx4 v15, s[12:15], s45 offen offset:2048 sc1 lds
  s_add_u32 s44, s44, 40960
  s_cmp_eq_u32 s44, 163840
  s_cselect_b32 s44, 0, s44
  s_add_u32 s40, s40, 1
  s_cmp_eq_u32 s40, s43
  s_cselect_b32 s40, s42, s40
  s_add_u32 s41, s41, 1
  s_cmp_eq_u32 s41, 3
  s_cselect_b32 s41, 0, s41
  s_cselect_b32 s45, 3, 0
  s_add_u32 s40, s40, s45
  s_add_u32 s42, s42, s45
  s_add_u32 s43, s43, s45
  s_waitcnt vmcnt(16)
  s_barrier
  s_mul_i32 s45, s40, 73728
  s_add_u32 s45, s45, s48
  s_mul_i32 s46, s40, 262144
  s_add_u32 s46, s46, s49
  s_add_u32 m0, s44, s2
  s_nop 0
  buffer_load_dwordx4 v10, s[16:19], s46 offen lds
  buffer_load_dwordx4 v11, s[16:19], s46 offen offset:1024 lds
  buffer_load_dwordx4 v12, s[16:19], s46 offen offset:2048 lds
  buffer_load_dwordx4 v13, s[16:19], s46 offen offset:3072 lds
  s_add_u32 m0, s44, s3
  s_nop 0
  buffer_load_dwordx4 v14, s[12:15], s45 offen sc1 lds
  buffer_load_dwordx4 v14, s[12:15], s45 offen offset:1024 sc1 lds
  buffer_load_dwordx4 v14, s[12:15], s45 offen offset:2048 sc1 lds
  s_add_u32 m0, s44, s10
  s_nop 0
  buffer_load_dwordx4 v15, s[12:15], s45 offen sc1 lds
  buffer_load_dwordx4 v15, s[12:15], s45 offen offset:1024 sc1 lds
  buffer_load_dwordx4 v15, s[12:15], s45 offen offset:2048 sc1 lds
  s_add_u32 s44, s44, 40960
  s_cmp_eq_u32 s44, 163840
  s_cselect_b32 s44, 0, s44
  s_add_u32 s40, s40, 1
  s_cmp_eq_u32 s40, s43
  s_cselect_b32 s40, s42, s40
  s_add_u32 s41, s41, 1
  s_cmp_eq_u32 s41, 3
  s_cselect_b32 s41, 0, s41
  s_cselect_b32 s45, 3, 0
  s_add_u32 s40, s40, s45
  s_add_u32 s42, s42, s45
  s_add_u32 s43, s43, s45
  s_mov_b32 s47, 5
L_g2_ld_30:
  s_waitcnt vmcnt(20)
  s_barrier
L_g2_sk_31:
  s_mul_i32 s45, s40, 73728
  s_add_u32 s45, s45, s48
  s_mul_i32 s46, s40, 262144
  s_add_u32 s46, s46, s49
  s_add_u32 m0, s44, s2
  s_nop 0
  buffer_load_dwordx4 v10, s[16:19], s46 offen lds
  buffer_load_dwordx4 v11, s[16:19], s46 offen offset:1024 lds
  buffer_load_dwordx4 v12, s[16:19], s46 offen offset:2048 lds
  buffer_load_dwordx4 v13, s[16:19], s46 offen offset:3072 lds
  s_add_u32 m0, s44, s3
  s_nop 0
  buffer_load_dwordx4 v14, s[12:15], s45 offen sc1 lds
  buffer_load_dwordx4 v14, s[12:15], s45 offen offset:1024 sc1 lds
  buffer_load_dwordx4 v14, s[12:15], s45 offen offset:2048 sc1 lds
  s_add_u32 m0, s44, s10
  s_nop 0
  buffer_load_dwordx4 v15, s[12:15], s45 offen sc1 lds
  buffer_load_dwordx4 v15, s[12:15], s45 offen offset:1024 sc1 lds
  buffer_load_dwordx4 v15, s[12:15], s45 offen offset:2048 sc1 lds
  s_add_u32 s44, s44, 40960
  s_cmp_eq_u32 s44, 163840
  s_cselect_b32 s44, 0, s44
  s_add_u32 s40, s40, 1
  s_cmp_eq_u32 s40, s43
  s_cselect_b32 s40, s42, s40
  s_add_u32 s41, s41, 1
  s_cmp_eq_u32 s41, 3
  s_cselect_b32 s41, 0, s41
  s_cselect_b32 s45, 3, 0
  s_add_u32 s40, s40, s45
  s_add_u32 s42, s42, s45
  s_add_u32 s43, s43, s45
  s_add_u32 s47, s47, 1
  s_cmp_lt_u32 s47, 18
  s_cbranch_scc1 L_g2_ld_30
  s_waitcnt vmcnt(20)
  s_barrier
  s_waitcnt vmcnt(10)
  s_barrier
  s_waitcnt vmcnt(0)
  s_barrier
  s_barrier
  s_load_dwordx2 s[8:9], s[0:1], 56
  s_load_dwordx2 s[52:53], s[0:1], 64
  s_load_dwordx2 s[4:5], s[0:1], 0
  s_and_b32 s28, s99, 7
  s_lshr_b32 s29, s99, 3
  s_mov_b32 s30, s100
  v_and_b32 v1, 63, v0
  s_sub_u32 s33, s29, 8
  s_mov_b32 s34, 1431655766
  s_mul_hi_u32 s56, s33, s34
  s_mul_i32 s34, s56, 3
  s_sub_u32 s32, s33, s34
  s_and_b32 s34, s28, 1
  s_lshl_b32 s34, s34, 3
  s_add_u32 s31, s56, s34
  s_lshr_b32 s57, s28, 1
  s_waitcnt lgkmcnt(0)
  s_mov_b32 s20, s52
  s_and_b32 s21, s53, 0xffff
  s_mov_b32 s22, 2359296
  s_mov_b32 s23, 0x20000
  s_add_u32 s24, s76, 24969216
  s_addc_u32 s25, s77, 0
  s_and_b32 s25, s25, 0xffff
  s_mov_b32 s26, 9437184
  s_mov_b32 s27, 0x20000
  s_mov_b32 s60, s8
  s_and_b32 s61, s9, 0xffff
  s_mov_b32 s62, 4096
  s_mov_b32 s63, 0x20000
  s_add_u32 s68, s76, 10223616
  s_addc_u32 s69, s77, 0
  s_and_b32 s69, s69, 0xffff
  s_mov_b32 s70, 9437184
  s_mov_b32 s71, 0x20000
  s_mov_b32 s12, s4
  s_and_b32 s13, s5, 0xffff
  s_mov_b32 s14, 2359296
  s_mov_b32 s15, 0x20000
  s_lshr_b32 s33, s57, 1
  s_lshl_b32 s36, s31, 1
  s_add_u32 s36, s36, s33
  s_and_b32 s33, s57, 1
  s_lshl_b32 s37, s32, 1
  s_add_u32 s37, s37, s33
  s_mul_i32 s34, s36, 73728
  s_mul_i32 s35, s37, 192
  s_add_u32 s64, s34, s35
  s_lshr_b32 s34, s30, 2
  s_lshl_b32 s35, s34, 6
  s_add_u32 s64, s64, s35
  s_and_b32 s33, s30, 3
  s_lshl_b32 s65, s36, 2
  s_add_u32 s65, s65, s33
  s_mul_i32 s65, s65, 18
  s_mul_i32 s35, s37, 3
  s_add_u32 s65, s65, s35
  s_add_u32 s65, s65, s34
  s_lshl_b32 s65, s65, 10
  s_lshl_b32 s35, s36, 7
  s_mul_i32 s58, s31, 3
  s_add_u32 s58, s58, s32
  s_lshl_b32 s58, s58, 2
  s_add_u32 s59, s58, s57
  s_mul_i32 s67, s59, 49152
  v_and_b32 v2, 15, v1
  v_lshrrev_b32 v3, 4, v1
  v_and_b32 v4, 1, v3
  v_lshlrev_b32 v4, 5, v4
  v_lshrrev_b32 v3, 1, v3
  v_lshl_add_u32 v4, v3, 4, v4
  s_lshl_b32 s33, s33, 4
  v_add_u32 v2, s33, v2
  v_mul_u32_u24 v5, 1152, v2
  v_add_u32 v240, v5, v4
  buffer_load_dwordx4 v[248:251], v240, s[12:15], s64 offen
  buffer_load_dwordx4 v[252:255], v240, s[12:15], s64 offen offset:128
  v_lshlrev_b32 v243, 4, v1
  v_lshlrev_b32 v241, 4, v1
  s_cmp_lg_u32 s30, 4
  s_cbranch_scc1 L_g2na_35
  s_lshl_b32 s34, s31, 7
  v_lshlrev_b32 v8, 2, v1
  v_add_u32 v8, s34, v8
  s_mov_b32 exec_lo, 15
  s_mov_b32 exec_hi, 0
  s_mov_b32 s78, 0
L_poll_36:
  buffer_load_dword v4, v8, s[72:75], 0 offen sc1
  s_add_u32 s78, s78, 1
  s_waitcnt vmcnt(0)
  v_xor_b32 v4, s98, v4
  v_cmp_ne_u32 vcc, 0, v4
  s_cmp_gt_u32 s78, 60000
  s_cbranch_scc1 L_poll_36_x
  s_cmp_eq_u64 vcc, 0
  s_cbranch_scc1 L_poll_36_x
  s_sleep 1
  s_branch L_poll_36
L_poll_36_x:
  s_mov_b64 exec, -1
L_g2na_35:
  s_barrier
  s_add_u32 s66, s65, 2359296
  s_add_u32 s2, s66, 2359296
  s_add_u32 s3, s2, 2359296
  buffer_load_dwordx4 v[112:115], v241, s[24:27], s65 offen offset:0 sc1
  buffer_load_dwordx4 v[116:119], v241, s[24:27], s66 offen offset:0 sc1
  buffer_load_dwordx4 v[120:123], v241, s[24:27], s2 offen offset:0 sc1
  buffer_load_dwordx4 v[124:127], v241, s[24:27], s3 offen offset:0 sc1
  s_cmp_lg_u32 s30, 4
  s_cbranch_scc1 L_g2epi_28
  s_add_u32 s33, s59, 64
  s_lshl_b32 s33, s33, 7
  s_add_u32 s34, s57, 1
  v_add_u32 v8, s34, v1
  v_and_b32 v8, 3, v8
  v_lshlrev_b32 v8, 2, v8
  v_add_u32 v8, s33, v8
  s_mov_b32 exec_lo, 7
  s_mov_b32 exec_hi, 0
  s_mov_b32 s78, 0
L_poll_37:
  buffer_load_dword v4, v8, s[72:75], 0 offen sc1
  s_add_u32 s78, s78, 1
  s_waitcnt vmcnt(0)
  v_xor_b32 v4, s98, v4
  v_cmp_ne_u32 vcc, 0, v4
  s_cmp_gt_u32 s78, 60000
  s_cbranch_scc1 L_poll_37_x
  s_cmp_eq_u64 vcc, 0
  s_cbranch_scc1 L_poll_37_x
  s_sleep 1
  s_branch L_poll_37
L_poll_37_x:
  s_mov_b64 exec, -1
  s_branch L_g2epi_28
L_g_cons:
  s_load_dwordx2 s[8:9], s[0:1], 40
  s_and_b32 s28, s99, 7
  s_lshr_b32 s29, s99, 3
  s_mov_b32 s30, s100
  v_and_b32 v1, 63, v0
  s_sub_u32 s29, s29, 8
  s_lshr_b32 s31, s29, 2
  s_lshr_b32 s32, s28, 1
  s_mul_i32 s32, s32, 6
  s_add_u32 s31, s31, s32
  s_and_b32 s32, s29, 3
  s_and_b32 s57, s28, 1
  s_add_u32 s20, s76, 4718592
  s_addc_u32 s21, s77, 0
  s_and_b32 s21, s21, 0xffff
  s_mov_b32 s22, 5308416
  s_mov_b32 s23, 0x20000
  s_add_u32 s68, s76, 19660800
  s_addc_u32 s69, s77, 0
  s_and_b32 s69, s69, 0xffff
  s_mov_b32 s70, 5308416
  s_mov_b32 s71, 0x20000
  s_lshl_b32 s58, s31, 1
  s_add_u32 s58, s58, s57
  s_lshl_b32 s59, s31, 2
  s_add_u32 s59, s59, s32
  s_lshl_b32 s59, s59, 1
  s_add_u32 s59, s59, s57
  v_lshlrev_b32 v239, 4, v1
  s_add_u32 s33, s30, 0
  s_mov_b32 s35, 477218589
  s_mul_hi_u32 s34, s33, s35
  s_mul_i32 s35, s34, 9
  s_sub_u32 s35, s33, s35
  s_mul_i32 s36, s34, 18432
  s_lshl_b32 s37, s35, 10
  s_add_u32 s60, s36, s37
  s_mul_i32 s36, s58, 3
  s_add_u32 s36, s36, s34
  s_mul_i32 s36, s36, 36864
  s_mul_i32 s37, s32, 2304
  s_add_u32 s36, s36, s37
  s_lshl_b32 s37, s35, 8
  s_add_u32 s64, s36, s37
  s_add_u32 s33, s30, 8
  s_mov_b32 s35, 477218589
  s_mul_hi_u32 s34, s33, s35
  s_mul_i32 s35, s34, 9
  s_sub_u32 s35, s33, s35
  s_mul_i32 s36, s34, 18432
  s_lshl_b32 s37, s35, 10
  s_add_u32 s61, s36, s37
  s_mul_i32 s36, s58, 3
  s_add_u32 s36, s36, s34
  s_mul_i32 s36, s36, 36864
  s_mul_i32 s37, s32, 2304
  s_add_u32 s36, s36, s37
  s_lshl_b32 s37, s35, 8
  s_add_u32 s65, s36, s37
  s_add_u32 s33, s30, 16
  s_mov_b32 s35, 477218589
  s_mul_hi_u32 s34, s33, s35
  s_mul_i32 s35, s34, 9
  s_sub_u32 s35, s33, s35
  s_mul_i32 s36, s34, 18432
  s_lshl_b32 s37, s35, 10
  s_add_u32 s62, s36, s37
  s_mul_i32 s36, s58, 3
  s_add_u32 s36, s36, s34
  s_mul_i32 s36, s36, 36864
  s_mul_i32 s37, s32, 2304
  s_add_u32 s36, s36, s37
  s_lshl_b32 s37, s35, 8
  s_add_u32 s66, s36, s37
  s_add_u32 s33, s30, 24
  s_mov_b32 s35, 477218589
  s_mul_hi_u32 s34, s33, s35
  s_mul_i32 s35, s34, 9
  s_sub_u32 s35, s33, s35
  s_mul_i32 s36, s34, 18432
  s_lshl_b32 s37, s35, 10
  s_add_u32 s63, s36, s37
  s_mul_i32 s36, s58, 3
  s_add_u32 s36, s36, s34
  s_mul_i32 s36, s36, 36864
  s_mul_i32 s37, s32, 2304
  s_add_u32 s36, s36, s37
  s_lshl_b32 s37, s35, 8
  s_add_u32 s67, s36, s37
  v_lshrrev_b32 v2, 4, v1
  v_lshlrev_b32 v2, 3, v2
  s_mul_i32 s33, s31, 384
  s_mul_i32 s34, s30, 96
  s_add_u32 s33, s33, s34
  s_lshr_b32 s34, s30, 1
  s_cmp_eq_u32 s34, s57
  s_cselect_b32 s33, s33, 0x7ff00000
  s_waitcnt lgkmcnt(0)
  s_mov_b32 s24, s8
  s_and_b32 s25, s9, 0xffff
  s_mov_b32 s26, 9216
  s_mov_b32 s27, 0x20000
  buffer_load_dwordx2 v[240:241], v2, s[24:27], s33 offen offset:0
  buffer_load_dwordx2 v[242:243], v2, s[24:27], s33 offen offset:32
  buffer_load_dwordx2 v[244:245], v2, s[24:27], s33 offen offset:64
  v_and_b32 v2, 15, v1
  v_lshrrev_b32 v3, 4, v1
  v_mul_u32_u24 v4, 2304, v3
  v_lshl_add_u32 v6, v2, 4, v4
  v_lshrrev_b32 v5, 2, v2
  v_lshl_add_u32 v4, v3, 3, v5
  v_mul_u32_u24 v4, 384, v4
  v_and_b32 v5, 3, v2
  v_lshl_add_u32 v4, v5, 3, v4
  v_add_u32 v4, 18432, v4
  v_lshrrev_b32 v5, 3, v2
  v_and_b32 v3, 1, v3
  v_lshl_add_u32 v5, v3, 1, v5
  s_mul_i32 s33, s30, 3
  v_xor_b32 v3, s33, v5
  v_lshl_add_u32 v7, v3, 5, v4
  s_add_u32 s33, s33, 1
  v_xor_b32 v3, s33, v5
  v_lshl_add_u32 v8, v3, 5, v4
  s_add_u32 s33, s33, 1
  v_xor_b32 v3, s33, v5
  v_lshl_add_u32 v9, v3, 5, v4
  s_and_b32 s33, s30, 1
  s_mul_i32 s55, s33, 27648
  s_xor_b32 s56, s59, 1
  s_mul_i32 s79, s56, 27648
  s_add_u32 s79, s79, s55
  v_add_u32 v10, s55, v239
  s_barrier
  s_mov_b32 s44, 0
  s_barrier
  v_add_u32 v12, s44, v6
  v_add_u32 v13, s44, v7
  v_add_u32 v14, s44, v8
  v_add_u32 v15, s44, v9
  s_add_u32 s44, s44, 43008
  s_cmp_eq_u32 s44, 129024
  s_cselect_b32 s44, 0, s44
  ds_read_b64_tr_b16 v[128:129], v13 offset:0
  ds_read_b64_tr_b16 v[130:131], v13 offset:1536
  ds_read_b64_tr_b16 v[132:133], v14 offset:0
  ds_read_b64_tr_b16 v[134:135], v14 offset:1536
  ds_read_b64_tr_b16 v[136:137], v15 offset:0
  ds_read_b64_tr_b16 v[138:139], v15 offset:1536
  ds_read_b128 v[140:143], v12 offset:0
  ds_read_b128 v[144:147], v12 offset:256
  ds_read_b128 v[148:151], v12 offset:512
  ds_read_b128 v[152:155], v12 offset:768
  ds_read_b128 v[156:159], v12 offset:1024
  ds_read_b128 v[160:163], v12 offset:1280
  ds_read_b128 v[164:167], v12 offset:1536
  ds_read_b128 v[168:171], v12 offset:1792
  ds_read_b128 v[172:175], v12 offset:2048
  s_waitcnt vmcnt(0)
  v_lshlrev_b32 v224, 16, v240
  v_and_b32 v225, 0xffff0000, v240
  v_lshlrev_b32 v226, 16, v241
  v_and_b32 v227, 0xffff0000, v241
  v_lshlrev_b32 v228, 16, v242
  v_and_b32 v229, 0xffff0000, v242
  v_lshlrev_b32 v230, 16, v243
  v_and_b32 v231, 0xffff0000, v243
  v_lshlrev_b32 v232, 16, v244
  v_and_b32 v233, 0xffff0000, v244
  v_lshlrev_b32 v234, 16, v245
  v_and_b32 v235, 0xffff0000, v245
  s_waitcnt lgkmcnt(0)
  ds_read_b64_tr_b16 v[176:177], v13 offset:12288
  v_mfma_f32_16x16x32_bf16 v[16:19], v[128:131], v[140:143], v[224:227]
  ds_read_b64_tr_b16 v[178:179], v13 offset:13824
  v_mfma_f32_16x16x32_bf16 v[20:23], v[128:131], v[144:147], v[224:227]
  ds_read_b64_tr_b16 v[180:181], v14 offset:12288
  v_mfma_f32_16x16x32_bf16 v[24:27], v[128:131], v[148:151], v[224:227]
  ds_read_b64_tr_b16 v[182:183], v14 offset:13824
  v_mfma_f32_16x16x32_bf16 v[28:31], v[128:131], v[152:155], v[224:227]
  ds_read_b64_tr_b16 v[184:185], v15 offset:12288
  v_mfma_f32_16x16x32_bf16 v[32:35], v[128:131], v[156:159], v[224:227]
  ds_read_b64_tr_b16 v[186:187], v15 offset:13824
  v_mfma_f32_16x16x32_bf16 v[36:39], v[128:131], v[160:163], v[224:227]
  ds_read_b128 v[188:191], v12 offset:9216
  v_mfma_f32_16x16x32_bf16 v[40:43], v[128:131], v[164:167], v[224:227]
  ds_read_b128 v[192:195], v12 offset:9472
  v_mfma_f32_16x16x32_bf16 v[44:47], v[128:131], v[168:171], v[224:227]
  ds_read_b128 v[196:199], v12 offset:9728
  v_mfma_f32_16x16x32_bf16 v[48:51], v[128:131], v[172:175], v[224:227]
  ds_read_b128 v[200:203], v12 offset:9984
  v_mfma_f32_16x16x32_bf16 v[52:55], v[132:135], v[140:143], v[228:231]
  ds_read_b128 v[204:207], v12 offset:10240
  v_mfma_f32_16x16x32_bf16 v[56:59], v[132:135], v[144:147], v[228:231]
  ds_read_b128 v[208:211], v12 offset:10496
  v_mfma_f32_16x16x32_bf16 v[60:63], v[132:135], v[148:151], v[228:231]
  ds_read_b128 v[212:215], v12 offset:10752
  v_mfma_f32_16x16x32_bf16 v[64:67], v[132:135], v[152:155], v[228:231]
  ds_read_b128 v[216:219], v12 offset:11008
  v_mfma_f32_16x16x32_bf16 v[68:71], v[132:135], v[156:159], v[228:231]
  ds_read_b128 v[220:223], v12 offset:11264
  v_mfma_f32_16x16x32_bf16 v[72:75], v[132:135], v[160:163], v[228:231]
  v_mfma_f32_16x16x32_bf16 v[76:79], v[132:135], v[164:167], v[228:231]
  v_mfma_f32_16x16x32_bf16 v[80:83], v[132:135], v[168:171], v[228:231]
  v_mfma_f32_16x16x32_bf16 v[84:87], v[132:135], v[172:175], v[228:231]
  v_mfma_f32_16x16x32_bf16 v[88:91], v[136:139], v[140:143], v[232:235]
  v_mfma_f32_16x16x32_bf16 v[92:95], v[136:139], v[144:147], v[232:235]
  v_mfma_f32_16x16x32_bf16 v[96:99], v[136:139], v[148:151], v[232:235]
  v_mfma_f32_16x16x32_bf16 v[100:103], v[136:139], v[152:155], v[232:235]
  v_mfma_f32_16x16x32_bf16 v[104:107], v[136:139], v[156:159], v[232:235]
  v_mfma_f32_16x16x32_bf16 v[108:111], v[136:139], v[160:163], v[232:235]
  v_mfma_f32_16x16x32_bf16 v[112:115], v[136:139], v[164:167], v[232:235]
  v_mfma_f32_16x16x32_bf16 v[116:119], v[136:139], v[168:171], v[232:235]
  v_mfma_f32_16x16x32_bf16 v[120:123], v[136:139], v[172:175], v[232:235]
  s_waitcnt lgkmcnt(0)
  s_barrier
  v_add_u32 v12, s44, v6
  v_add_u32 v13, s44, v7
  v_add_u32 v14, s44, v8
  v_add_u32 v15, s44, v9
  s_add_u32 s44, s44, 43008
  s_cmp_eq_u32 s44, 129024
  s_cselect_b32 s44, 0, s44
  ds_read_b64_tr_b16 v[128:129], v13 offset:0
  v_mfma_f32_16x16x32_bf16 v[16:19], v[176:179], v[188:191], v[16:19]
  ds_read_b64_tr_b16 v[130:131], v13 offset:1536
  v_mfma_f32_16x16x32_bf16 v[20:23], v[176:179], v[192:195], v[20:23]
  ds_read_b64_tr_b16 v[132:133], v14 offset:0
  v_mfma_f32_16x16x32_bf16 v[24:27], v[176:179], v[196:199], v[24:27]
  ds_read_b64_tr_b16 v[134:135], v14 offset:1536
  v_mfma_f32_16x16x32_bf16 v[28:31], v[176:179], v[200:203], v[28:31]
  ds_read_b64_tr_b16 v[136:137], v15 offset:0
  v_mfma_f32_16x16x32_bf16 v[32:35], v[176:179], v[204:207], v[32:35]
  ds_read_b64_tr_b16 v[138:139], v15 offset:1536
  v_mfma_f32_16x16x32_bf16 v[36:39], v[176:179], v[208:211], v[36:39]
  ds_read_b128 v[140:143], v12 offset:0
  v_mfma_f32_16x16x32_bf16 v[40:43], v[176:179], v[212:215], v[40:43]
  ds_read_b128 v[144:147], v12 offset:256
  v_mfma_f32_16x16x32_bf16 v[44:47], v[176:179], v[216:219], v[44:47]
  ds_read_b128 v[148:151], v12 offset:512
  v_mfma_f32_16x16x32_bf16 v[48:51], v[176:179], v[220:223], v[48:51]
  ds_read_b128 v[152:155], v12 offset:768
  v_mfma_f32_16x16x32_bf16 v[52:55], v[180:183], v[188:191], v[52:55]
  ds_read_b128 v[156:159], v12 offset:1024
  v_mfma_f32_16x16x32_bf16 v[56:59], v[180:183], v[192:195], v[56:59]
  ds_read_b128 v[160:163], v12 offset:1280
  v_mfma_f32_16x16x32_bf16 v[60:63], v[180:183], v[196:199], v[60:63]
  ds_read_b128 v[164:167], v12 offset:1536
  v_mfma_f32_16x16x32_bf16 v[64:67], v[180:183], v[200:203], v[64:67]
  ds_read_b128 v[168:171], v12 offset:1792
  v_mfma_f32_16x16x32_bf16 v[68:71], v[180:183], v[204:207], v[68:71]
  ds_read_b128 v[172:175], v12 offset:2048
  v_mfma_f32_16x16x32_bf16 v[72:75], v[180:183], v[208:211], v[72:75]
  v_mfma_f32_16x16x32_bf16 v[76:79], v[180:183], v[212:215], v[76:79]
  v_mfma_f32_16x16x32_bf16 v[80:83], v[180:183], v[216:219], v[80:83]
  v_mfma_f32_16x16x32_bf16 v[84:87], v[180:183], v[220:223], v[84:87]
  v_mfma_f32_16x16x32_bf16 v[88:91], v[184:187], v[188:191], v[88:91]
  v_mfma_f32_16x16x32_bf16 v[92:95], v[184:187], v[192:195], v[92:95]
  v_mfma_f32_16x16x32_bf16 v[96:99], v[184:187], v[196:199], v[96:99]
  v_mfma_f32_16x16x32_bf16 v[100:103], v[184:187], v[200:203], v[100:103]
  v_mfma_f32_16x16x32_bf16 v[104:107], v[184:187], v[204:207], v[104:107]
  v_mfma_f32_16x16x32_bf16 v[108:111], v[184:187], v[208:211], v[108:111]
  v_mfma_f32_16x16x32_bf16 v[112:115], v[184:187], v[212:215], v[112:115]
  v_mfma_f32_16x16x32_bf16 v[116:119], v[184:187], v[216:219], v[116:119]
  v_mfma_f32_16x16x32_bf16 v[120:123], v[184:187], v[220:223], v[120:123]
  s_waitcnt lgkmcnt(0)
  s_mov_b32 s47, 0
L_g1_c2_38:
  ds_read_b64_tr_b16 v[176:177], v13 offset:12288
  v_mfma_f32_16x16x32_bf16 v[16:19], v[128:131], v[140:143], v[16:19]
  ds_read_b64_tr_b16 v[178:179], v13 offset:13824
  v_mfma_f32_16x16x32_bf16 v[20:23], v[128:131], v[144:147], v[20:23]
  ds_read_b64_tr_b16 v[180:181], v14 offset:12288
  v_mfma_f32_16x16x32_bf16 v[24:27], v[128:131], v[148:151], v[24:27]
  ds_read_b64_tr_b16 v[182:183], v14 offset:13824
  v_mfma_f32_16x16x32_bf16 v[28:31], v[128:131], v[152:155], v[28:31]
  ds_read_b64_tr_b16 v[184:185], v15 offset:12288
  v_mfma_f32_16x16x32_bf16 v[32:35], v[128:131], v[156:159], v[32:35]
  ds_read_b64_tr_b16 v[186:187], v15 offset:13824
  v_mfma_f32_16x16x32_bf16 v[36:39], v[128:131], v[160:163], v[36:39]
  ds_read_b128 v[188:191], v12 offset:9216
  v_mfma_f32_16x16x32_bf16 v[40:43], v[128:131], v[164:167], v[40:43]
  ds_read_b128 v[192:195], v12 offset:9472
  v_mfma_f32_16x16x32_bf16 v[44:47], v[128:131], v[168:171], v[44:47]
  ds_read_b128 v[196:199], v12 offset:9728
  v_mfma_f32_16x16x32_bf16 v[48:51], v[128:131], v[172:175], v[48:51]
  ds_read_b128 v[200:203], v12 offset:9984
  v_mfma_f32_16x16x32_bf16 v[52:55], v[132:135], v[140:143], v[52:55]
  ds_read_b128 v[204:207], v12 offset:10240
  v_mfma_f32_16x16x32_bf16 v[56:59], v[132:135], v[144:147], v[56:59]
  ds_read_b128 v[208:211], v12 offset:10496
  v_mfma_f32_16x16x32_bf16 v[60:63], v[132:135], v[148:151], v[60:63]
  ds_read_b128 v[212:215], v12 offset:10752
  v_mfma_f32_16x16x32_bf16 v[64:67], v[132:135], v[152:155], v[64:67]
  ds_read_b128 v[216:219], v12 offset:11008
  v_mfma_f32_16x16x32_bf16 v[68:71], v[132:135], v[156:159], v[68:71]
  ds_read_b128 v[220:223], v12 offset:11264
  v_mfma_f32_16x16x32_bf16 v[72:75], v[132:135], v[160:163], v[72:75]
  v_mfma_f32_16x16x32_bf16 v[76:79], v[132:135], v[164:167], v[76:79]
  v_mfma_f32_16x16x32_bf16 v[80:83], v[132:135], v[168:171], v[80:83]
  v_mfma_f32_16x16x32_bf16 v[84:87], v[132:135], v[172:175], v[84:87]
  v_mfma_f32_16x16x32_bf16 v[88:91], v[136:139], v[140:143], v[88:91]
  v_mfma_f32_16x16x32_bf16 v[92:95], v[136:139], v[144:147], v[92:95]
  v_mfma_f32_16x16x32_bf16 v[96:99], v[136:139], v[148:151], v[96:99]
  v_mfma_f32_16x16x32_bf16 v[100:103], v[136:139], v[152:155], v[100:103]
  v_mfma_f32_16x16x32_bf16 v[104:107], v[136:139], v[156:159], v[104:107]
  v_mfma_f32_16x16x32_bf16 v[108:111], v[136:139], v[160:163], v[108:111]
  v_mfma_f32_16x16x32_bf16 v[112:115], v[136:139], v[164:167], v[112:115]
  v_mfma_f32_16x16x32_bf16 v[116:119], v[136:139], v[168:171], v[116:119]
  v_mfma_f32_16x16x32_bf16 v[120:123], v[136:139], v[172:175], v[120:123]
  s_waitcnt lgkmcnt(0)
  s_barrier
  v_add_u32 v12, s44, v6
  v_add_u32 v13, s44, v7
  v_add_u32 v14, s44, v8
  v_add_u32 v15, s44, v9
  s_add_u32 s44, s44, 43008
  s_cmp_eq_u32 s44, 129024
  s_cselect_b32 s44, 0, s44
  ds_read_b64_tr_b16 v[128:129], v13 offset:0
  v_mfma_f32_16x16x32_bf16 v[16:19], v[176:179], v[188:191], v[16:19]
  ds_read_b64_tr_b16 v[130:131], v13 offset:1536
  v_mfma_f32_16x16x32_bf16 v[20:23], v[176:179], v[192:195], v[20:23]
  ds_read_b64_tr_b16 v[132:133], v14 offset:0
  v_mfma_f32_16x16x32_bf16 v[24:27], v[176:179], v[196:199], v[24:27]
  ds_read_b64_tr_b16 v[134:135], v14 offset:1536
  v_mfma_f32_16x16x32_bf16 v[28:31], v[176:179], v[200:203], v[28:31]
  ds_read_b64_tr_b16 v[136:137], v15 offset:0
  v_mfma_f32_16x16x32_bf16 v[32:35], v[176:179], v[204:207], v[32:35]
  ds_read_b64_tr_b16 v[138:139], v15 offset:1536
  v_mfma_f32_16x16x32_bf16 v[36:39], v[176:179], v[208:211], v[36:39]
  ds_read_b128 v[140:143], v12 offset:0
  v_mfma_f32_16x16x32_bf16 v[40:43], v[176:179], v[212:215], v[40:43]
  ds_read_b128 v[144:147], v12 offset:256
  v_mfma_f32_16x16x32_bf16 v[44:47], v[176:179], v[216:219], v[44:47]
  ds_read_b128 v[148:151], v12 offset:512
  v_mfma_f32_16x16x32_bf16 v[48:51], v[176:179], v[220:223], v[48:51]
  ds_read_b128 v[152:155], v12 offset:768
  v_mfma_f32_16x16x32_bf16 v[52:55], v[180:183], v[188:191], v[52:55]
  ds_read_b128 v[156:159], v12 offset:1024
  v_mfma_f32_16x16x32_bf16 v[56:59], v[180:183], v[192:195], v[56:59]
  ds_read_b128 v[160:163], v12 offset:1280
  v_mfma_f32_16x16x32_bf16 v[60:63], v[180:183], v[196:199], v[60:63]
  ds_read_b128 v[164:167], v12 offset:1536
  v_mfma_f32_16x16x32_bf16 v[64:67], v[180:183], v[200:203], v[64:67]
  ds_read_b128 v[168:171], v12 offset:1792
  v_mfma_f32_16x16x32_bf16 v[68:71], v[180:183], v[204:207], v[68:71]
  ds_read_b128 v[172:175], v12 offset:2048
  v_mfma_f32_16x16x32_bf16 v[72:75], v[180:183], v[208:211], v[72:75]
  v_mfma_f32_16x16x32_bf16 v[76:79], v[180:183], v[212:215], v[76:79]
  v_mfma_f32_16x16x32_bf16 v[80:83], v[180:183], v[216:219], v[80:83]
  v_mfma_f32_16x16x32_bf16 v[84:87], v[180:183], v[220:223], v[84:87]
  v_mfma_f32_16x16x32_bf16 v[88:91], v[184:187], v[188:191], v[88:91]
  v_mfma_f32_16x16x32_bf16 v[92:95], v[184:187], v[192:195], v[92:95]
  v_mfma_f32_16x16x32_bf16 v[96:99], v[184:187], v[196:199], v[96:99]
  v_mfma_f32_16x16x32_bf16 v[100:103], v[184:187], v[200:203], v[100:103]
  v_mfma_f32_16x16x32_bf16 v[104:107], v[184:187], v[204:207], v[104:107]
  v_mfma_f32_16x16x32_bf16 v[108:111], v[184:187], v[208:211], v[108:111]
  v_mfma_f32_16x16x32_bf16 v[112:115], v[184:187], v[212:215], v[112:115]
  v_mfma_f32_16x16x32_bf16 v[116:119], v[184:187], v[216:219], v[116:119]
  v_mfma_f32_16x16x32_bf16 v[120:123], v[184:187], v[220:223], v[120:123]
  s_waitcnt lgkmcnt(0)
  s_add_u32 s47, s47, 1
  s_cmp_lt_u32 s47, 14
  s_cbranch_scc1 L_g1_c2_38
  ds_read_b64_tr_b16 v[176:177], v13 offset:12288
  v_mfma_f32_16x16x32_bf16 v[16:19], v[128:131], v[140:143], v[16:19]
  ds_read_b64_tr_b16 v[178:179], v13 offset:13824
  v_mfma_f32_16x16x32_bf16 v[20:23], v[128:131], v[144:147], v[20:23]
  ds_read_b64_tr_b16 v[180:181], v14 offset:12288
  v_mfma_f32_16x16x32_bf16 v[24:27], v[128:131], v[148:151], v[24:27]
  ds_read_b64_tr_b16 v[182:183], v14 offset:13824
  v_mfma_f32_16x16x32_bf16 v[28:31], v[128:131], v[152:155], v[28:31]
  ds_read_b64_tr_b16 v[184:185], v15 offset:12288
  v_mfma_f32_16x16x32_bf16 v[32:35], v[128:131], v[156:159], v[32:35]
  ds_read_b64_tr_b16 v[186:187], v15 offset:13824
  v_mfma_f32_16x16x32_bf16 v[36:39], v[128:131], v[160:163], v[36:39]
  ds_read_b128 v[188:191], v12 offset:9216
  v_mfma_f32_16x16x32_bf16 v[40:43], v[128:131], v[164:167], v[40:43]
  ds_read_b128 v[192:195], v12 offset:9472
  v_mfma_f32_16x16x32_bf16 v[44:47], v[128:131], v[168:171], v[44:47]
  ds_read_b128 v[196:199], v12 offset:9728
  v_mfma_f32_16x16x32_bf16 v[48:51], v[128:131], v[172:175], v[48:51]
  ds_read_b128 v[200:203], v12 offset:9984
  v_mfma_f32_16x16x32_bf16 v[52:55], v[132:135], v[140:143], v[52:55]
  ds_read_b128 v[204:207], v12 offset:10240
  v_mfma_f32_16x16x32_bf16 v[56:59], v[132:135], v[144:147], v[56:59]
  ds_read_b128 v[208:211], v12 offset:10496
  v_mfma_f32_16x16x32_bf16 v[60:63], v[132:135], v[148:151], v[60:63]
  ds_read_b128 v[212:215], v12 offset:10752
  v_mfma_f32_16x16x32_bf16 v[64:67], v[132:135], v[152:155], v[64:67]
  ds_read_b128 v[216:219], v12 offset:11008
  v_mfma_f32_16x16x32_bf16 v[68:71], v[132:135], v[156:159], v[68:71]
  ds_read_b128 v[220:223], v12 offset:11264
  v_mfma_f32_16x16x32_bf16 v[72:75], v[132:135], v[160:163], v[72:75]
  v_mfma_f32_16x16x32_bf16 v[76:79], v[132:135], v[164:167], v[76:79]
  v_mfma_f32_16x16x32_bf16 v[80:83], v[132:135], v[168:171], v[80:83]
  v_mfma_f32_16x16x32_bf16 v[84:87], v[132:135], v[172:175], v[84:87]
  v_mfma_f32_16x16x32_bf16 v[88:91], v[136:139], v[140:143], v[88:91]
  v_mfma_f32_16x16x32_bf16 v[92:95], v[136:139], v[144:147], v[92:95]
  v_mfma_f32_16x16x32_bf16 v[96:99], v[136:139], v[148:151], v[96:99]
  v_mfma_f32_16x16x32_bf16 v[100:103], v[136:139], v[152:155], v[100:103]
  v_mfma_f32_16x16x32_bf16 v[104:107], v[136:139], v[156:159], v[104:107]
  v_mfma_f32_16x16x32_bf16 v[108:111], v[136:139], v[160:163], v[108:111]
  v_mfma_f32_16x16x32_bf16 v[112:115], v[136:139], v[164:167], v[112:115]
  v_mfma_f32_16x16x32_bf16 v[116:119], v[136:139], v[168:171], v[116:119]
  v_mfma_f32_16x16x32_bf16 v[120:123], v[136:139], v[172:175], v[120:123]
  s_waitcnt lgkmcnt(0)
  s_barrier
  s_lshr_b32 s33, s30, 1
  s_cmp_eq_u32 s33, s57
  s_cbranch_scc1 L_g1own_39
  s_sub_u32 s79, s79, s55
  v_lshlrev_b32 v238, 3, v1
  s_cmp_lg_u32 s55, 0
  s_cbranch_scc1 L_g1s1_40
  s_add_u32 s39, s79, 18432
  s_add_u32 s79, s79, 0
  v_mfma_f32_16x16x32_bf16 v[16:19], v[176:179], v[188:191], v[16:19]
  v_mfma_f32_16x16x32_bf16 v[20:23], v[176:179], v[192:195], v[20:23]
  v_mfma_f32_16x16x32_bf16 v[24:27], v[176:179], v[196:199], v[24:27]
  v_mfma_f32_16x16x32_bf16 v[28:31], v[176:179], v[200:203], v[28:31]
  v_mfma_f32_16x16x32_bf16 v[32:35], v[176:179], v[204:207], v[32:35]
  v_mfma_f32_16x16x32_bf16 v[36:39], v[176:179], v[208:211], v[36:39]
  v_mfma_f32_16x16x32_bf16 v[40:43], v[176:179], v[212:215], v[40:43]
  v_mfma_f32_16x16x32_bf16 v[44:47], v[176:179], v[216:219], v[44:47]
  v_mfma_f32_16x16x32_bf16 v[48:51], v[176:179], v[220:223], v[48:51]
  v_cvt_pk_bf16_f32 v128, v16, v17
  v_cvt_pk_bf16_f32 v129, v18, v19
  v_mfma_f32_16x16x32_bf16 v[52:55], v[180:183], v[188:191], v[52:55]
  v_cvt_pk_bf16_f32 v132, v20, v21
  v_cvt_pk_bf16_f32 v133, v22, v23
  v_mfma_f32_16x16x32_bf16 v[56:59], v[180:183], v[192:195], v[56:59]
  v_cvt_pk_bf16_f32 v136, v24, v25
  v_cvt_pk_bf16_f32 v137, v26, v27
  v_mfma_f32_16x16x32_bf16 v[60:63], v[180:183], v[196:199], v[60:63]
  v_cvt_pk_bf16_f32 v140, v28, v29
  v_cvt_pk_bf16_f32 v141, v30, v31
  v_mfma_f32_16x16x32_bf16 v[64:67], v[180:183], v[200:203], v[64:67]
  v_cvt_pk_bf16_f32 v144, v32, v33
  v_cvt_pk_bf16_f32 v145, v34, v35
  v_mfma_f32_16x16x32_bf16 v[68:71], v[180:183], v[204:207], v[68:71]
  v_cvt_pk_bf16_f32 v148, v36, v37
  v_cvt_pk_bf16_f32 v149, v38, v39
  v_mfma_f32_16x16x32_bf16 v[72:75], v[180:183], v[208:211], v[72:75]
  v_cvt_pk_bf16_f32 v152, v40, v41
  v_cvt_pk_bf16_f32 v153, v42, v43
  v_mfma_f32_16x16x32_bf16 v[76:79], v[180:183], v[212:215], v[76:79]
  v_cvt_pk_bf16_f32 v156, v44, v45
  v_cvt_pk_bf16_f32 v157, v46, v47
  v_mfma_f32_16x16x32_bf16 v[80:83], v[180:183], v[216:219], v[80:83]
  v_cvt_pk_bf16_f32 v160, v48, v49
  v_cvt_pk_bf16_f32 v161, v50, v51
  v_mfma_f32_16x16x32_bf16 v[84:87], v[180:183], v[220:223], v[84:87]
  v_cvt_pk_bf16_f32 v130, v52, v53
  v_cvt_pk_bf16_f32 v131, v54, v55
  buffer_store_dwordx4 v[128:131], v239, s[68:71], s79 offen offset:0 sc1
  v_mfma_f32_16x16x32_bf16 v[88:91], v[184:187], v[188:191], v[88:91]
  v_cvt_pk_bf16_f32 v134, v56, v57
  v_cvt_pk_bf16_f32 v135, v58, v59
  buffer_store_dwordx4 v[132:135], v239, s[68:71], s79 offen offset:1024 sc1
  v_mfma_f32_16x16x32_bf16 v[92:95], v[184:187], v[192:195], v[92:95]
  v_cvt_pk_bf16_f32 v138, v60, v61
  v_cvt_pk_bf16_f32 v139, v62, v63
  buffer_store_dwordx4 v[136:139], v239, s[68:71], s79 offen offset:2048 sc1
  v_mfma_f32_16x16x32_bf16 v[96:99], v[184:187], v[196:199], v[96:99]
  v_cvt_pk_bf16_f32 v142, v64, v65
  v_cvt_pk_bf16_f32 v143, v66, v67
  buffer_store_dwordx4 v[140:143], v239, s[68:71], s79 offen offset:3072 sc1
  v_mfma_f32_16x16x32_bf16 v[100:103], v[184:187], v[200:203], v[100:103]
  v_cvt_pk_bf16_f32 v146, v68, v69
  v_cvt_pk_bf16_f32 v147, v70, v71
  s_add_u32 s79, s79, 4096
  buffer_store_dwordx4 v[144:147], v239, s[68:71], s79 offen offset:0 sc1
  v_mfma_f32_16x16x32_bf16 v[104:107], v[184:187], v[204:207], v[104:107]
  v_cvt_pk_bf16_f32 v150, v72, v73
  v_cvt_pk_bf16_f32 v151, v74, v75
  buffer_store_dwordx4 v[148:151], v239, s[68:71], s79 offen offset:1024 sc1
  v_mfma_f32_16x16x32_bf16 v[108:111], v[184:187], v[208:211], v[108:111]
  v_cvt_pk_bf16_f32 v154, v76, v77
  v_cvt_pk_bf16_f32 v155, v78, v79
  buffer_store_dwordx4 v[152:155], v239, s[68:71], s79 offen offset:2048 sc1
  v_mfma_f32_16x16x32_bf16 v[112:115], v[184:187], v[212:215], v[112:115]
  v_cvt_pk_bf16_f32 v158, v80, v81
  v_cvt_pk_bf16_f32 v159, v82, v83
  buffer_store_dwordx4 v[156:159], v239, s[68:71], s79 offen offset:3072 sc1
  v_mfma_f32_16x16x32_bf16 v[116:119], v[184:187], v[216:219], v[116:119]
  v_cvt_pk_bf16_f32 v162, v84, v85
  v_cvt_pk_bf16_f32 v163, v86, v87
  s_add_u32 s79, s79, 4096
  buffer_store_dwordx4 v[160:163], v239, s[68:71], s79 offen offset:0 sc1
  v_mfma_f32_16x16x32_bf16 v[120:123], v[184:187], v[220:223], v[120:123]
  v_cvt_pk_bf16_f32 v224, v88, v89
  v_cvt_pk_bf16_f32 v225, v90, v91
  buffer_store_dwordx2 v[224:225], v238, s[68:71], s39 offen offset:0 sc1
  s_nop 7
  v_cvt_pk_bf16_f32 v226, v92, v93
  v_cvt_pk_bf16_f32 v227, v94, v95
  buffer_store_dwordx2 v[226:227], v238, s[68:71], s39 offen offset:512 sc1
  v_cvt_pk_bf16_f32 v228, v96, v97
  v_cvt_pk_bf16_f32 v229, v98, v99
  buffer_store_dwordx2 v[228:229], v238, s[68:71], s39 offen offset:1024 sc1
  v_cvt_pk_bf16_f32 v230, v100, v101
  v_cvt_pk_bf16_f32 v231, v102, v103
  buffer_store_dwordx2 v[230:231], v238, s[68:71], s39 offen offset:1536 sc1
  v_cvt_pk_bf16_f32 v232, v104, v105
  v_cvt_pk_bf16_f32 v233, v106, v107
  buffer_store_dwordx2 v[232:233], v238, s[68:71], s39 offen offset:2048 sc1
  v_cvt_pk_bf16_f32 v234, v108, v109
  v_cvt_pk_bf16_f32 v235, v110, v111
  buffer_store_dwordx2 v[234:235], v238, s[68:71], s39 offen offset:2560 sc1
  v_cvt_pk_bf16_f32 v236, v112, v113
  v_cvt_pk_bf16_f32 v237, v114, v115
  buffer_store_dwordx2 v[236:237], v238, s[68:71], s39 offen offset:3072 sc1
  v_cvt_pk_bf16_f32 v124, v116, v117
  v_cvt_pk_bf16_f32 v125, v118, v119
  buffer_store_dwordx2 v[124:125], v238, s[68:71], s39 offen offset:3584 sc1
  v_cvt_pk_bf16_f32 v126, v120, v121
  v_cvt_pk_bf16_f32 v127, v122, v123
  s_add_u32 s39, s39, 4096
  buffer_store_dwordx2 v[126:127], v238, s[68:71], s39 offen offset:0 sc1
  s_branch L_g1sj_41
L_g1s1_40:
  s_add_u32 s39, s79, 23040
  s_add_u32 s79, s79, 9216
  v_mfma_f32_16x16x32_bf16 v[16:19], v[176:179], v[188:191], v[16:19]
  v_mfma_f32_16x16x32_bf16 v[20:23], v[176:179], v[192:195], v[20:23]
  v_mfma_f32_16x16x32_bf16 v[24:27], v[176:179], v[196:199], v[24:27]
  v_mfma_f32_16x16x32_bf16 v[28:31], v[176:179], v[200:203], v[28:31]
  v_mfma_f32_16x16x32_bf16 v[32:35], v[176:179], v[204:207], v[32:35]
  v_mfma_f32_16x16x32_bf16 v[36:39], v[176:179], v[208:211], v[36:39]
  v_mfma_f32_16x16x32_bf16 v[40:43], v[176:179], v[212:215], v[40:43]
  v_mfma_f32_16x16x32_bf16 v[44:47], v[176:179], v[216:219], v[44:47]
  v_mfma_f32_16x16x32_bf16 v[48:51], v[176:179], v[220:223], v[48:51]
  v_cvt_pk_bf16_f32 v224, v16, v17
  v_cvt_pk_bf16_f32 v225, v18, v19
  buffer_store_dwordx2 v[224:225], v238, s[68:71], s39 offen offset:0 sc1
  v_mfma_f32_16x16x32_bf16 v[52:55], v[180:183], v[188:191], v[52:55]
  v_cvt_pk_bf16_f32 v226, v20, v21
  v_cvt_pk_bf16_f32 v227, v22, v23
  buffer_store_dwordx2 v[226:227], v238, s[68:71], s39 offen offset:512 sc1
  v_mfma_f32_16x16x32_bf16 v[56:59], v[180:183], v[192:195], v[56:59]
  v_cvt_pk_bf16_f32 v228, v24, v25
  v_cvt_pk_bf16_f32 v229, v26, v27
  buffer_store_dwordx2 v[228:229], v238, s[68:71], s39 offen offset:1024 sc1
  v_mfma_f32_16x16x32_bf16 v[60:63], v[180:183], v[196:199], v[60:63]
  v_cvt_pk_bf16_f32 v230, v28, v29
  v_cvt_pk_bf16_f32 v231, v30, v31
  buffer_store_dwordx2 v[230:231], v238, s[68:71], s39 offen offset:1536 sc1
  v_mfma_f32_16x16x32_bf16 v[64:67], v[180:183], v[200:203], v[64:67]
  v_cvt_pk_bf16_f32 v232, v32, v33
  v_cvt_pk_bf16_f32 v233, v34, v35
  buffer_store_dwordx2 v[232:233], v238, s[68:71], s39 offen offset:2048 sc1
  v_mfma_f32_16x16x32_bf16 v[68:71], v[180:183], v[204:207], v[68:71]
  v_cvt_pk_bf16_f32 v234, v36, v37
  v_cvt_pk_bf16_f32 v235, v38, v39
  buffer_store_dwordx2 v[234:235], v238, s[68:71], s39 offen offset:2560 sc1
  v_mfma_f32_16x16x32_bf16 v[72:75], v[180:183], v[208:211], v[72:75]
  v_cvt_pk_bf16_f32 v236, v40, v41
  v_cvt_pk_bf16_f32 v237, v42, v43
  buffer_store_dwordx2 v[236:237], v238, s[68:71], s39 offen offset:3072 sc1
  v_mfma_f32_16x16x32_bf16 v[76:79], v[180:183], v[212:215], v[76:79]
  v_cvt_pk_bf16_f32 v124, v44, v45
  v_cvt_pk_bf16_f32 v125, v46, v47
  buffer_store_dwordx2 v[124:125], v238, s[68:71], s39 offen offset:3584 sc1
  v_mfma_f32_16x16x32_bf16 v[80:83], v[180:183], v[216:219], v[80:83]
  v_cvt_pk_bf16_f32 v126, v48, v49
  v_cvt_pk_bf16_f32 v127, v50, v51
  s_add_u32 s39, s39, 4096
  buffer_store_dwordx2 v[126:127], v238, s[68:71], s39 offen offset:0 sc1
  v_mfma_f32_16x16x32_bf16 v[84:87], v[180:183], v[220:223], v[84:87]
  v_cvt_pk_bf16_f32 v128, v52, v53
  v_cvt_pk_bf16_f32 v129, v54, v55
  v_mfma_f32_16x16x32_bf16 v[88:91], v[184:187], v[188:191], v[88:91]
  v_cvt_pk_bf16_f32 v132, v56, v57
  v_cvt_pk_bf16_f32 v133, v58, v59
  v_mfma_f32_16x16x32_bf16 v[92:95], v[184:187], v[192:195], v[92:95]
  v_cvt_pk_bf16_f32 v136, v60, v61
  v_cvt_pk_bf16_f32 v137, v62, v63
  v_mfma_f32_16x16x32_bf16 v[96:99], v[184:187], v[196:199], v[96:99]
  v_cvt_pk_bf16_f32 v140, v64, v65
  v_cvt_pk_bf16_f32 v141, v66, v67
  v_mfma_f32_16x16x32_bf16 v[100:103], v[184:187], v[200:203], v[100:103]
  v_cvt_pk_bf16_f32 v144, v68, v69
  v_cvt_pk_bf16_f32 v145, v70, v71
  v_mfma_f32_16x16x32_bf16 v[104:107], v[184:187], v[204:207], v[104:107]
  v_cvt_pk_bf16_f32 v148, v72, v73
  v_cvt_pk_bf16_f32 v149, v74, v75
  v_mfma_f32_16x16x32_bf16 v[108:111], v[184:187], v[208:211], v[108:111]
  v_cvt_pk_bf16_f32 v152, v76, v77
  v_cvt_pk_bf16_f32 v153, v78, v79
  v_mfma_f32_16x16x32_bf16 v[112:115], v[184:187], v[212:215], v[112:115]
  v_cvt_pk_bf16_f32 v156, v80, v81
  v_cvt_pk_bf16_f32 v157, v82, v83
  v_mfma_f32_16x16x32_bf16 v[116:119], v[184:187], v[216:219], v[116:119]
  v_cvt_pk_bf16_f32 v160, v84, v85
  v_cvt_pk_bf16_f32 v161, v86, v87
  v_mfma_f32_16x16x32_bf16 v[120:123], v[184:187], v[220:223], v[120:123]
  v_cvt_pk_bf16_f32 v130, v88, v89
  v_cvt_pk_bf16_f32 v131, v90, v91
  buffer_store_dwordx4 v[128:131], v239, s[68:71], s79 offen offset:0 sc1
  s_nop 7
  v_cvt_pk_bf16_f32 v134, v92, v93
  v_cvt_pk_bf16_f32 v135, v94, v95
  buffer_store_dwordx4 v[132:135], v239, s[68:71], s79 offen offset:1024 sc1
  v_cvt_pk_bf16_f32 v138, v96, v97
  v_cvt_pk_bf16_f32 v139, v98, v99
  buffer_store_dwordx4 v[136:139], v239, s[68:71], s79 offen offset:2048 sc1
  v_cvt_pk_bf16_f32 v142, v100, v101
  v_cvt_pk_bf16_f32 v143, v102, v103
  buffer_store_dwordx4 v[140:143], v239, s[68:71], s79 offen offset:3072 sc1
  v_cvt_pk_bf16_f32 v146, v104, v105
  v_cvt_pk_bf16_f32 v147, v106, v107
  s_add_u32 s79, s79, 4096
  buffer_store_dwordx4 v[144:147], v239, s[68:71], s79 offen offset:0 sc1
  v_cvt_pk_bf16_f32 v150, v108, v109
  v_cvt_pk_bf16_f32 v151, v110, v111
  buffer_store_dwordx4 v[148:151], v239, s[68:71], s79 offen offset:1024 sc1
  v_cvt_pk_bf16_f32 v154, v112, v113
  v_cvt_pk_bf16_f32 v155, v114, v115
  buffer_store_dwordx4 v[152:155], v239, s[68:71], s79 offen offset:2048 sc1
  v_cvt_pk_bf16_f32 v158, v116, v117
  v_cvt_pk_bf16_f32 v159, v118, v119
  buffer_store_dwordx4 v[156:159], v239, s[68:71], s79 offen offset:3072 sc1
  v_cvt_pk_bf16_f32 v162, v120, v121
  v_cvt_pk_bf16_f32 v163, v122, v123
  s_add_u32 s79, s79, 4096
  buffer_store_dwordx4 v[160:163], v239, s[68:71], s79 offen offset:0 sc1
L_g1sj_41:
  s_barrier
  s_add_u32 s56, s56, 256
  s_lshl_b32 s56, s56, 7
  s_and_b32 s33, s30, 1
  s_lshl_b32 s33, s33, 2
  s_add_u32 s56, s56, s33
  s_waitcnt vmcnt(0)
  v_mov_b32 v3, s56
  v_mov_b32 v4, s98
  s_mov_b64 exec, 1
  buffer_store_dword v4, v3, s[72:75], 0 offen sc1
  s_mov_b64 exec, -1
  s_branch L_g1epi_9
L_g1own_39:
  v_mfma_f32_16x16x32_bf16 v[16:19], v[176:179], v[188:191], v[16:19]
  v_mfma_f32_16x16x32_bf16 v[20:23], v[176:179], v[192:195], v[20:23]
  v_mfma_f32_16x16x32_bf16 v[24:27], v[176:179], v[196:199], v[24:27]
  v_mfma_f32_16x16x32_bf16 v[28:31], v[176:179], v[200:203], v[28:31]
  v_mfma_f32_16x16x32_bf16 v[32:35], v[176:179], v[204:207], v[32:35]
  v_mfma_f32_16x16x32_bf16 v[36:39], v[176:179], v[208:211], v[36:39]
  v_mfma_f32_16x16x32_bf16 v[40:43], v[176:179], v[212:215], v[40:43]
  v_mfma_f32_16x16x32_bf16 v[44:47], v[176:179], v[216:219], v[44:47]
  v_mfma_f32_16x16x32_bf16 v[48:51], v[176:179], v[220:223], v[48:51]
  ds_write_b128 v10, v[16:19] offset:0
  v_mfma_f32_16x16x32_bf16 v[52:55], v[180:183], v[188:191], v[52:55]
  ds_write_b128 v10, v[20:23] offset:1024
  v_mfma_f32_16x16x32_bf16 v[56:59], v[180:183], v[192:195], v[56:59]
  ds_write_b128 v10, v[24:27] offset:2048
  v_mfma_f32_16x16x32_bf16 v[60:63], v[180:183], v[196:199], v[60:63]
  ds_write_b128 v10, v[28:31] offset:3072
  v_mfma_f32_16x16x32_bf16 v[64:67], v[180:183], v[200:203], v[64:67]
  ds_write_b128 v10, v[32:35] offset:4096
  v_mfma_f32_16x16x32_bf16 v[68:71], v[180:183], v[204:207], v[68:71]
  ds_write_b128 v10, v[36:39] offset:5120
  v_mfma_f32_16x16x32_bf16 v[72:75], v[180:183], v[208:211], v[72:75]
  ds_write_b128 v10, v[40:43] offset:6144
  v_mfma_f32_16x16x32_bf16 v[76:79], v[180:183], v[212:215], v[76:79]
  ds_write_b128 v10, v[44:47] offset:7168
  v_mfma_f32_16x16x32_bf16 v[80:83], v[180:183], v[216:219], v[80:83]
  ds_write_b128 v10, v[48:51] offset:8192
  v_mfma_f32_16x16x32_bf16 v[84:87], v[180:183], v[220:223], v[84:87]
  ds_write_b128 v10, v[52:55] offset:9216
  v_mfma_f32_16x16x32_bf16 v[88:91], v[184:187], v[188:191], v[88:91]
  ds_write_b128 v10, v[56:59] offset:10240
  v_mfma_f32_16x16x32_bf16 v[92:95], v[184:187], v[192:195], v[92:95]
  ds_write_b128 v10, v[60:63] offset:11264
  v_mfma_f32_16x16x32_bf16 v[96:99], v[184:187], v[196:199], v[96:99]
  ds_write_b128 v10, v[64:67] offset:12288
  v_mfma_f32_16x16x32_bf16 v[100:103], v[184:187], v[200:203], v[100:103]
  ds_write_b128 v10, v[68:71] offset:13312
  v_mfma_f32_16x16x32_bf16 v[104:107], v[184:187], v[204:207], v[104:107]
  ds_write_b128 v10, v[72:75] offset:14336
  v_mfma_f32_16x16x32_bf16 v[108:111], v[184:187], v[208:211], v[108:111]
  ds_write_b128 v10, v[76:79] offset:15360
  v_mfma_f32_16x16x32_bf16 v[112:115], v[184:187], v[212:215], v[112:115]
  ds_write_b128 v10, v[80:83] offset:16384
  v_mfma_f32_16x16x32_bf16 v[116:119], v[184:187], v[216:219], v[116:119]
  ds_write_b128 v10, v[84:87] offset:17408
  v_mfma_f32_16x16x32_bf16 v[120:123], v[184:187], v[220:223], v[120:123]
  ds_write_b128 v10, v[88:91] offset:18432
  s_nop 7
  ds_write_b128 v10, v[92:95] offset:19456
  ds_write_b128 v10, v[96:99] offset:20480
  ds_write_b128 v10, v[100:103] offset:21504
  ds_write_b128 v10, v[104:107] offset:22528
  ds_write_b128 v10, v[108:111] offset:23552
  ds_write_b128 v10, v[112:115] offset:24576
  ds_write_b128 v10, v[116:119] offset:25600
  ds_write_b128 v10, v[120:123] offset:26624
  s_barrier
  s_waitcnt vmcnt(0) lgkmcnt(0)
L_g1epi_9:
  v_and_b32 v2, 15, v1
  v_lshrrev_b32 v3, 4, v1
  v_mul_u32_u24 v4, 9216, v3
  v_lshl_add_u32 v4, v2, 4, v4
  s_mov_b32 s50, 0xbdd2d3e8
  v_mov_b32 v8, 0xc0135761
  s_mul_i32 s51, s59, 27648
  s_add_u32 s52, s51, 9216
  s_barrier
  s_cmp_ge_u32 s60, 36864
  s_cselect_b32 s33, 27648, 0
  s_sub_u32 s34, s60, s33
  s_add_u32 s35, s34, 8
  s_mov_b32 s37, 4
  s_sub_u32 s36, s60, 18432
  s_cmp_lt_u32 s36, 18432
  s_cbranch_scc0 L_g1x0
  s_lshr_b32 s34, s36, 1
  s_add_u32 s34, s34, 18432
  s_add_u32 s35, s34, 4608
  s_mov_b32 s37, 3
L_g1x0:
  s_add_u32 s34, s34, s51
  s_add_u32 s35, s35, s51
  v_lshlrev_b32 v7, s37, v1
  v_add_u32 v6, s60, v239
  buffer_load_dwordx2 v[24:25], v7, s[68:71], s34 offen sc1
  buffer_load_dwordx2 v[26:27], v7, s[68:71], s35 offen sc1
  ds_read_b128 v[16:19], v6
  ds_read_b128 v[20:23], v6 offset:9216
  s_cmp_ge_u32 s61, 36864
  s_cselect_b32 s33, 27648, 0
  s_sub_u32 s34, s61, s33
  s_add_u32 s35, s34, 8
  s_mov_b32 s37, 4
  s_sub_u32 s36, s61, 18432
  s_cmp_lt_u32 s36, 18432
  s_cbranch_scc0 L_g1x1
  s_lshr_b32 s34, s36, 1
  s_add_u32 s34, s34, 18432
  s_add_u32 s35, s34, 4608
  s_mov_b32 s37, 3
L_g1x1:
  s_add_u32 s34, s34, s51
  s_add_u32 s35, s35, s51
  v_lshlrev_b32 v7, s37, v1
  v_add_u32 v6, s61, v239
  buffer_load_dwordx2 v[40:41], v7, s[68:71], s34 offen sc1
  buffer_load_dwordx2 v[42:43], v7, s[68:71], s35 offen sc1
  ds_read_b128 v[32:35], v6
  ds_read_b128 v[36:39], v6 offset:9216
  s_cmp_ge_u32 s62, 36864
  s_cselect_b32 s33, 27648, 0
  s_sub_u32 s34, s62, s33
  s_add_u32 s35, s34, 8
  s_mov_b32 s37, 4
  s_sub_u32 s36, s62, 18432
  s_cmp_lt_u32 s36, 18432
  s_cbranch_scc0 L_g1x2
  s_lshr_b32 s34, s36, 1
  s_add_u32 s34, s34, 18432
  s_add_u32 s35, s34, 4608
  s_mov_b32 s37, 3
L_g1x2:
  s_add_u32 s34, s34, s51
  s_add_u32 s35, s35, s51
  v_lshlrev_b32 v7, s37, v1
  v_add_u32 v6, s62, v239
  buffer_load_dwordx2 v[56:57], v7, s[68:71], s34 offen sc1
  buffer_load_dwordx2 v[58:59], v7, s[68:71], s35 offen sc1
  ds_read_b128 v[48:51], v6
  ds_read_b128 v[52:55], v6 offset:9216
  s_cmp_ge_u32 s30, 3
  s_cbranch_scc1 L_g1e3_42
  s_cmp_ge_u32 s63, 36864
  s_cselect_b32 s33, 27648, 0
  s_sub_u32 s34, s63, s33
  s_add_u32 s35, s34, 8
  s_mov_b32 s37, 4
  s_sub_u32 s36, s63, 18432
  s_cmp_lt_u32 s36, 18432
  s_cbranch_scc0 L_g1x3
  s_lshr_b32 s34, s36, 1
  s_add_u32 s34, s34, 18432
  s_add_u32 s35, s34, 4608
  s_mov_b32 s37, 3
L_g1x3:
  s_add_u32 s34, s34, s51
  s_add_u32 s35, s35, s51
  v_lshlrev_b32 v7, s37, v1
  v_add_u32 v6, s63, v239
  buffer_load_dwordx2 v[72:73], v7, s[68:71], s34 offen sc1
  buffer_load_dwordx2 v[74:75], v7, s[68:71], s35 offen sc1
  ds_read_b128 v[64:67], v6
  ds_read_b128 v[68:71], v6 offset:9216
  s_waitcnt lgkmcnt(0)
  s_waitcnt vmcnt(6)
  v_lshlrev_b32 v96, 16, v24
  v_and_b32 v97, 0xffff0000, v24
  v_lshlrev_b32 v98, 16, v25
  v_and_b32 v99, 0xffff0000, v25
  v_lshlrev_b32 v100, 16, v26
  v_and_b32 v101, 0xffff0000, v26
  v_lshlrev_b32 v102, 16, v27
  v_and_b32 v103, 0xffff0000, v27
  v_pk_add_f32 v[16:17], v[16:17], v[96:97]
  v_pk_add_f32 v[18:19], v[18:19], v[98:99]
  v_pk_add_f32 v[20:21], v[20:21], v[100:101]
  v_pk_add_f32 v[22:23], v[22:23], v[102:103]
  v_pk_mul_f32 v[24:25], v[16:17], v[16:17]
  v_pk_mul_f32 v[26:27], v[18:19], v[18:19]
  v_pk_mul_f32 v[28:29], v[20:21], v[20:21]
  v_pk_mul_f32 v[30:31], v[22:23], v[22:23]
  v_fma_f32 v24, v24, s50, v8
  v_fma_f32 v25, v25, s50, v8
  v_fma_f32 v26, v26, s50, v8
  v_fma_f32 v27, v27, s50, v8
  v_fma_f32 v28, v28, s50, v8
  v_fma_f32 v29, v29, s50, v8
  v_fma_f32 v30, v30, s50, v8
  v_fma_f32 v31, v31, s50, v8
  v_pk_mul_f32 v[24:25], v[24:25], v[16:17]
  v_pk_mul_f32 v[26:27], v[26:27], v[18:19]
  v_pk_mul_f32 v[28:29], v[28:29], v[20:21]
  v_pk_mul_f32 v[30:31], v[30:31], v[22:23]
  v_exp_f32 v24, v24
  v_exp_f32 v25, v25
  v_exp_f32 v26, v26
  v_exp_f32 v27, v27
  v_exp_f32 v28, v28
  v_exp_f32 v29, v29
  v_exp_f32 v30, v30
  v_exp_f32 v31, v31
  v_add_f32 v24, 1.0, v24
  v_add_f32 v25, 1.0, v25
  v_add_f32 v26, 1.0, v26
  v_add_f32 v27, 1.0, v27
  v_add_f32 v28, 1.0, v28
  v_add_f32 v29, 1.0, v29
  v_add_f32 v30, 1.0, v30
  v_add_f32 v31, 1.0, v31
  v_rcp_f32 v24, v24
  v_rcp_f32 v25, v25
  v_rcp_f32 v26, v26
  v_rcp_f32 v27, v27
  v_rcp_f32 v28, v28
  v_rcp_f32 v29, v29
  v_rcp_f32 v30, v30
  v_rcp_f32 v31, v31
  s_nop 0
  v_pk_mul_f32 v[16:17], v[16:17], v[24:25]
  v_pk_mul_f32 v[18:19], v[18:19], v[26:27]
  v_pk_mul_f32 v[20:21], v[20:21], v[28:29]
  v_pk_mul_f32 v[22:23], v[22:23], v[30:31]
  v_cvt_pk_bf16_f32 v104, v16, v17
  v_cvt_pk_bf16_f32 v105, v18, v19
  v_cvt_pk_bf16_f32 v106, v20, v21
  v_cvt_pk_bf16_f32 v107, v22, v23
  buffer_store_dwordx4 v[104:107], v4, s[20:23], s64 offen sc1
  s_waitcnt vmcnt(5)
  v_lshlrev_b32 v96, 16, v40
  v_and_b32 v97, 0xffff0000, v40
  v_lshlrev_b32 v98, 16, v41
  v_and_b32 v99, 0xffff0000, v41
  v_lshlrev_b32 v100, 16, v42
  v_and_b32 v101, 0xffff0000, v42
  v_lshlrev_b32 v102, 16, v43
  v_and_b32 v103, 0xffff0000, v43
  v_pk_add_f32 v[32:33], v[32:33], v[96:97]
  v_pk_add_f32 v[34:35], v[34:35], v[98:99]
  v_pk_add_f32 v[36:37], v[36:37], v[100:101]
  v_pk_add_f32 v[38:39], v[38:39], v[102:103]
  v_pk_mul_f32 v[40:41], v[32:33], v[32:33]
  v_pk_mul_f32 v[42:43], v[34:35], v[34:35]
  v_pk_mul_f32 v[44:45], v[36:37], v[36:37]
  v_pk_mul_f32 v[46:47], v[38:39], v[38:39]
  v_fma_f32 v40, v40, s50, v8
  v_fma_f32 v41, v41, s50, v8
  v_fma_f32 v42, v42, s50, v8
  v_fma_f32 v43, v43, s50, v8
  v_fma_f32 v44, v44, s50, v8
  v_fma_f32 v45, v45, s50, v8
  v_fma_f32 v46, v46, s50, v8
  v_fma_f32 v47, v47, s50, v8
  v_pk_mul_f32 v[40:41], v[40:41], v[32:33]
  v_pk_mul_f32 v[42:43], v[42:43], v[34:35]
  v_pk_mul_f32 v[44:45], v[44:45], v[36:37]
  v_pk_mul_f32 v[46:47], v[46:47], v[38:39]
  v_exp_f32 v40, v40
  v_exp_f32 v41, v41
  v_exp_f32 v42, v42
  v_exp_f32 v43, v43
  v_exp_f32 v44, v44
  v_exp_f32 v45, v45
  v_exp_f32 v46, v46
  v_exp_f32 v47, v47
  v_add_f32 v40, 1.0, v40
  v_add_f32 v41, 1.0, v41
  v_add_f32 v42, 1.0, v42
  v_add_f32 v43, 1.0, v43
  v_add_f32 v44, 1.0, v44
  v_add_f32 v45, 1.0, v45
  v_add_f32 v46, 1.0, v46
  v_add_f32 v47, 1.0, v47
  v_rcp_f32 v40, v40
  v_rcp_f32 v41, v41
  v_rcp_f32 v42, v42
  v_rcp_f32 v43, v43
  v_rcp_f32 v44, v44
  v_rcp_f32 v45, v45
  v_rcp_f32 v46, v46
  v_rcp_f32 v47, v47
  s_nop 0
  v_pk_mul_f32 v[32:33], v[32:33], v[40:41]
  v_pk_mul_f32 v[34:35], v[34:35], v[42:43]
  v_pk_mul_f32 v[36:37], v[36:37], v[44:45]
  v_pk_mul_f32 v[38:39], v[38:39], v[46:47]
  v_cvt_pk_bf16_f32 v108, v32, v33
  v_cvt_pk_bf16_f32 v109, v34, v35
  v_cvt_pk_bf16_f32 v110, v36, v37
  v_cvt_pk_bf16_f32 v111, v38, v39
  buffer_store_dwordx4 v[108:111], v4, s[20:23], s65 offen sc1
  s_waitcnt vmcnt(4)
  v_lshlrev_b32 v96, 16, v56
  v_and_b32 v97, 0xffff0000, v56
  v_lshlrev_b32 v98, 16, v57
  v_and_b32 v99, 0xffff0000, v57
  v_lshlrev_b32 v100, 16, v58
  v_and_b32 v101, 0xffff0000, v58
  v_lshlrev_b32 v102, 16, v59
  v_and_b32 v103, 0xffff0000, v59
  v_pk_add_f32 v[48:49], v[48:49], v[96:97]
  v_pk_add_f32 v[50:51], v[50:51], v[98:99]
  v_pk_add_f32 v[52:53], v[52:53], v[100:101]
  v_pk_add_f32 v[54:55], v[54:55], v[102:103]
  v_pk_mul_f32 v[56:57], v[48:49], v[48:49]
  v_pk_mul_f32 v[58:59], v[50:51], v[50:51]
  v_pk_mul_f32 v[60:61], v[52:53], v[52:53]
  v_pk_mul_f32 v[62:63], v[54:55], v[54:55]
  v_fma_f32 v56, v56, s50, v8
  v_fma_f32 v57, v57, s50, v8
  v_fma_f32 v58, v58, s50, v8
  v_fma_f32 v59, v59, s50, v8
  v_fma_f32 v60, v60, s50, v8
  v_fma_f32 v61, v61, s50, v8
  v_fma_f32 v62, v62, s50, v8
  v_fma_f32 v63, v63, s50, v8
  v_pk_mul_f32 v[56:57], v[56:57], v[48:49]
  v_pk_mul_f32 v[58:59], v[58:59], v[50:51]
  v_pk_mul_f32 v[60:61], v[60:61], v[52:53]
  v_pk_mul_f32 v[62:63], v[62:63], v[54:55]
  v_exp_f32 v56, v56
  v_exp_f32 v57, v57
  v_exp_f32 v58, v58
  v_exp_f32 v59, v59
  v_exp_f32 v60, v60
  v_exp_f32 v61, v61
  v_exp_f32 v62, v62
  v_exp_f32 v63, v63
  v_add_f32 v56, 1.0, v56
  v_add_f32 v57, 1.0, v57
  v_add_f32 v58, 1.0, v58
  v_add_f32 v59, 1.0, v59
  v_add_f32 v60, 1.0, v60
  v_add_f32 v61, 1.0, v61
  v_add_f32 v62, 1.0, v62
  v_add_f32 v63, 1.0, v63
  v_rcp_f32 v56, v56
  v_rcp_f32 v57, v57
  v_rcp_f32 v58, v58
  v_rcp_f32 v59, v59
  v_rcp_f32 v60, v60
  v_rcp_f32 v61, v61
  v_rcp_f32 v62, v62
  v_rcp_f32 v63, v63
  s_nop 0
  v_pk_mul_f32 v[48:49], v[48:49], v[56:57]
  v_pk_mul_f32 v[50:51], v[50:51], v[58:59]
  v_pk_mul_f32 v[52:53], v[52:53], v[60:61]
  v_pk_mul_f32 v[54:55], v[54:55], v[62:63]
  v_cvt_pk_bf16_f32 v112, v48, v49
  v_cvt_pk_bf16_f32 v113, v50, v51
  v_cvt_pk_bf16_f32 v114, v52, v53
  v_cvt_pk_bf16_f32 v115, v54, v55
  buffer_store_dwordx4 v[112:115], v4, s[20:23], s66 offen sc1
  s_waitcnt vmcnt(3)
  v_lshlrev_b32 v96, 16, v72
  v_and_b32 v97, 0xffff0000, v72
  v_lshlrev_b32 v98, 16, v73
  v_and_b32 v99, 0xffff0000, v73
  v_lshlrev_b32 v100, 16, v74
  v_and_b32 v101, 0xffff0000, v74
  v_lshlrev_b32 v102, 16, v75
  v_and_b32 v103, 0xffff0000, v75
  v_pk_add_f32 v[64:65], v[64:65], v[96:97]
  v_pk_add_f32 v[66:67], v[66:67], v[98:99]
  v_pk_add_f32 v[68:69], v[68:69], v[100:101]
  v_pk_add_f32 v[70:71], v[70:71], v[102:103]
  v_pk_mul_f32 v[72:73], v[64:65], v[64:65]
  v_pk_mul_f32 v[74:75], v[66:67], v[66:67]
  v_pk_mul_f32 v[76:77], v[68:69], v[68:69]
  v_pk_mul_f32 v[78:79], v[70:71], v[70:71]
  v_fma_f32 v72, v72, s50, v8
  v_fma_f32 v73, v73, s50, v8
  v_fma_f32 v74, v74, s50, v8
  v_fma_f32 v75, v75, s50, v8
  v_fma_f32 v76, v76, s50, v8
  v_fma_f32 v77, v77, s50, v8
  v_fma_f32 v78, v78, s50, v8
  v_fma_f32 v79, v79, s50, v8
  v_pk_mul_f32 v[72:73], v[72:73], v[64:65]
  v_pk_mul_f32 v[74:75], v[74:75], v[66:67]
  v_pk_mul_f32 v[76:77], v[76:77], v[68:69]
  v_pk_mul_f32 v[78:79], v[78:79], v[70:71]
  v_exp_f32 v72, v72
  v_exp_f32 v73, v73
  v_exp_f32 v74, v74
  v_exp_f32 v75, v75
  v_exp_f32 v76, v76
  v_exp_f32 v77, v77
  v_exp_f32 v78, v78
  v_exp_f32 v79, v79
  v_add_f32 v72, 1.0, v72
  v_add_f32 v73, 1.0, v73
  v_add_f32 v74, 1.0, v74
  v_add_f32 v75, 1.0, v75
  v_add_f32 v76, 1.0, v76
  v_add_f32 v77, 1.0, v77
  v_add_f32 v78, 1.0, v78
  v_add_f32 v79, 1.0, v79
  v_rcp_f32 v72, v72
  v_rcp_f32 v73, v73
  v_rcp_f32 v74, v74
  v_rcp_f32 v75, v75
  v_rcp_f32 v76, v76
  v_rcp_f32 v77, v77
  v_rcp_f32 v78, v78
  v_rcp_f32 v79, v79
  s_nop 0
  v_pk_mul_f32 v[64:65], v[64:65], v[72:73]
  v_pk_mul_f32 v[66:67], v[66:67], v[74:75]
  v_pk_mul_f32 v[68:69], v[68:69], v[76:77]
  v_pk_mul_f32 v[70:71], v[70:71], v[78:79]
  v_cvt_pk_bf16_f32 v116, v64, v65
  v_cvt_pk_bf16_f32 v117, v66, v67
  v_cvt_pk_bf16_f32 v118, v68, v69
  v_cvt_pk_bf16_f32 v119, v70, v71
  buffer_store_dwordx4 v[116:119], v4, s[20:23], s67 offen sc1
  s_branch L_g1ee_43
L_g1e3_42:
  s_waitcnt lgkmcnt(0)
  s_waitcnt vmcnt(4)
  v_lshlrev_b32 v96, 16, v24
  v_and_b32 v97, 0xffff0000, v24
  v_lshlrev_b32 v98, 16, v25
  v_and_b32 v99, 0xffff0000, v25
  v_lshlrev_b32 v100, 16, v26
  v_and_b32 v101, 0xffff0000, v26
  v_lshlrev_b32 v102, 16, v27
  v_and_b32 v103, 0xffff0000, v27
  v_pk_add_f32 v[16:17], v[16:17], v[96:97]
  v_pk_add_f32 v[18:19], v[18:19], v[98:99]
  v_pk_add_f32 v[20:21], v[20:21], v[100:101]
  v_pk_add_f32 v[22:23], v[22:23], v[102:103]
  v_pk_mul_f32 v[24:25], v[16:17], v[16:17]
  v_pk_mul_f32 v[26:27], v[18:19], v[18:19]
  v_pk_mul_f32 v[28:29], v[20:21], v[20:21]
  v_pk_mul_f32 v[30:31], v[22:23], v[22:23]
  v_fma_f32 v24, v24, s50, v8
  v_fma_f32 v25, v25, s50, v8
  v_fma_f32 v26, v26, s50, v8
  v_fma_f32 v27, v27, s50, v8
  v_fma_f32 v28, v28, s50, v8
  v_fma_f32 v29, v29, s50, v8
  v_fma_f32 v30, v30, s50, v8
  v_fma_f32 v31, v31, s50, v8
  v_pk_mul_f32 v[24:25], v[24:25], v[16:17]
  v_pk_mul_f32 v[26:27], v[26:27], v[18:19]
  v_pk_mul_f32 v[28:29], v[28:29], v[20:21]
  v_pk_mul_f32 v[30:31], v[30:31], v[22:23]
  v_exp_f32 v24, v24
  v_exp_f32 v25, v25
  v_exp_f32 v26, v26
  v_exp_f32 v27, v27
  v_exp_f32 v28, v28
  v_exp_f32 v29, v29
  v_exp_f32 v30, v30
  v_exp_f32 v31, v31
  v_add_f32 v24, 1.0, v24
  v_add_f32 v25, 1.0, v25
  v_add_f32 v26, 1.0, v26
  v_add_f32 v27, 1.0, v27
  v_add_f32 v28, 1.0, v28
  v_add_f32 v29, 1.0, v29
  v_add_f32 v30, 1.0, v30
  v_add_f32 v31, 1.0, v31
  v_rcp_f32 v24, v24
  v_rcp_f32 v25, v25
  v_rcp_f32 v26, v26
  v_rcp_f32 v27, v27
  v_rcp_f32 v28, v28
  v_rcp_f32 v29, v29
  v_rcp_f32 v30, v30
  v_rcp_f32 v31, v31
  s_nop 0
  v_pk_mul_f32 v[16:17], v[16:17], v[24:25]
  v_pk_mul_f32 v[18:19], v[18:19], v[26:27]
  v_pk_mul_f32 v[20:21], v[20:21], v[28:29]
  v_pk_mul_f32 v[22:23], v[22:23], v[30:31]
  v_cvt_pk_bf16_f32 v104, v16, v17
  v_cvt_pk_bf16_f32 v105, v18, v19
  v_cvt_pk_bf16_f32 v106, v20, v21
  v_cvt_pk_bf16_f32 v107, v22, v23
  buffer_store_dwordx4 v[104:107], v4, s[20:23], s64 offen sc1
  s_waitcnt vmcnt(3)
  v_lshlrev_b32 v96, 16, v40
  v_and_b32 v97, 0xffff0000, v40
  v_lshlrev_b32 v98, 16, v41
  v_and_b32 v99, 0xffff0000, v41
  v_lshlrev_b32 v100, 16, v42
  v_and_b32 v101, 0xffff0000, v42
  v_lshlrev_b32 v102, 16, v43
  v_and_b32 v103, 0xffff0000, v43
  v_pk_add_f32 v[32:33], v[32:33], v[96:97]
  v_pk_add_f32 v[34:35], v[34:35], v[98:99]
  v_pk_add_f32 v[36:37], v[36:37], v[100:101]
  v_pk_add_f32 v[38:39], v[38:39], v[102:103]
  v_pk_mul_f32 v[40:41], v[32:33], v[32:33]
  v_pk_mul_f32 v[42:43], v[34:35], v[34:35]
  v_pk_mul_f32 v[44:45], v[36:37], v[36:37]
  v_pk_mul_f32 v[46:47], v[38:39], v[38:39]
  v_fma_f32 v40, v40, s50, v8
  v_fma_f32 v41, v41, s50, v8
  v_fma_f32 v42, v42, s50, v8
  v_fma_f32 v43, v43, s50, v8
  v_fma_f32 v44, v44, s50, v8
  v_fma_f32 v45, v45, s50, v8
  v_fma_f32 v46, v46, s50, v8
  v_fma_f32 v47, v47, s50, v8
  v_pk_mul_f32 v[40:41], v[40:41], v[32:33]
  v_pk_mul_f32 v[42:43], v[42:43], v[34:35]
  v_pk_mul_f32 v[44:45], v[44:45], v[36:37]
  v_pk_mul_f32 v[46:47], v[46:47], v[38:39]
  v_exp_f32 v40, v40
  v_exp_f32 v41, v41
  v_exp_f32 v42, v42
  v_exp_f32 v43, v43
  v_exp_f32 v44, v44
  v_exp_f32 v45, v45
  v_exp_f32 v46, v46
  v_exp_f32 v47, v47
  v_add_f32 v40, 1.0, v40
  v_add_f32 v41, 1.0, v41
  v_add_f32 v42, 1.0, v42
  v_add_f32 v43, 1.0, v43
  v_add_f32 v44, 1.0, v44
  v_add_f32 v45, 1.0, v45
  v_add_f32 v46, 1.0, v46
  v_add_f32 v47, 1.0, v47
  v_rcp_f32 v40, v40
  v_rcp_f32 v41, v41
  v_rcp_f32 v42, v42
  v_rcp_f32 v43, v43
  v_rcp_f32 v44, v44
  v_rcp_f32 v45, v45
  v_rcp_f32 v46, v46
  v_rcp_f32 v47, v47
  s_nop 0
  v_pk_mul_f32 v[32:33], v[32:33], v[40:41]
  v_pk_mul_f32 v[34:35], v[34:35], v[42:43]
  v_pk_mul_f32 v[36:37], v[36:37], v[44:45]
  v_pk_mul_f32 v[38:39], v[38:39], v[46:47]
  v_cvt_pk_bf16_f32 v108, v32, v33
  v_cvt_pk_bf16_f32 v109, v34, v35
  v_cvt_pk_bf16_f32 v110, v36, v37
  v_cvt_pk_bf16_f32 v111, v38, v39
  buffer_store_dwordx4 v[108:111], v4, s[20:23], s65 offen sc1
  s_waitcnt vmcnt(2)
  v_lshlrev_b32 v96, 16, v56
  v_and_b32 v97, 0xffff0000, v56
  v_lshlrev_b32 v98, 16, v57
  v_and_b32 v99, 0xffff0000, v57
  v_lshlrev_b32 v100, 16, v58
  v_and_b32 v101, 0xffff0000, v58
  v_lshlrev_b32 v102, 16, v59
  v_and_b32 v103, 0xffff0000, v59
  v_pk_add_f32 v[48:49], v[48:49], v[96:97]
  v_pk_add_f32 v[50:51], v[50:51], v[98:99]
  v_pk_add_f32 v[52:53], v[52:53], v[100:101]
  v_pk_add_f32 v[54:55], v[54:55], v[102:103]
  v_pk_mul_f32 v[56:57], v[48:49], v[48:49]
  v_pk_mul_f32 v[58:59], v[50:51], v[50:51]
  v_pk_mul_f32 v[60:61], v[52:53], v[52:53]
  v_pk_mul_f32 v[62:63], v[54:55], v[54:55]
  v_fma_f32 v56, v56, s50, v8
  v_fma_f32 v57, v57, s50, v8
  v_fma_f32 v58, v58, s50, v8
  v_fma_f32 v59, v59, s50, v8
  v_fma_f32 v60, v60, s50, v8
  v_fma_f32 v61, v61, s50, v8
  v_fma_f32 v62, v62, s50, v8
  v_fma_f32 v63, v63, s50, v8
  v_pk_mul_f32 v[56:57], v[56:57], v[48:49]
  v_pk_mul_f32 v[58:59], v[58:59], v[50:51]
  v_pk_mul_f32 v[60:61], v[60:61], v[52:53]
  v_pk_mul_f32 v[62:63], v[62:63], v[54:55]
  v_exp_f32 v56, v56
  v_exp_f32 v57, v57
  v_exp_f32 v58, v58
  v_exp_f32 v59, v59
  v_exp_f32 v60, v60
  v_exp_f32 v61, v61
  v_exp_f32 v62, v62
  v_exp_f32 v63, v63
  v_add_f32 v56, 1.0, v56
  v_add_f32 v57, 1.0, v57
  v_add_f32 v58, 1.0, v58
  v_add_f32 v59, 1.0, v59
  v_add_f32 v60, 1.0, v60
  v_add_f32 v61, 1.0, v61
  v_add_f32 v62, 1.0, v62
  v_add_f32 v63, 1.0, v63
  v_rcp_f32 v56, v56
  v_rcp_f32 v57, v57
  v_rcp_f32 v58, v58
  v_rcp_f32 v59, v59
  v_rcp_f32 v60, v60
  v_rcp_f32 v61, v61
  v_rcp_f32 v62, v62
  v_rcp_f32 v63, v63
  s_nop 0
  v_pk_mul_f32 v[48:49], v[48:49], v[56:57]
  v_pk_mul_f32 v[50:51], v[50:51], v[58:59]
  v_pk_mul_f32 v[52:53], v[52:53], v[60:61]
  v_pk_mul_f32 v[54:55], v[54:55], v[62:63]
  v_cvt_pk_bf16_f32 v112, v48, v49
  v_cvt_pk_bf16_f32 v113, v50, v51
  v_cvt_pk_bf16_f32 v114, v52, v53
  v_cvt_pk_bf16_f32 v115, v54, v55
  buffer_store_dwordx4 v[112:115], v4, s[20:23], s66 offen sc1
L_g1ee_43:
  s_add_u32 s33, s58, 480
  s_lshl_b32 s33, s33, 7
  s_lshl_b32 s34, s32, 2
  s_add_u32 s33, s33, s34
  s_waitcnt vmcnt(0)
  s_barrier
  s_cmp_ge_u32 s30, 4
  s_cbranch_scc1 L_g1back_10
  s_cmp_lg_u32 s30, 0
  s_cbranch_scc1 L_g2_3
  v_mov_b32 v3, s33
  v_mov_b32 v4, s98
  s_mov_b64 exec, 1
  buffer_store_dword v4, v3, s[72:75], 0 offen sc1
  s_mov_b64 exec, -1
L_g2_3:
  s_load_dwordx2 s[8:9], s[0:1], 56
  s_load_dwordx2 s[52:53], s[0:1], 64
  s_load_dwordx2 s[4:5], s[0:1], 0
  s_and_b32 s28, s99, 7
  s_lshr_b32 s29, s99, 3
  s_mov_b32 s30, s100
  v_and_b32 v1, 63, v0
  s_sub_u32 s33, s29, 8
  s_mov_b32 s34, 1431655766
  s_mul_hi_u32 s56, s33, s34
  s_mul_i32 s34, s56, 3
  s_sub_u32 s32, s33, s34
  s_and_b32 s34, s28, 1
  s_lshl_b32 s34, s34, 3
  s_add_u32 s31, s56, s34
  s_lshr_b32 s57, s28, 1
  s_waitcnt lgkmcnt(0)
  s_mov_b32 s20, s52
  s_and_b32 s21, s53, 0xffff
  s_mov_b32 s22, 2359296
  s_mov_b32 s23, 0x20000
  s_add_u32 s24, s76, 24969216
  s_addc_u32 s25, s77, 0
  s_and_b32 s25, s25, 0xffff
  s_mov_b32 s26, 9437184
  s_mov_b32 s27, 0x20000
  s_mov_b32 s60, s8
  s_and_b32 s61, s9, 0xffff
  s_mov_b32 s62, 4096
  s_mov_b32 s63, 0x20000
  s_add_u32 s68, s76, 10223616
  s_addc_u32 s69, s77, 0
  s_and_b32 s69, s69, 0xffff
  s_mov_b32 s70, 9437184
  s_mov_b32 s71, 0x20000
  s_mov_b32 s12, s4
  s_and_b32 s13, s5, 0xffff
  s_mov_b32 s14, 2359296
  s_mov_b32 s15, 0x20000
  s_lshr_b32 s33, s57, 1
  s_lshl_b32 s36, s31, 1
  s_add_u32 s36, s36, s33
  s_and_b32 s33, s57, 1
  s_lshl_b32 s37, s32, 1
  s_add_u32 s37, s37, s33
  s_mul_i32 s34, s36, 73728
  s_mul_i32 s35, s37, 192
  s_add_u32 s64, s34, s35
  s_lshr_b32 s34, s30, 2
  s_lshl_b32 s35, s34, 6
  s_add_u32 s64, s64, s35
  s_and_b32 s33, s30, 3
  s_lshl_b32 s65, s36, 2
  s_add_u32 s65, s65, s33
  s_mul_i32 s65, s65, 18
  s_mul_i32 s35, s37, 3
  s_add_u32 s65, s65, s35
  s_add_u32 s65, s65, s34
  s_lshl_b32 s65, s65, 10
  s_lshl_b32 s35, s36, 7
  s_mul_i32 s58, s31, 3
  s_add_u32 s58, s58, s32
  s_lshl_b32 s58, s58, 2
  s_add_u32 s59, s58, s57
  s_mul_i32 s67, s59, 49152
  v_and_b32 v2, 15, v1
  v_lshrrev_b32 v3, 4, v1
  v_and_b32 v4, 1, v3
  v_lshlrev_b32 v4, 5, v4
  v_lshrrev_b32 v3, 1, v3
  v_lshl_add_u32 v4, v3, 4, v4
  s_lshl_b32 s33, s33, 4
  v_add_u32 v2, s33, v2
  v_mul_u32_u24 v5, 1152, v2
  v_add_u32 v240, v5, v4
  buffer_load_dwordx4 v[248:251], v240, s[12:15], s64 offen
  buffer_load_dwordx4 v[252:255], v240, s[12:15], s64 offen offset:128
  v_lshlrev_b32 v243, 4, v1
  v_lshlrev_b32 v241, 4, v1
  s_and_b32 s33, s30, 1
  s_lshr_b32 s34, s30, 1
  v_and_b32 v2, 15, v1
  v_lshrrev_b32 v3, 4, v1
  v_mul_u32_u24 v4, 3072, v3
  v_lshl_add_u32 v4, v2, 4, v4
  s_mul_i32 s35, s33, 1536
  v_add_u32 v6, s35, v4
  v_lshrrev_b32 v5, 2, v2
  v_lshl_add_u32 v4, v3, 2, v5
  v_and_b32 v5, 7, v4
  s_lshl_b32 s35, s34, 2
  v_xor_b32 v5, s35, v5
  v_lshlrev_b32 v4, 8, v4
  v_lshl_add_u32 v4, v5, 5, v4
  v_and_b32 v5, 3, v2
  v_lshl_add_u32 v4, v5, 3, v4
  v_add_u32 v7, 24576, v4
  v_xor_b32 v8, 32, v7
  v_xor_b32 v9, 64, v7
  v_xor_b32 v10, 96, v7
  s_add_u32 s55, s58, s30
  s_lshl_b32 s79, s55, 2
  s_add_u32 s79, s79, s57
  s_mul_i32 s79, s79, 12288
  s_lshl_b32 s35, s31, 8
  s_lshl_b32 s36, s34, 7
  s_add_u32 s35, s35, s36
  s_cmp_eq_u32 s30, s57
  s_cselect_b32 s35, s35, 0x7ff00000
  v_lshlrev_b32 v5, 1, v2
  buffer_load_ushort v192, v5, s[60:63], s35 offen
  buffer_load_ushort v196, v5, s[60:63], s35 offen offset:32
  buffer_load_ushort v200, v5, s[60:63], s35 offen offset:64
  buffer_load_ushort v204, v5, s[60:63], s35 offen offset:96
  s_barrier
  s_mov_b32 s44, 40960
  s_barrier
  v_add_u32 v11, s44, v6
  v_add_u32 v12, s44, v7
  v_add_u32 v13, s44, v8
  v_add_u32 v14, s44, v9
  v_add_u32 v15, s44, v10
  s_add_u32 s44, s44, 40960
  s_cmp_eq_u32 s44, 163840
  s_cselect_b32 s44, 0, s44
  ds_read_b64_tr_b16 v[136:137], v12 offset:0
  ds_read_b64_tr_b16 v[138:139], v12 offset:4096
  ds_read_b64_tr_b16 v[140:141], v13 offset:0
  ds_read_b64_tr_b16 v[142:143], v13 offset:4096
  ds_read_b64_tr_b16 v[144:145], v14 offset:0
  ds_read_b64_tr_b16 v[146:147], v14 offset:4096
  ds_read_b64_tr_b16 v[148:149], v15 offset:0
  ds_read_b64_tr_b16 v[150:151], v15 offset:4096
  ds_read_b128 v[112:115], v11 offset:0
  ds_read_b128 v[116:119], v11 offset:256
  ds_read_b128 v[120:123], v11 offset:512
  ds_read_b128 v[124:127], v11 offset:768
  ds_read_b128 v[128:131], v11 offset:1024
  ds_read_b128 v[132:135], v11 offset:1280
  s_waitcnt vmcnt(0)
  v_lshlrev_b32 v192, 16, v192
  v_mov_b32 v193, v192
  v_mov_b32 v194, v192
  v_mov_b32 v195, v192
  v_lshlrev_b32 v196, 16, v196
  v_mov_b32 v197, v196
  v_mov_b32 v198, v196
  v_mov_b32 v199, v196
  v_lshlrev_b32 v200, 16, v200
  v_mov_b32 v201, v200
  v_mov_b32 v202, v200
  v_mov_b32 v203, v200
  v_lshlrev_b32 v204, 16, v204
  v_mov_b32 v205, v204
  v_mov_b32 v206, v204
  v_mov_b32 v207, v204
  s_waitcnt lgkmcnt(0)
  ds_read_b64_tr_b16 v[176:177], v12 offset:8192
  v_mfma_f32_16x16x32_bf16 v[16:19], v[112:115], v[136:139], v[192:195]
  ds_read_b64_tr_b16 v[178:179], v12 offset:12288
  v_mfma_f32_16x16x32_bf16 v[20:23], v[112:115], v[140:143], v[196:199]
  ds_read_b64_tr_b16 v[180:181], v13 offset:8192
  v_mfma_f32_16x16x32_bf16 v[24:27], v[112:115], v[144:147], v[200:203]
  ds_read_b64_tr_b16 v[182:183], v13 offset:12288
  v_mfma_f32_16x16x32_bf16 v[28:31], v[112:115], v[148:151], v[204:207]
  ds_read_b64_tr_b16 v[184:185], v14 offset:8192
  v_mfma_f32_16x16x32_bf16 v[32:35], v[116:119], v[136:139], v[192:195]
  ds_read_b64_tr_b16 v[186:187], v14 offset:12288
  v_mfma_f32_16x16x32_bf16 v[36:39], v[116:119], v[140:143], v[196:199]
  ds_read_b64_tr_b16 v[188:189], v15 offset:8192
  v_mfma_f32_16x16x32_bf16 v[40:43], v[116:119], v[144:147], v[200:203]
  ds_read_b64_tr_b16 v[190:191], v15 offset:12288
  v_mfma_f32_16x16x32_bf16 v[44:47], v[116:119], v[148:151], v[204:207]
  ds_read_b128 v[152:155], v11 offset:12288
  v_mfma_f32_16x16x32_bf16 v[48:51], v[120:123], v[136:139], v[192:195]
  ds_read_b128 v[156:159], v11 offset:12544
  v_mfma_f32_16x16x32_bf16 v[52:55], v[120:123], v[140:143], v[196:199]
  ds_read_b128 v[160:163], v11 offset:12800
  v_mfma_f32_16x16x32_bf16 v[56:59], v[120:123], v[144:147], v[200:203]
  ds_read_b128 v[164:167], v11 offset:13056
  v_mfma_f32_16x16x32_bf16 v[60:63], v[120:123], v[148:151], v[204:207]
  ds_read_b128 v[168:171], v11 offset:13312
  v_mfma_f32_16x16x32_bf16 v[64:67], v[124:127], v[136:139], v[192:195]
  ds_read_b128 v[172:175], v11 offset:13568
  v_mfma_f32_16x16x32_bf16 v[68:71], v[124:127], v[140:143], v[196:199]
  v_mfma_f32_16x16x32_bf16 v[72:75], v[124:127], v[144:147], v[200:203]
  v_mfma_f32_16x16x32_bf16 v[76:79], v[124:127], v[148:151], v[204:207]
  v_mfma_f32_16x16x32_bf16 v[80:83], v[128:131], v[136:139], v[192:195]
  v_mfma_f32_16x16x32_bf16 v[84:87], v[128:131], v[140:143], v[196:199]
  v_mfma_f32_16x16x32_bf16 v[88:91], v[128:131], v[144:147], v[200:203]
  v_mfma_f32_16x16x32_bf16 v[92:95], v[128:131], v[148:151], v[204:207]
  v_mfma_f32_16x16x32_bf16 v[96:99], v[132:135], v[136:139], v[192:195]
  v_mfma_f32_16x16x32_bf16 v[100:103], v[132:135], v[140:143], v[196:199]
  v_mfma_f32_16x16x32_bf16 v[104:107], v[132:135], v[144:147], v[200:203]
  v_mfma_f32_16x16x32_bf16 v[108:111], v[132:135], v[148:151], v[204:207]
  s_waitcnt lgkmcnt(0)
  s_barrier
  v_add_u32 v11, s44, v6
  v_add_u32 v12, s44, v7
  v_add_u32 v13, s44, v8
  v_add_u32 v14, s44, v9
  v_add_u32 v15, s44, v10
  s_add_u32 s44, s44, 40960
  s_cmp_eq_u32 s44, 163840
  s_cselect_b32 s44, 0, s44
  ds_read_b64_tr_b16 v[136:137], v12 offset:0
  v_mfma_f32_16x16x32_bf16 v[16:19], v[152:155], v[176:179], v[16:19]
  ds_read_b64_tr_b16 v[138:139], v12 offset:4096
  v_mfma_f32_16x16x32_bf16 v[20:23], v[152:155], v[180:183], v[20:23]
  ds_read_b64_tr_b16 v[140:141], v13 offset:0
  v_mfma_f32_16x16x32_bf16 v[24:27], v[152:155], v[184:187], v[24:27]
  ds_read_b64_tr_b16 v[142:143], v13 offset:4096
  v_mfma_f32_16x16x32_bf16 v[28:31], v[152:155], v[188:191], v[28:31]
  ds_read_b64_tr_b16 v[144:145], v14 offset:0
  v_mfma_f32_16x16x32_bf16 v[32:35], v[156:159], v[176:179], v[32:35]
  ds_read_b64_tr_b16 v[146:147], v14 offset:4096
  v_mfma_f32_16x16x32_bf16 v[36:39], v[156:159], v[180:183], v[36:39]
  ds_read_b64_tr_b16 v[148:149], v15 offset:0
  v_mfma_f32_16x16x32_bf16 v[40:43], v[156:159], v[184:187], v[40:43]
  ds_read_b64_tr_b16 v[150:151], v15 offset:4096
  v_mfma_f32_16x16x32_bf16 v[44:47], v[156:159], v[188:191], v[44:47]
  ds_read_b128 v[112:115], v11 offset:0
  v_mfma_f32_16x16x32_bf16 v[48:51], v[160:163], v[176:179], v[48:51]
  ds_read_b128 v[116:119], v11 offset:256
  v_mfma_f32_16x16x32_bf16 v[52:55], v[160:163], v[180:183], v[52:55]
  ds_read_b128 v[120:123], v11 offset:512
  v_mfma_f32_16x16x32_bf16 v[56:59], v[160:163], v[184:187], v[56:59]
  ds_read_b128 v[124:127], v11 offset:768
  v_mfma_f32_16x16x32_bf16 v[60:63], v[160:163], v[188:191], v[60:63]
  ds_read_b128 v[128:131], v11 offset:1024
  v_mfma_f32_16x16x32_bf16 v[64:67], v[164:167], v[176:179], v[64:67]
  ds_read_b128 v[132:135], v11 offset:1280
  v_mfma_f32_16x16x32_bf16 v[68:71], v[164:167], v[180:183], v[68:71]
  v_mfma_f32_16x16x32_bf16 v[72:75], v[164:167], v[184:187], v[72:75]
  v_mfma_f32_16x16x32_bf16 v[76:79], v[164:167], v[188:191], v[76:79]
  v_mfma_f32_16x16x32_bf16 v[80:83], v[168:171], v[176:179], v[80:83]
  v_mfma_f32_16x16x32_bf16 v[84:87], v[168:171], v[180:183], v[84:87]
  v_mfma_f32_16x16x32_bf16 v[88:91], v[168:171], v[184:187], v[88:91]
  v_mfma_f32_16x16x32_bf16 v[92:95], v[168:171], v[188:191], v[92:95]
  v_mfma_f32_16x16x32_bf16 v[96:99], v[172:175], v[176:179], v[96:99]
  v_mfma_f32_16x16x32_bf16 v[100:103], v[172:175], v[180:183], v[100:103]
  v_mfma_f32_16x16x32_bf16 v[104:107], v[172:175], v[184:187], v[104:107]
  v_mfma_f32_16x16x32_bf16 v[108:111], v[172:175], v[188:191], v[108:111]
  s_waitcnt lgkmcnt(0)
  s_mov_b32 s47, 0
L_g2_c2_44:
  ds_read_b64_tr_b16 v[176:177], v12 offset:8192
  v_mfma_f32_16x16x32_bf16 v[16:19], v[112:115], v[136:139], v[16:19]
  ds_read_b64_tr_b16 v[178:179], v12 offset:12288
  v_mfma_f32_16x16x32_bf16 v[20:23], v[112:115], v[140:143], v[20:23]
  ds_read_b64_tr_b16 v[180:181], v13 offset:8192
  v_mfma_f32_16x16x32_bf16 v[24:27], v[112:115], v[144:147], v[24:27]
  ds_read_b64_tr_b16 v[182:183], v13 offset:12288
  v_mfma_f32_16x16x32_bf16 v[28:31], v[112:115], v[148:151], v[28:31]
  ds_read_b64_tr_b16 v[184:185], v14 offset:8192
  v_mfma_f32_16x16x32_bf16 v[32:35], v[116:119], v[136:139], v[32:35]
  ds_read_b64_tr_b16 v[186:187], v14 offset:12288
  v_mfma_f32_16x16x32_bf16 v[36:39], v[116:119], v[140:143], v[36:39]
  ds_read_b64_tr_b16 v[188:189], v15 offset:8192
  v_mfma_f32_16x16x32_bf16 v[40:43], v[116:119], v[144:147], v[40:43]
  ds_read_b64_tr_b16 v[190:191], v15 offset:12288
  v_mfma_f32_16x16x32_bf16 v[44:47], v[116:119], v[148:151], v[44:47]
  ds_read_b128 v[152:155], v11 offset:12288
  v_mfma_f32_16x16x32_bf16 v[48:51], v[120:123], v[136:139], v[48:51]
  ds_read_b128 v[156:159], v11 offset:12544
  v_mfma_f32_16x16x32_bf16 v[52:55], v[120:123], v[140:143], v[52:55]
  ds_read_b128 v[160:163], v11 offset:12800
  v_mfma_f32_16x16x32_bf16 v[56:59], v[120:123], v[144:147], v[56:59]
  ds_read_b128 v[164:167], v11 offset:13056
  v_mfma_f32_16x16x32_bf16 v[60:63], v[120:123], v[148:151], v[60:63]
  ds_read_b128 v[168:171], v11 offset:13312
  v_mfma_f32_16x16x32_bf16 v[64:67], v[124:127], v[136:139], v[64:67]
  ds_read_b128 v[172:175], v11 offset:13568
  v_mfma_f32_16x16x32_bf16 v[68:71], v[124:127], v[140:143], v[68:71]
  v_mfma_f32_16x16x32_bf16 v[72:75], v[124:127], v[144:147], v[72:75]
  v_mfma_f32_16x16x32_bf16 v[76:79], v[124:127], v[148:151], v[76:79]
  v_mfma_f32_16x16x32_bf16 v[80:83], v[128:131], v[136:139], v[80:83]
  v_mfma_f32_16x16x32_bf16 v[84:87], v[128:131], v[140:143], v[84:87]
  v_mfma_f32_16x16x32_bf16 v[88:91], v[128:131], v[144:147], v[88:91]
  v_mfma_f32_16x16x32_bf16 v[92:95], v[128:131], v[148:151], v[92:95]
  v_mfma_f32_16x16x32_bf16 v[96:99], v[132:135], v[136:139], v[96:99]
  v_mfma_f32_16x16x32_bf16 v[100:103], v[132:135], v[140:143], v[100:103]
  v_mfma_f32_16x16x32_bf16 v[104:107], v[132:135], v[144:147], v[104:107]
  v_mfma_f32_16x16x32_bf16 v[108:111], v[132:135], v[148:151], v[108:111]
  s_waitcnt lgkmcnt(0)
  s_barrier
  v_add_u32 v11, s44, v6
  v_add_u32 v12, s44, v7
  v_add_u32 v13, s44, v8
  v_add_u32 v14, s44, v9
  v_add_u32 v15, s44, v10
  s_add_u32 s44, s44, 40960
  s_cmp_eq_u32 s44, 163840
  s_cselect_b32 s44, 0, s44
  ds_read_b64_tr_b16 v[136:137], v12 offset:0
  v_mfma_f32_16x16x32_bf16 v[16:19], v[152:155], v[176:179], v[16:19]
  ds_read_b64_tr_b16 v[138:139], v12 offset:4096
  v_mfma_f32_16x16x32_bf16 v[20:23], v[152:155], v[180:183], v[20:23]
  ds_read_b64_tr_b16 v[140:141], v13 offset:0
  v_mfma_f32_16x16x32_bf16 v[24:27], v[152:155], v[184:187], v[24:27]
  ds_read_b64_tr_b16 v[142:143], v13 offset:4096
  v_mfma_f32_16x16x32_bf16 v[28:31], v[152:155], v[188:191], v[28:31]
  ds_read_b64_tr_b16 v[144:145], v14 offset:0
  v_mfma_f32_16x16x32_bf16 v[32:35], v[156:159], v[176:179], v[32:35]
  ds_read_b64_tr_b16 v[146:147], v14 offset:4096
  v_mfma_f32_16x16x32_bf16 v[36:39], v[156:159], v[180:183], v[36:39]
  ds_read_b64_tr_b16 v[148:149], v15 offset:0
  v_mfma_f32_16x16x32_bf16 v[40:43], v[156:159], v[184:187], v[40:43]
  ds_read_b64_tr_b16 v[150:151], v15 offset:4096
  v_mfma_f32_16x16x32_bf16 v[44:47], v[156:159], v[188:191], v[44:47]
  ds_read_b128 v[112:115], v11 offset:0
  v_mfma_f32_16x16x32_bf16 v[48:51], v[160:163], v[176:179], v[48:51]
  ds_read_b128 v[116:119], v11 offset:256
  v_mfma_f32_16x16x32_bf16 v[52:55], v[160:163], v[180:183], v[52:55]
  ds_read_b128 v[120:123], v11 offset:512
  v_mfma_f32_16x16x32_bf16 v[56:59], v[160:163], v[184:187], v[56:59]
  ds_read_b128 v[124:127], v11 offset:768
  v_mfma_f32_16x16x32_bf16 v[60:63], v[160:163], v[188:191], v[60:63]
  ds_read_b128 v[128:131], v11 offset:1024
  v_mfma_f32_16x16x32_bf16 v[64:67], v[164:167], v[176:179], v[64:67]
  ds_read_b128 v[132:135], v11 offset:1280
  v_mfma_f32_16x16x32_bf16 v[68:71], v[164:167], v[180:183], v[68:71]
  v_mfma_f32_16x16x32_bf16 v[72:75], v[164:167], v[184:187], v[72:75]
  v_mfma_f32_16x16x32_bf16 v[76:79], v[164:167], v[188:191], v[76:79]
  v_mfma_f32_16x16x32_bf16 v[80:83], v[168:171], v[176:179], v[80:83]
  v_mfma_f32_16x16x32_bf16 v[84:87], v[168:171], v[180:183], v[84:87]
  v_mfma_f32_16x16x32_bf16 v[88:91], v[168:171], v[184:187], v[88:91]
  v_mfma_f32_16x16x32_bf16 v[92:95], v[168:171], v[188:191], v[92:95]
  v_mfma_f32_16x16x32_bf16 v[96:99], v[172:175], v[176:179], v[96:99]
  v_mfma_f32_16x16x32_bf16 v[100:103], v[172:175], v[180:183], v[100:103]
  v_mfma_f32_16x16x32_bf16 v[104:107], v[172:175], v[184:187], v[104:107]
  v_mfma_f32_16x16x32_bf16 v[108:111], v[172:175], v[188:191], v[108:111]
  s_waitcnt lgkmcnt(0)
  s_add_u32 s47, s47, 1
  s_cmp_lt_u32 s47, 16
  s_cbranch_scc1 L_g2_c2_44
  ds_read_b64_tr_b16 v[176:177], v12 offset:8192
  v_mfma_f32_16x16x32_bf16 v[16:19], v[112:115], v[136:139], v[16:19]
  ds_read_b64_tr_b16 v[178:179], v12 offset:12288
  v_mfma_f32_16x16x32_bf16 v[20:23], v[112:115], v[140:143], v[20:23]
  ds_read_b64_tr_b16 v[180:181], v13 offset:8192
  v_mfma_f32_16x16x32_bf16 v[24:27], v[112:115], v[144:147], v[24:27]
  ds_read_b64_tr_b16 v[182:183], v13 offset:12288
  v_mfma_f32_16x16x32_bf16 v[28:31], v[112:115], v[148:151], v[28:31]
  ds_read_b64_tr_b16 v[184:185], v14 offset:8192
  v_mfma_f32_16x16x32_bf16 v[32:35], v[116:119], v[136:139], v[32:35]
  ds_read_b64_tr_b16 v[186:187], v14 offset:12288
  v_mfma_f32_16x16x32_bf16 v[36:39], v[116:119], v[140:143], v[36:39]
  ds_read_b64_tr_b16 v[188:189], v15 offset:8192
  v_mfma_f32_16x16x32_bf16 v[40:43], v[116:119], v[144:147], v[40:43]
  ds_read_b64_tr_b16 v[190:191], v15 offset:12288
  v_mfma_f32_16x16x32_bf16 v[44:47], v[116:119], v[148:151], v[44:47]
  ds_read_b128 v[152:155], v11 offset:12288
  v_mfma_f32_16x16x32_bf16 v[48:51], v[120:123], v[136:139], v[48:51]
  ds_read_b128 v[156:159], v11 offset:12544
  v_mfma_f32_16x16x32_bf16 v[52:55], v[120:123], v[140:143], v[52:55]
  ds_read_b128 v[160:163], v11 offset:12800
  v_mfma_f32_16x16x32_bf16 v[56:59], v[120:123], v[144:147], v[56:59]
  ds_read_b128 v[164:167], v11 offset:13056
  v_mfma_f32_16x16x32_bf16 v[60:63], v[120:123], v[148:151], v[60:63]
  ds_read_b128 v[168:171], v11 offset:13312
  v_mfma_f32_16x16x32_bf16 v[64:67], v[124:127], v[136:139], v[64:67]
  ds_read_b128 v[172:175], v11 offset:13568
  v_mfma_f32_16x16x32_bf16 v[68:71], v[124:127], v[140:143], v[68:71]
  v_mfma_f32_16x16x32_bf16 v[72:75], v[124:127], v[144:147], v[72:75]
  v_mfma_f32_16x16x32_bf16 v[76:79], v[124:127], v[148:151], v[76:79]
  v_mfma_f32_16x16x32_bf16 v[80:83], v[128:131], v[136:139], v[80:83]
  v_mfma_f32_16x16x32_bf16 v[84:87], v[128:131], v[140:143], v[84:87]
  v_mfma_f32_16x16x32_bf16 v[88:91], v[128:131], v[144:147], v[88:91]
  v_mfma_f32_16x16x32_bf16 v[92:95], v[128:131], v[148:151], v[92:95]
  v_mfma_f32_16x16x32_bf16 v[96:99], v[132:135], v[136:139], v[96:99]
  v_mfma_f32_16x16x32_bf16 v[100:103], v[132:135], v[140:143], v[100:103]
  v_mfma_f32_16x16x32_bf16 v[104:107], v[132:135], v[144:147], v[104:107]
  v_mfma_f32_16x16x32_bf16 v[108:111], v[132:135], v[148:151], v[108:111]
  s_waitcnt lgkmcnt(0)
  s_barrier
  s_cmp_eq_u32 s30, s57
  s_cbranch_scc1 L_g2own_45
  v_mfma_f32_16x16x32_bf16 v[16:19], v[152:155], v[176:179], v[16:19]
  v_mfma_f32_16x16x32_bf16 v[20:23], v[152:155], v[180:183], v[20:23]
  v_mfma_f32_16x16x32_bf16 v[24:27], v[152:155], v[184:187], v[24:27]
  v_mfma_f32_16x16x32_bf16 v[28:31], v[152:155], v[188:191], v[28:31]
  v_mfma_f32_16x16x32_bf16 v[32:35], v[156:159], v[176:179], v[32:35]
  v_mfma_f32_16x16x32_bf16 v[36:39], v[156:159], v[180:183], v[36:39]
  v_mfma_f32_16x16x32_bf16 v[40:43], v[156:159], v[184:187], v[40:43]
  v_mfma_f32_16x16x32_bf16 v[44:47], v[156:159], v[188:191], v[44:47]
  v_mfma_f32_16x16x32_bf16 v[48:51], v[160:163], v[176:179], v[48:51]
  v_cvt_pk_bf16_f32 v192, v16, v17
  v_cvt_pk_bf16_f32 v193, v18, v19
  v_mfma_f32_16x16x32_bf16 v[52:55], v[160:163], v[180:183], v[52:55]
  v_cvt_pk_bf16_f32 v196, v20, v21
  v_cvt_pk_bf16_f32 v197, v22, v23
  v_mfma_f32_16x16x32_bf16 v[56:59], v[160:163], v[184:187], v[56:59]
  v_cvt_pk_bf16_f32 v200, v24, v25
  v_cvt_pk_bf16_f32 v201, v26, v27
  v_mfma_f32_16x16x32_bf16 v[60:63], v[160:163], v[188:191], v[60:63]
  v_cvt_pk_bf16_f32 v204, v28, v29
  v_cvt_pk_bf16_f32 v205, v30, v31
  v_mfma_f32_16x16x32_bf16 v[64:67], v[164:167], v[176:179], v[64:67]
  v_cvt_pk_bf16_f32 v194, v32, v33
  v_cvt_pk_bf16_f32 v195, v34, v35
  buffer_store_dwordx4 v[192:195], v243, s[68:71], s79 offen offset:0 sc1
  v_mfma_f32_16x16x32_bf16 v[68:71], v[164:167], v[180:183], v[68:71]
  v_cvt_pk_bf16_f32 v198, v36, v37
  v_cvt_pk_bf16_f32 v199, v38, v39
  buffer_store_dwordx4 v[196:199], v243, s[68:71], s79 offen offset:1024 sc1
  v_mfma_f32_16x16x32_bf16 v[72:75], v[164:167], v[184:187], v[72:75]
  v_cvt_pk_bf16_f32 v202, v40, v41
  v_cvt_pk_bf16_f32 v203, v42, v43
  buffer_store_dwordx4 v[200:203], v243, s[68:71], s79 offen offset:2048 sc1
  v_mfma_f32_16x16x32_bf16 v[76:79], v[164:167], v[188:191], v[76:79]
  v_cvt_pk_bf16_f32 v206, v44, v45
  v_cvt_pk_bf16_f32 v207, v46, v47
  buffer_store_dwordx4 v[204:207], v243, s[68:71], s79 offen offset:3072 sc1
  v_mfma_f32_16x16x32_bf16 v[80:83], v[168:171], v[176:179], v[80:83]
  v_cvt_pk_bf16_f32 v208, v48, v49
  v_cvt_pk_bf16_f32 v209, v50, v51
  v_mfma_f32_16x16x32_bf16 v[84:87], v[168:171], v[180:183], v[84:87]
  v_cvt_pk_bf16_f32 v212, v52, v53
  v_cvt_pk_bf16_f32 v213, v54, v55
  v_mfma_f32_16x16x32_bf16 v[88:91], v[168:171], v[184:187], v[88:91]
  v_cvt_pk_bf16_f32 v216, v56, v57
  v_cvt_pk_bf16_f32 v217, v58, v59
  v_mfma_f32_16x16x32_bf16 v[92:95], v[168:171], v[188:191], v[92:95]
  v_cvt_pk_bf16_f32 v220, v60, v61
  v_cvt_pk_bf16_f32 v221, v62, v63
  v_mfma_f32_16x16x32_bf16 v[96:99], v[172:175], v[176:179], v[96:99]
  v_cvt_pk_bf16_f32 v210, v64, v65
  v_cvt_pk_bf16_f32 v211, v66, v67
  s_add_u32 s79, s79, 4096
  buffer_store_dwordx4 v[208:211], v243, s[68:71], s79 offen offset:0 sc1
  v_mfma_f32_16x16x32_bf16 v[100:103], v[172:175], v[180:183], v[100:103]
  v_cvt_pk_bf16_f32 v214, v68, v69
  v_cvt_pk_bf16_f32 v215, v70, v71
  buffer_store_dwordx4 v[212:215], v243, s[68:71], s79 offen offset:1024 sc1
  v_mfma_f32_16x16x32_bf16 v[104:107], v[172:175], v[184:187], v[104:107]
  v_cvt_pk_bf16_f32 v218, v72, v73
  v_cvt_pk_bf16_f32 v219, v74, v75
  buffer_store_dwordx4 v[216:219], v243, s[68:71], s79 offen offset:2048 sc1
  v_mfma_f32_16x16x32_bf16 v[108:111], v[172:175], v[188:191], v[108:111]
  v_cvt_pk_bf16_f32 v222, v76, v77
  v_cvt_pk_bf16_f32 v223, v78, v79
  buffer_store_dwordx4 v[220:223], v243, s[68:71], s79 offen offset:3072 sc1
  s_nop 7
  v_cvt_pk_bf16_f32 v224, v80, v81
  v_cvt_pk_bf16_f32 v225, v82, v83
  v_cvt_pk_bf16_f32 v228, v84, v85
  v_cvt_pk_bf16_f32 v229, v86, v87
  v_cvt_pk_bf16_f32 v232, v88, v89
  v_cvt_pk_bf16_f32 v233, v90, v91
  v_cvt_pk_bf16_f32 v236, v92, v93
  v_cvt_pk_bf16_f32 v237, v94, v95
  v_cvt_pk_bf16_f32 v226, v96, v97
  v_cvt_pk_bf16_f32 v227, v98, v99
  s_add_u32 s79, s79, 4096
  buffer_store_dwordx4 v[224:227], v243, s[68:71], s79 offen offset:0 sc1
  v_cvt_pk_bf16_f32 v230, v100, v101
  v_cvt_pk_bf16_f32 v231, v102, v103
  buffer_store_dwordx4 v[228:231], v243, s[68:71], s79 offen offset:1024 sc1
  v_cvt_pk_bf16_f32 v234, v104, v105
  v_cvt_pk_bf16_f32 v235, v106, v107
  buffer_store_dwordx4 v[232:235], v243, s[68:71], s79 offen offset:2048 sc1
  v_cvt_pk_bf16_f32 v238, v108, v109
  v_cvt_pk_bf16_f32 v239, v110, v111
  buffer_store_dwordx4 v[236:239], v243, s[68:71], s79 offen offset:3072 sc1
  s_add_u32 s55, s55, 64
  s_lshl_b32 s55, s55, 7
  s_lshl_b32 s33, s57, 2
  s_add_u32 s55, s55, s33
  s_barrier
  s_add_u32 s66, s65, 2359296
  s_add_u32 s2, s66, 2359296
  s_add_u32 s3, s2, 2359296
  buffer_load_dwordx4 v[112:115], v241, s[24:27], s65 offen offset:0 sc1
  buffer_load_dwordx4 v[116:119], v241, s[24:27], s66 offen offset:0 sc1
  buffer_load_dwordx4 v[120:123], v241, s[24:27], s2 offen offset:0 sc1
  buffer_load_dwordx4 v[124:127], v241, s[24:27], s3 offen offset:0 sc1
  buffer_load_dwordx4 v[128:131], v241, s[24:27], s65 offen offset:2048 sc1
  buffer_load_dwordx4 v[132:135], v241, s[24:27], s66 offen offset:2048 sc1
  buffer_load_dwordx4 v[136:139], v241, s[24:27], s2 offen offset:2048 sc1
  buffer_load_dwordx4 v[140:143], v241, s[24:27], s3 offen offset:2048 sc1
  s_waitcnt vmcnt(8)
  v_mov_b32 v3, s55
  v_mov_b32 v4, s98
  s_mov_b64 exec, 1
  buffer_store_dword v4, v3, s[72:75], 0 offen sc1
  s_mov_b64 exec, -1
  s_branch L_g2epi_28
L_g2own_45:
  v_mfma_f32_16x16x32_bf16 v[16:19], v[152:155], v[176:179], v[16:19]
  v_mfma_f32_16x16x32_bf16 v[20:23], v[152:155], v[180:183], v[20:23]
  v_mfma_f32_16x16x32_bf16 v[24:27], v[152:155], v[184:187], v[24:27]
  v_mfma_f32_16x16x32_bf16 v[28:31], v[152:155], v[188:191], v[28:31]
  v_mfma_f32_16x16x32_bf16 v[32:35], v[156:159], v[176:179], v[32:35]
  v_mfma_f32_16x16x32_bf16 v[36:39], v[156:159], v[180:183], v[36:39]
  v_mfma_f32_16x16x32_bf16 v[40:43], v[156:159], v[184:187], v[40:43]
  v_mfma_f32_16x16x32_bf16 v[44:47], v[156:159], v[188:191], v[44:47]
  v_mfma_f32_16x16x32_bf16 v[48:51], v[160:163], v[176:179], v[48:51]
  ds_write_b128 v243, v[16:19] offset:0
  v_mfma_f32_16x16x32_bf16 v[52:55], v[160:163], v[180:183], v[52:55]
  ds_write_b128 v243, v[20:23] offset:1024
  v_mfma_f32_16x16x32_bf16 v[56:59], v[160:163], v[184:187], v[56:59]
  ds_write_b128 v243, v[24:27] offset:2048
  v_mfma_f32_16x16x32_bf16 v[60:63], v[160:163], v[188:191], v[60:63]
  ds_write_b128 v243, v[28:31] offset:3072
  v_mfma_f32_16x16x32_bf16 v[64:67], v[164:167], v[176:179], v[64:67]
  ds_write_b128 v243, v[32:35] offset:4096
  v_mfma_f32_16x16x32_bf16 v[68:71], v[164:167], v[180:183], v[68:71]
  ds_write_b128 v243, v[36:39] offset:5120
  v_mfma_f32_16x16x32_bf16 v[72:75], v[164:167], v[184:187], v[72:75]
  ds_write_b128 v243, v[40:43] offset:6144
  v_mfma_f32_16x16x32_bf16 v[76:79], v[164:167], v[188:191], v[76:79]
  ds_write_b128 v243, v[44:47] offset:7168
  v_mfma_f32_16x16x32_bf16 v[80:83], v[168:171], v[176:179], v[80:83]
  ds_write_b128 v243, v[48:51] offset:8192
  v_mfma_f32_16x16x32_bf16 v[84:87], v[168:171], v[180:183], v[84:87]
  ds_write_b128 v243, v[52:55] offset:9216
  v_mfma_f32_16x16x32_bf16 v[88:91], v[168:171], v[184:187], v[88:91]
  ds_write_b128 v243, v[56:59] offset:10240
  v_mfma_f32_16x16x32_bf16 v[92:95], v[168:171], v[188:191], v[92:95]
  ds_write_b128 v243, v[60:63] offset:11264
  v_mfma_f32_16x16x32_bf16 v[96:99], v[172:175], v[176:179], v[96:99]
  ds_write_b128 v243, v[64:67] offset:12288
  v_mfma_f32_16x16x32_bf16 v[100:103], v[172:175], v[180:183], v[100:103]
  ds_write_b128 v243, v[68:71] offset:13312
  v_mfma_f32_16x16x32_bf16 v[104:107], v[172:175], v[184:187], v[104:107]
  ds_write_b128 v243, v[72:75] offset:14336
  v_mfma_f32_16x16x32_bf16 v[108:111], v[172:175], v[188:191], v[108:111]
  ds_write_b128 v243, v[76:79] offset:15360
  s_nop 7
  ds_write_b128 v243, v[80:83] offset:16384
  ds_write_b128 v243, v[84:87] offset:17408
  ds_write_b128 v243, v[88:91] offset:18432
  ds_write_b128 v243, v[92:95] offset:19456
  ds_write_b128 v243, v[96:99] offset:20480
  ds_write_b128 v243, v[100:103] offset:21504
  ds_write_b128 v243, v[104:107] offset:22528
  ds_write_b128 v243, v[108:111] offset:23552
  s_barrier
  s_add_u32 s66, s65, 2359296
  s_add_u32 s2, s66, 2359296
  s_add_u32 s3, s2, 2359296
  buffer_load_dwordx4 v[112:115], v241, s[24:27], s65 offen offset:0 sc1
  buffer_load_dwordx4 v[116:119], v241, s[24:27], s66 offen offset:0 sc1
  buffer_load_dwordx4 v[120:123], v241, s[24:27], s2 offen offset:0 sc1
  buffer_load_dwordx4 v[124:127], v241, s[24:27], s3 offen offset:0 sc1
  buffer_load_dwordx4 v[128:131], v241, s[24:27], s65 offen offset:2048 sc1
  buffer_load_dwordx4 v[132:135], v241, s[24:27], s66 offen offset:2048 sc1
  buffer_load_dwordx4 v[136:139], v241, s[24:27], s2 offen offset:2048 sc1
  buffer_load_dwordx4 v[140:143], v241, s[24:27], s3 offen offset:2048 sc1
  s_waitcnt lgkmcnt(0)
L_g2epi_28:
  s_add_u32 s33, s57, 1
  s_and_b32 s33, s33, 3
  s_mul_i32 s36, s33, 12288
  s_add_u32 s33, s57, 2
  s_and_b32 s33, s33, 3
  s_mul_i32 s37, s33, 12288
  s_add_u32 s33, s57, 3
  s_and_b32 s33, s33, 3
  s_mul_i32 s38, s33, 12288
  s_and_b32 s33, s30, 3
  s_lshl_b32 s33, s33, 10
  s_lshr_b32 s34, s30, 2
  s_lshl_b32 s35, s34, 13
  s_lshr_b32 s39, s35, 1
  s_add_u32 s39, s39, s33
  v_add_u32 v246, s39, v243
  s_add_u32 s33, s33, s35
  v_add_u32 v243, s33, v243
  s_add_u32 s36, s36, s67
  s_add_u32 s37, s37, s67
  s_add_u32 s38, s38, s67
  s_barrier
  buffer_load_dwordx4 v[24:27], v246, s[68:71], s36 offen sc1
  buffer_load_dwordx4 v[28:31], v246, s[68:71], s37 offen sc1
  buffer_load_dwordx4 v[32:35], v246, s[68:71], s38 offen sc1
  ds_read_b128 v[16:19], v243
  ds_read_b128 v[20:23], v243 offset:4096
  s_cmp_ge_u32 s30, 4
  s_cbranch_scc1 L_g2hi2_46
  v_add_u32 v244, 16384, v243
  s_add_u32 s36, s36, 8192
  buffer_load_dwordx4 v[72:75], v246, s[68:71], s36 offen sc1
  s_add_u32 s37, s37, 8192
  buffer_load_dwordx4 v[76:79], v246, s[68:71], s37 offen sc1
  s_add_u32 s38, s38, 8192
  buffer_load_dwordx4 v[80:83], v246, s[68:71], s38 offen sc1
  ds_read_b128 v[64:67], v244
  ds_read_b128 v[68:71], v244 offset:4096
  s_waitcnt vmcnt(6) lgkmcnt(0)
  v_lshlrev_b32 v36, 16, v248
  v_and_b32 v37, 0xffff0000, v248
  v_lshlrev_b32 v38, 16, v249
  v_and_b32 v39, 0xffff0000, v249
  v_lshlrev_b32 v40, 16, v250
  v_and_b32 v41, 0xffff0000, v250
  v_lshlrev_b32 v42, 16, v251
  v_and_b32 v43, 0xffff0000, v251
  v_lshlrev_b32 v52, 16, v112
  v_and_b32 v53, 0xffff0000, v112
  v_lshlrev_b32 v54, 16, v113
  v_and_b32 v55, 0xffff0000, v113
  v_lshlrev_b32 v56, 16, v114
  v_and_b32 v57, 0xffff0000, v114
  v_lshlrev_b32 v58, 16, v115
  v_and_b32 v59, 0xffff0000, v115
  v_pk_add_f32 v[36:37], v[36:37], v[52:53]
  v_pk_add_f32 v[38:39], v[38:39], v[54:55]
  v_pk_add_f32 v[40:41], v[40:41], v[56:57]
  v_pk_add_f32 v[42:43], v[42:43], v[58:59]
  v_lshlrev_b32 v52, 16, v116
  v_and_b32 v53, 0xffff0000, v116
  v_lshlrev_b32 v54, 16, v117
  v_and_b32 v55, 0xffff0000, v117
  v_lshlrev_b32 v56, 16, v118
  v_and_b32 v57, 0xffff0000, v118
  v_lshlrev_b32 v58, 16, v119
  v_and_b32 v59, 0xffff0000, v119
  v_pk_add_f32 v[36:37], v[36:37], v[52:53]
  v_pk_add_f32 v[38:39], v[38:39], v[54:55]
  v_pk_add_f32 v[40:41], v[40:41], v[56:57]
  v_pk_add_f32 v[42:43], v[42:43], v[58:59]
  v_lshlrev_b32 v52, 16, v120
  v_and_b32 v53, 0xffff0000, v120
  v_lshlrev_b32 v54, 16, v121
  v_and_b32 v55, 0xffff0000, v121
  v_lshlrev_b32 v56, 16, v122
  v_and_b32 v57, 0xffff0000, v122
  v_lshlrev_b32 v58, 16, v123
  v_and_b32 v59, 0xffff0000, v123
  v_pk_add_f32 v[36:37], v[36:37], v[52:53]
  v_pk_add_f32 v[38:39], v[38:39], v[54:55]
  v_pk_add_f32 v[40:41], v[40:41], v[56:57]
  v_pk_add_f32 v[42:43], v[42:43], v[58:59]
  v_lshlrev_b32 v52, 16, v124
  v_and_b32 v53, 0xffff0000, v124
  v_lshlrev_b32 v54, 16, v125
  v_and_b32 v55, 0xffff0000, v125
  v_lshlrev_b32 v56, 16, v126
  v_and_b32 v57, 0xffff0000, v126
  v_lshlrev_b32 v58, 16, v127
  v_and_b32 v59, 0xffff0000, v127
  v_pk_add_f32 v[36:37], v[36:37], v[52:53]
  v_pk_add_f32 v[38:39], v[38:39], v[54:55]
  v_pk_add_f32 v[40:41], v[40:41], v[56:57]
  v_pk_add_f32 v[42:43], v[42:43], v[58:59]
  s_waitcnt vmcnt(5)
  v_lshlrev_b32 v52, 16, v24
  v_and_b32 v53, 0xffff0000, v24
  v_lshlrev_b32 v54, 16, v25
  v_and_b32 v55, 0xffff0000, v25
  v_lshlrev_b32 v56, 16, v26
  v_and_b32 v57, 0xffff0000, v26
  v_lshlrev_b32 v58, 16, v27
  v_and_b32 v59, 0xffff0000, v27
  v_pk_add_f32 v[16:17], v[16:17], v[52:53]
  v_pk_add_f32 v[18:19], v[18:19], v[54:55]
  v_pk_add_f32 v[20:21], v[20:21], v[56:57]
  v_pk_add_f32 v[22:23], v[22:23], v[58:59]
  s_waitcnt vmcnt(4)
  v_lshlrev_b32 v52, 16, v28
  v_and_b32 v53, 0xffff0000, v28
  v_lshlrev_b32 v54, 16, v29
  v_and_b32 v55, 0xffff0000, v29
  v_lshlrev_b32 v56, 16, v30
  v_and_b32 v57, 0xffff0000, v30
  v_lshlrev_b32 v58, 16, v31
  v_and_b32 v59, 0xffff0000, v31
  v_pk_add_f32 v[16:17], v[16:17], v[52:53]
  v_pk_add_f32 v[18:19], v[18:19], v[54:55]
  v_pk_add_f32 v[20:21], v[20:21], v[56:57]
  v_pk_add_f32 v[22:23], v[22:23], v[58:59]
  s_waitcnt vmcnt(3)
  v_lshlrev_b32 v52, 16, v32
  v_and_b32 v53, 0xffff0000, v32
  v_lshlrev_b32 v54, 16, v33
  v_and_b32 v55, 0xffff0000, v33
  v_lshlrev_b32 v56, 16, v34
  v_and_b32 v57, 0xffff0000, v34
  v_lshlrev_b32 v58, 16, v35
  v_and_b32 v59, 0xffff0000, v35
  v_pk_add_f32 v[16:17], v[16:17], v[52:53]
  v_pk_add_f32 v[18:19], v[18:19], v[54:55]
  v_pk_add_f32 v[20:21], v[20:21], v[56:57]
  v_pk_add_f32 v[22:23], v[22:23], v[58:59]
  s_nop 1
  v_permlane16_swap_b32 v16, v20
  v_permlane16_swap_b32 v17, v21
  v_permlane16_swap_b32 v18, v22
  v_permlane16_swap_b32 v19, v23
  s_nop 0
  v_pk_add_f32 v[16:17], v[16:17], v[36:37]
  v_pk_add_f32 v[18:19], v[18:19], v[38:39]
  v_pk_add_f32 v[20:21], v[20:21], v[40:41]
  v_pk_add_f32 v[22:23], v[22:23], v[42:43]
  v_cvt_pk_bf16_f32 v60, v16, v17
  v_cvt_pk_bf16_f32 v61, v18, v19
  v_cvt_pk_bf16_f32 v62, v20, v21
  v_cvt_pk_bf16_f32 v63, v22, v23
  buffer_store_dwordx4 v[60:63], v240, s[20:23], s64 offen offset:0
  s_waitcnt vmcnt(4) lgkmcnt(0)
  v_lshlrev_b32 v84, 16, v252
  v_and_b32 v85, 0xffff0000, v252
  v_lshlrev_b32 v86, 16, v253
  v_and_b32 v87, 0xffff0000, v253
  v_lshlrev_b32 v88, 16, v254
  v_and_b32 v89, 0xffff0000, v254
  v_lshlrev_b32 v90, 16, v255
  v_and_b32 v91, 0xffff0000, v255
  v_lshlrev_b32 v100, 16, v128
  v_and_b32 v101, 0xffff0000, v128
  v_lshlrev_b32 v102, 16, v129
  v_and_b32 v103, 0xffff0000, v129
  v_lshlrev_b32 v104, 16, v130
  v_and_b32 v105, 0xffff0000, v130
  v_lshlrev_b32 v106, 16, v131
  v_and_b32 v107, 0xffff0000, v131
  v_pk_add_f32 v[84:85], v[84:85], v[100:101]
  v_pk_add_f32 v[86:87], v[86:87], v[102:103]
  v_pk_add_f32 v[88:89], v[88:89], v[104:105]
  v_pk_add_f32 v[90:91], v[90:91], v[106:107]
  v_lshlrev_b32 v100, 16, v132
  v_and_b32 v101, 0xffff0000, v132
  v_lshlrev_b32 v102, 16, v133
  v_and_b32 v103, 0xffff0000, v133
  v_lshlrev_b32 v104, 16, v134
  v_and_b32 v105, 0xffff0000, v134
  v_lshlrev_b32 v106, 16, v135
  v_and_b32 v107, 0xffff0000, v135
  v_pk_add_f32 v[84:85], v[84:85], v[100:101]
  v_pk_add_f32 v[86:87], v[86:87], v[102:103]
  v_pk_add_f32 v[88:89], v[88:89], v[104:105]
  v_pk_add_f32 v[90:91], v[90:91], v[106:107]
  v_lshlrev_b32 v100, 16, v136
  v_and_b32 v101, 0xffff0000, v136
  v_lshlrev_b32 v102, 16, v137
  v_and_b32 v103, 0xffff0000, v137
  v_lshlrev_b32 v104, 16, v138
  v_and_b32 v105, 0xffff0000, v138
  v_lshlrev_b32 v106, 16, v139
  v_and_b32 v107, 0xffff0000, v139
  v_pk_add_f32 v[84:85], v[84:85], v[100:101]
  v_pk_add_f32 v[86:87], v[86:87], v[102:103]
  v_pk_add_f32 v[88:89], v[88:89], v[104:105]
  v_pk_add_f32 v[90:91], v[90:91], v[106:107]
  v_lshlrev_b32 v100, 16, v140
  v_and_b32 v101, 0xffff0000, v140
  v_lshlrev_b32 v102, 16, v141
  v_and_b32 v103, 0xffff0000, v141
  v_lshlrev_b32 v104, 16, v142
  v_and_b32 v105, 0xffff0000, v142
  v_lshlrev_b32 v106, 16, v143
  v_and_b32 v107, 0xffff0000, v143
  v_pk_add_f32 v[84:85], v[84:85], v[100:101]
  v_pk_add_f32 v[86:87], v[86:87], v[102:103]
  v_pk_add_f32 v[88:89], v[88:89], v[104:105]
  v_pk_add_f32 v[90:91], v[90:91], v[106:107]
  s_waitcnt vmcnt(3)
  v_lshlrev_b32 v100, 16, v72
  v_and_b32 v101, 0xffff0000, v72
  v_lshlrev_b32 v102, 16, v73
  v_and_b32 v103, 0xffff0000, v73
  v_lshlrev_b32 v104, 16, v74
  v_and_b32 v105, 0xffff0000, v74
  v_lshlrev_b32 v106, 16, v75
  v_and_b32 v107, 0xffff0000, v75
  v_pk_add_f32 v[64:65], v[64:65], v[100:101]
  v_pk_add_f32 v[66:67], v[66:67], v[102:103]
  v_pk_add_f32 v[68:69], v[68:69], v[104:105]
  v_pk_add_f32 v[70:71], v[70:71], v[106:107]
  s_waitcnt vmcnt(2)
  v_lshlrev_b32 v100, 16, v76
  v_and_b32 v101, 0xffff0000, v76
  v_lshlrev_b32 v102, 16, v77
  v_and_b32 v103, 0xffff0000, v77
  v_lshlrev_b32 v104, 16, v78
  v_and_b32 v105, 0xffff0000, v78
  v_lshlrev_b32 v106, 16, v79
  v_and_b32 v107, 0xffff0000, v79
  v_pk_add_f32 v[64:65], v[64:65], v[100:101]
  v_pk_add_f32 v[66:67], v[66:67], v[102:103]
  v_pk_add_f32 v[68:69], v[68:69], v[104:105]
  v_pk_add_f32 v[70:71], v[70:71], v[106:107]
  s_waitcnt vmcnt(1)
  v_lshlrev_b32 v100, 16, v80
  v_and_b32 v101, 0xffff0000, v80
  v_lshlrev_b32 v102, 16, v81
  v_and_b32 v103, 0xffff0000, v81
  v_lshlrev_b32 v104, 16, v82
  v_and_b32 v105, 0xffff0000, v82
  v_lshlrev_b32 v106, 16, v83
  v_and_b32 v107, 0xffff0000, v83
  v_pk_add_f32 v[64:65], v[64:65], v[100:101]
  v_pk_add_f32 v[66:67], v[66:67], v[102:103]
  v_pk_add_f32 v[68:69], v[68:69], v[104:105]
  v_pk_add_f32 v[70:71], v[70:71], v[106:107]
  s_nop 1
  v_permlane16_swap_b32 v64, v68
  v_permlane16_swap_b32 v65, v69
  v_permlane16_swap_b32 v66, v70
  v_permlane16_swap_b32 v67, v71
  s_nop 0
  v_pk_add_f32 v[64:65], v[64:65], v[84:85]
  v_pk_add_f32 v[66:67], v[66:67], v[86:87]
  v_pk_add_f32 v[68:69], v[68:69], v[88:89]
  v_pk_add_f32 v[70:71], v[70:71], v[90:91]
  v_cvt_pk_bf16_f32 v108, v64, v65
  v_cvt_pk_bf16_f32 v109, v66, v67
  v_cvt_pk_bf16_f32 v110, v68, v69
  v_cvt_pk_bf16_f32 v111, v70, v71
  buffer_store_dwordx4 v[108:111], v240, s[20:23], s64 offen offset:128
  s_branch L_done_1
L_g2hi2_46:
  s_waitcnt vmcnt(3) lgkmcnt(0)
  v_lshlrev_b32 v36, 16, v248
  v_and_b32 v37, 0xffff0000, v248
  v_lshlrev_b32 v38, 16, v249
  v_and_b32 v39, 0xffff0000, v249
  v_lshlrev_b32 v40, 16, v250
  v_and_b32 v41, 0xffff0000, v250
  v_lshlrev_b32 v42, 16, v251
  v_and_b32 v43, 0xffff0000, v251
  v_lshlrev_b32 v52, 16, v112
  v_and_b32 v53, 0xffff0000, v112
  v_lshlrev_b32 v54, 16, v113
  v_and_b32 v55, 0xffff0000, v113
  v_lshlrev_b32 v56, 16, v114
  v_and_b32 v57, 0xffff0000, v114
  v_lshlrev_b32 v58, 16, v115
  v_and_b32 v59, 0xffff0000, v115
  v_pk_add_f32 v[36:37], v[36:37], v[52:53]
  v_pk_add_f32 v[38:39], v[38:39], v[54:55]
  v_pk_add_f32 v[40:41], v[40:41], v[56:57]
  v_pk_add_f32 v[42:43], v[42:43], v[58:59]
  v_lshlrev_b32 v52, 16, v116
  v_and_b32 v53, 0xffff0000, v116
  v_lshlrev_b32 v54, 16, v117
  v_and_b32 v55, 0xffff0000, v117
  v_lshlrev_b32 v56, 16, v118
  v_and_b32 v57, 0xffff0000, v118
  v_lshlrev_b32 v58, 16, v119
  v_and_b32 v59, 0xffff0000, v119
  v_pk_add_f32 v[36:37], v[36:37], v[52:53]
  v_pk_add_f32 v[38:39], v[38:39], v[54:55]
  v_pk_add_f32 v[40:41], v[40:41], v[56:57]
  v_pk_add_f32 v[42:43], v[42:43], v[58:59]
  v_lshlrev_b32 v52, 16, v120
  v_and_b32 v53, 0xffff0000, v120
  v_lshlrev_b32 v54, 16, v121
  v_and_b32 v55, 0xffff0000, v121
  v_lshlrev_b32 v56, 16, v122
  v_and_b32 v57, 0xffff0000, v122
  v_lshlrev_b32 v58, 16, v123
  v_and_b32 v59, 0xffff0000, v123
  v_pk_add_f32 v[36:37], v[36:37], v[52:53]
  v_pk_add_f32 v[38:39], v[38:39], v[54:55]
  v_pk_add_f32 v[40:41], v[40:41], v[56:57]
  v_pk_add_f32 v[42:43], v[42:43], v[58:59]
  v_lshlrev_b32 v52, 16, v124
  v_and_b32 v53, 0xffff0000, v124
  v_lshlrev_b32 v54, 16, v125
  v_and_b32 v55, 0xffff0000, v125
  v_lshlrev_b32 v56, 16, v126
  v_and_b32 v57, 0xffff0000, v126
  v_lshlrev_b32 v58, 16, v127
  v_and_b32 v59, 0xffff0000, v127
  v_pk_add_f32 v[36:37], v[36:37], v[52:53]
  v_pk_add_f32 v[38:39], v[38:39], v[54:55]
  v_pk_add_f32 v[40:41], v[40:41], v[56:57]
  v_pk_add_f32 v[42:43], v[42:43], v[58:59]
  s_waitcnt vmcnt(2)
  v_lshlrev_b32 v52, 16, v24
  v_and_b32 v53, 0xffff0000, v24
  v_lshlrev_b32 v54, 16, v25
  v_and_b32 v55, 0xffff0000, v25
  v_lshlrev_b32 v56, 16, v26
  v_and_b32 v57, 0xffff0000, v26
  v_lshlrev_b32 v58, 16, v27
  v_and_b32 v59, 0xffff0000, v27
  v_pk_add_f32 v[16:17], v[16:17], v[52:53]
  v_pk_add_f32 v[18:19], v[18:19], v[54:55]
  v_pk_add_f32 v[20:21], v[20:21], v[56:57]
  v_pk_add_f32 v[22:23], v[22:23], v[58:59]
  s_waitcnt vmcnt(1)
  v_lshlrev_b32 v52, 16, v28
  v_and_b32 v53, 0xffff0000, v28
  v_lshlrev_b32 v54, 16, v29
  v_and_b32 v55, 0xffff0000, v29
  v_lshlrev_b32 v56, 16, v30
  v_and_b32 v57, 0xffff0000, v30
  v_lshlrev_b32 v58, 16, v31
  v_and_b32 v59, 0xffff0000, v31
  v_pk_add_f32 v[16:17], v[16:17], v[52:53]
  v_pk_add_f32 v[18:19], v[18:19], v[54:55]
  v_pk_add_f32 v[20:21], v[20:21], v[56:57]
  v_pk_add_f32 v[22:23], v[22:23], v[58:59]
  s_waitcnt vmcnt(0)
  v_lshlrev_b32 v52, 16, v32
  v_and_b32 v53, 0xffff0000, v32
  v_lshlrev_b32 v54, 16, v33
  v_and_b32 v55, 0xffff0000, v33
  v_lshlrev_b32 v56, 16, v34
  v_and_b32 v57, 0xffff0000, v34
  v_lshlrev_b32 v58, 16, v35
  v_and_b32 v59, 0xffff0000, v35
  v_pk_add_f32 v[16:17], v[16:17], v[52:53]
  v_pk_add_f32 v[18:19], v[18:19], v[54:55]
  v_pk_add_f32 v[20:21], v[20:21], v[56:57]
  v_pk_add_f32 v[22:23], v[22:23], v[58:59]
  s_nop 1
  v_permlane16_swap_b32 v16, v20
  v_permlane16_swap_b32 v17, v21
  v_permlane16_swap_b32 v18, v22
  v_permlane16_swap_b32 v19, v23
  s_nop 0
  v_pk_add_f32 v[16:17], v[16:17], v[36:37]
  v_pk_add_f32 v[18:19], v[18:19], v[38:39]
  v_pk_add_f32 v[20:21], v[20:21], v[40:41]
  v_pk_add_f32 v[22:23], v[22:23], v[42:43]
  v_cvt_pk_bf16_f32 v60, v16, v17
  v_cvt_pk_bf16_f32 v61, v18, v19
  v_cvt_pk_bf16_f32 v62, v20, v21
  v_cvt_pk_bf16_f32 v63, v22, v23
  buffer_store_dwordx4 v[60:63], v240, s[20:23], s64 offen offset:0
  s_branch L_done_1
L_a_cons:
  s_and_b32 s28, s99, 7
  s_lshr_b32 s29, s99, 3
  s_mov_b32 s30, s100
  v_and_b32 v1, 63, v0
  s_lshr_b32 s31, s28, 1
  s_and_b32 s32, s28, 1
  s_lshl_b32 s32, s32, 3
  s_add_u32 s32, s32, s29
  s_mov_b32 s50, 0x3fb8aa3b
  s_mov_b32 s51, 0x3fb8aa3b
  s_mov_b32 s56, 0x358637bd
  s_and_b32 s33, s30, 3
  v_and_b32 v2, 15, v1
  v_lshrrev_b32 v3, 4, v1
  v_lshrrev_b32 v4, 2, v2
  v_lshlrev_b32 v5, 11, v3
  v_lshl_add_u32 v10, v2, 4, v5
  s_lshl_b32 s34, s33, 9
  v_add_u32 v10, s34, v10
  v_lshl_add_u32 v4, v3, 2, v4
  v_mul_u32_u24 v4, 288, v4
  v_and_b32 v5, 3, v2
  v_lshl_add_u32 v4, v5, 3, v4
  v_add_u32 v11, 8192, v4
  s_barrier
  s_getpc_b64 s[62:63]
L_pc_48:
  s_add_u32 s62, s62, L_tab_wo-L_pc_48
  s_addc_u32 s63, s63, 0
  s_lshl_b32 s35, s30, 11
  v_lshlrev_b32 v2, 4, v1
  v_add_u32 v2, s35, v2
  global_load_dwordx4 v[244:247], v2, s[62:63]
  global_load_dwordx4 v[248:251], v2, s[62:63] offset:1024
  s_mov_b32 s44, 0
  s_barrier
  v_add_u32 v13, s44, v10
  v_add_u32 v14, s44, v11
  s_add_u32 s44, s44, 35840
  s_cmp_eq_u32 s44, 143360
  s_cselect_b32 s44, 0, s44
  ds_read_b128 v[160:163], v13 offset:0
  ds_read_b128 v[164:167], v13 offset:256
  ds_read_b64_tr_b16 v[176:177], v14 offset:9216
  ds_read_b64_tr_b16 v[178:179], v14 offset:13824
  ds_read_b64_tr_b16 v[180:181], v14 offset:9248
  ds_read_b64_tr_b16 v[182:183], v14 offset:13856
  ds_read_b64_tr_b16 v[184:185], v14 offset:9280
  ds_read_b64_tr_b16 v[186:187], v14 offset:13888
  ds_read_b64_tr_b16 v[188:189], v14 offset:9312
  ds_read_b64_tr_b16 v[190:191], v14 offset:13920
  ds_read_b64_tr_b16 v[192:193], v14 offset:9344
  ds_read_b64_tr_b16 v[194:195], v14 offset:13952
  s_waitcnt lgkmcnt(8)
  v_mfma_f32_16x16x32_bf16 v[16:19], v[160:163], v[176:179], 0
  ds_read_b64_tr_b16 v[196:197], v14 offset:9376
  v_mfma_f32_16x16x32_bf16 v[20:23], v[164:167], v[176:179], 0
  ds_read_b64_tr_b16 v[198:199], v14 offset:13984
  s_waitcnt lgkmcnt(8)
  v_mfma_f32_16x16x32_bf16 v[24:27], v[160:163], v[180:183], 0
  ds_read_b64_tr_b16 v[200:201], v14 offset:9408
  v_mfma_f32_16x16x32_bf16 v[28:31], v[164:167], v[180:183], 0
  ds_read_b64_tr_b16 v[202:203], v14 offset:14016
  s_waitcnt lgkmcnt(8)
  v_mfma_f32_16x16x32_bf16 v[32:35], v[160:163], v[184:187], 0
  ds_read_b64_tr_b16 v[204:205], v14 offset:9440
  v_mfma_f32_16x16x32_bf16 v[36:39], v[164:167], v[184:187], 0
  ds_read_b64_tr_b16 v[206:207], v14 offset:14048
  s_waitcnt lgkmcnt(8)
  v_mfma_f32_16x16x32_bf16 v[40:43], v[160:163], v[188:191], 0
  ds_read_b64_tr_b16 v[208:209], v14 offset:9472
  v_mfma_f32_16x16x32_bf16 v[44:47], v[164:167], v[188:191], 0
  ds_read_b64_tr_b16 v[210:211], v14 offset:14080
  s_waitcnt lgkmcnt(8)
  v_mfma_f32_16x16x32_bf16 v[48:51], v[160:163], v[192:195], 0
  ds_read_b64_tr_b16 v[176:177], v14 offset:18432
  v_mfma_f32_16x16x32_bf16 v[52:55], v[164:167], v[192:195], 0
  ds_read_b64_tr_b16 v[178:179], v14 offset:23040
  s_waitcnt lgkmcnt(8)
  v_mfma_f32_16x16x32_bf16 v[56:59], v[160:163], v[196:199], 0
  ds_read_b64_tr_b16 v[180:181], v14 offset:18464
  v_mfma_f32_16x16x32_bf16 v[60:63], v[164:167], v[196:199], 0
  ds_read_b64_tr_b16 v[182:183], v14 offset:23072
  s_waitcnt lgkmcnt(8)
  v_mfma_f32_16x16x32_bf16 v[64:67], v[160:163], v[200:203], 0
  ds_read_b64_tr_b16 v[184:185], v14 offset:18496
  v_mfma_f32_16x16x32_bf16 v[68:71], v[164:167], v[200:203], 0
  ds_read_b64_tr_b16 v[186:187], v14 offset:23104
  s_waitcnt lgkmcnt(8)
  v_mfma_f32_16x16x32_bf16 v[72:75], v[160:163], v[204:207], 0
  ds_read_b64_tr_b16 v[188:189], v14 offset:18528
  v_mfma_f32_16x16x32_bf16 v[76:79], v[164:167], v[204:207], 0
  ds_read_b64_tr_b16 v[190:191], v14 offset:23136
  s_waitcnt lgkmcnt(8)
  v_mfma_f32_16x16x32_bf16 v[80:83], v[160:163], v[208:211], 0
  ds_read_b64_tr_b16 v[192:193], v14 offset:18560
  v_mfma_f32_16x16x32_bf16 v[84:87], v[164:167], v[208:211], 0
  ds_read_b64_tr_b16 v[194:195], v14 offset:23168
  s_waitcnt lgkmcnt(8)
  v_mfma_f32_16x16x32_bf16 v[88:91], v[160:163], v[176:179], 0
  ds_read_b64_tr_b16 v[196:197], v14 offset:18592
  v_mfma_f32_16x16x32_bf16 v[92:95], v[164:167], v[176:179], 0
  ds_read_b64_tr_b16 v[198:199], v14 offset:23200
  s_waitcnt lgkmcnt(8)
  v_mfma_f32_16x16x32_bf16 v[96:99], v[160:163], v[180:183], 0
  ds_read_b64_tr_b16 v[200:201], v14 offset:18624
  v_mfma_f32_16x16x32_bf16 v[100:103], v[164:167], v[180:183], 0
  ds_read_b64_tr_b16 v[202:203], v14 offset:23232
  s_waitcnt lgkmcnt(8)
  v_mfma_f32_16x16x32_bf16 v[104:107], v[160:163], v[184:187], 0
  ds_read_b64_tr_b16 v[204:205], v14 offset:18656
  v_mfma_f32_16x16x32_bf16 v[108:111], v[164:167], v[184:187], 0
  ds_read_b64_tr_b16 v[206:207], v14 offset:23264
  s_waitcnt lgkmcnt(8)
  v_mfma_f32_16x16x32_bf16 v[112:115], v[160:163], v[188:191], 0
  ds_read_b64_tr_b16 v[208:209], v14 offset:18688
  v_mfma_f32_16x16x32_bf16 v[116:119], v[164:167], v[188:191], 0
  ds_read_b64_tr_b16 v[210:211], v14 offset:23296
  s_barrier
  v_add_u32 v13, s44, v10
  v_add_u32 v14, s44, v11
  s_add_u32 s44, s44, 35840
  s_cmp_eq_u32 s44, 143360
  s_cselect_b32 s44, 0, s44
  s_waitcnt lgkmcnt(8)
  v_mfma_f32_16x16x32_bf16 v[120:123], v[160:163], v[192:195], 0
  ds_read_b128 v[168:171], v13 offset:0
  ds_read_b128 v[172:175], v13 offset:256
  v_mfma_f32_16x16x32_bf16 v[124:127], v[164:167], v[192:195], 0
  ds_read_b64_tr_b16 v[176:177], v14 offset:9216
  ds_read_b64_tr_b16 v[178:179], v14 offset:13824
  s_waitcnt lgkmcnt(10)
  v_mfma_f32_16x16x32_bf16 v[128:131], v[160:163], v[196:199], 0
  ds_read_b64_tr_b16 v[180:181], v14 offset:9248
  v_mfma_f32_16x16x32_bf16 v[132:135], v[164:167], v[196:199], 0
  ds_read_b64_tr_b16 v[182:183], v14 offset:13856
  s_waitcnt lgkmcnt(10)
  v_mfma_f32_16x16x32_bf16 v[136:139], v[160:163], v[200:203], 0
  ds_read_b64_tr_b16 v[184:185], v14 offset:9280
  v_mfma_f32_16x16x32_bf16 v[140:143], v[164:167], v[200:203], 0
  ds_read_b64_tr_b16 v[186:187], v14 offset:13888
  s_waitcnt lgkmcnt(10)
  v_mfma_f32_16x16x32_bf16 v[144:147], v[160:163], v[204:207], 0
  ds_read_b64_tr_b16 v[188:189], v14 offset:9312
  v_mfma_f32_16x16x32_bf16 v[148:151], v[164:167], v[204:207], 0
  ds_read_b64_tr_b16 v[190:191], v14 offset:13920
  s_waitcnt lgkmcnt(10)
  v_mfma_f32_16x16x32_bf16 v[152:155], v[160:163], v[208:211], 0
  ds_read_b64_tr_b16 v[192:193], v14 offset:9344
  v_mfma_f32_16x16x32_bf16 v[156:159], v[164:167], v[208:211], 0
  ds_read_b64_tr_b16 v[194:195], v14 offset:13952
  s_mov_b32 s47, 0
L_kv_cr_49:
  s_waitcnt lgkmcnt(8)
  v_mfma_f32_16x16x32_bf16 v[16:19], v[168:171], v[176:179], v[16:19]
  ds_read_b64_tr_b16 v[196:197], v14 offset:9376
  v_mfma_f32_16x16x32_bf16 v[20:23], v[172:175], v[176:179], v[20:23]
  ds_read_b64_tr_b16 v[198:199], v14 offset:13984
  s_waitcnt lgkmcnt(8)
  v_mfma_f32_16x16x32_bf16 v[24:27], v[168:171], v[180:183], v[24:27]
  ds_read_b64_tr_b16 v[200:201], v14 offset:9408
  v_mfma_f32_16x16x32_bf16 v[28:31], v[172:175], v[180:183], v[28:31]
  ds_read_b64_tr_b16 v[202:203], v14 offset:14016
  s_waitcnt lgkmcnt(8)
  v_mfma_f32_16x16x32_bf16 v[32:35], v[168:171], v[184:187], v[32:35]
  ds_read_b64_tr_b16 v[204:205], v14 offset:9440
  v_mfma_f32_16x16x32_bf16 v[36:39], v[172:175], v[184:187], v[36:39]
  ds_read_b64_tr_b16 v[206:207], v14 offset:14048
  s_waitcnt lgkmcnt(8)
  v_mfma_f32_16x16x32_bf16 v[40:43], v[168:171], v[188:191], v[40:43]
  ds_read_b64_tr_b16 v[208:209], v14 offset:9472
  v_mfma_f32_16x16x32_bf16 v[44:47], v[172:175], v[188:191], v[44:47]
  ds_read_b64_tr_b16 v[210:211], v14 offset:14080
  s_waitcnt lgkmcnt(8)
  v_mfma_f32_16x16x32_bf16 v[48:51], v[168:171], v[192:195], v[48:51]
  ds_read_b64_tr_b16 v[176:177], v14 offset:18432
  v_mfma_f32_16x16x32_bf16 v[52:55], v[172:175], v[192:195], v[52:55]
  ds_read_b64_tr_b16 v[178:179], v14 offset:23040
  s_waitcnt lgkmcnt(8)
  v_mfma_f32_16x16x32_bf16 v[56:59], v[168:171], v[196:199], v[56:59]
  ds_read_b64_tr_b16 v[180:181], v14 offset:18464
  v_mfma_f32_16x16x32_bf16 v[60:63], v[172:175], v[196:199], v[60:63]
  ds_read_b64_tr_b16 v[182:183], v14 offset:23072
  s_waitcnt lgkmcnt(8)
  v_mfma_f32_16x16x32_bf16 v[64:67], v[168:171], v[200:203], v[64:67]
  ds_read_b64_tr_b16 v[184:185], v14 offset:18496
  v_mfma_f32_16x16x32_bf16 v[68:71], v[172:175], v[200:203], v[68:71]
  ds_read_b64_tr_b16 v[186:187], v14 offset:23104
  s_waitcnt lgkmcnt(8)
  v_mfma_f32_16x16x32_bf16 v[72:75], v[168:171], v[204:207], v[72:75]
  ds_read_b64_tr_b16 v[188:189], v14 offset:18528
  v_mfma_f32_16x16x32_bf16 v[76:79], v[172:175], v[204:207], v[76:79]
  ds_read_b64_tr_b16 v[190:191], v14 offset:23136
  s_waitcnt lgkmcnt(8)
  v_mfma_f32_16x16x32_bf16 v[80:83], v[168:171], v[208:211], v[80:83]
  ds_read_b64_tr_b16 v[192:193], v14 offset:18560
  v_mfma_f32_16x16x32_bf16 v[84:87], v[172:175], v[208:211], v[84:87]
  ds_read_b64_tr_b16 v[194:195], v14 offset:23168
  s_waitcnt lgkmcnt(8)
  v_mfma_f32_16x16x32_bf16 v[88:91], v[168:171], v[176:179], v[88:91]
  ds_read_b64_tr_b16 v[196:197], v14 offset:18592
  v_mfma_f32_16x16x32_bf16 v[92:95], v[172:175], v[176:179], v[92:95]
  ds_read_b64_tr_b16 v[198:199], v14 offset:23200
  s_waitcnt lgkmcnt(8)
  v_mfma_f32_16x16x32_bf16 v[96:99], v[168:171], v[180:183], v[96:99]
  ds_read_b64_tr_b16 v[200:201], v14 offset:18624
  v_mfma_f32_16x16x32_bf16 v[100:103], v[172:175], v[180:183], v[100:103]
  ds_read_b64_tr_b16 v[202:203], v14 offset:23232
  s_waitcnt lgkmcnt(8)
  v_mfma_f32_16x16x32_bf16 v[104:107], v[168:171], v[184:187], v[104:107]
  ds_read_b64_tr_b16 v[204:205], v14 offset:18656
  v_mfma_f32_16x16x32_bf16 v[108:111], v[172:175], v[184:187], v[108:111]
  ds_read_b64_tr_b16 v[206:207], v14 offset:23264
  s_waitcnt lgkmcnt(8)
  v_mfma_f32_16x16x32_bf16 v[112:115], v[168:171], v[188:191], v[112:115]
  ds_read_b64_tr_b16 v[208:209], v14 offset:18688
  v_mfma_f32_16x16x32_bf16 v[116:119], v[172:175], v[188:191], v[116:119]
  ds_read_b64_tr_b16 v[210:211], v14 offset:23296
  s_barrier
  v_add_u32 v13, s44, v10
  v_add_u32 v14, s44, v11
  s_add_u32 s44, s44, 35840
  s_cmp_eq_u32 s44, 143360
  s_cselect_b32 s44, 0, s44
  s_waitcnt lgkmcnt(8)
  v_mfma_f32_16x16x32_bf16 v[120:123], v[168:171], v[192:195], v[120:123]
  ds_read_b128 v[160:163], v13 offset:0
  ds_read_b128 v[164:167], v13 offset:256
  v_mfma_f32_16x16x32_bf16 v[124:127], v[172:175], v[192:195], v[124:127]
  ds_read_b64_tr_b16 v[176:177], v14 offset:9216
  ds_read_b64_tr_b16 v[178:179], v14 offset:13824
  s_waitcnt lgkmcnt(10)
  v_mfma_f32_16x16x32_bf16 v[128:131], v[168:171], v[196:199], v[128:131]
  ds_read_b64_tr_b16 v[180:181], v14 offset:9248
  v_mfma_f32_16x16x32_bf16 v[132:135], v[172:175], v[196:199], v[132:135]
  ds_read_b64_tr_b16 v[182:183], v14 offset:13856
  s_waitcnt lgkmcnt(10)
  v_mfma_f32_16x16x32_bf16 v[136:139], v[168:171], v[200:203], v[136:139]
  ds_read_b64_tr_b16 v[184:185], v14 offset:9280
  v_mfma_f32_16x16x32_bf16 v[140:143], v[172:175], v[200:203], v[140:143]
  ds_read_b64_tr_b16 v[186:187], v14 offset:13888
  s_waitcnt lgkmcnt(10)
  v_mfma_f32_16x16x32_bf16 v[144:147], v[168:171], v[204:207], v[144:147]
  ds_read_b64_tr_b16 v[188:189], v14 offset:9312
  v_mfma_f32_16x16x32_bf16 v[148:151], v[172:175], v[204:207], v[148:151]
  ds_read_b64_tr_b16 v[190:191], v14 offset:13920
  s_waitcnt lgkmcnt(10)
  v_mfma_f32_16x16x32_bf16 v[152:155], v[168:171], v[208:211], v[152:155]
  ds_read_b64_tr_b16 v[192:193], v14 offset:9344
  v_mfma_f32_16x16x32_bf16 v[156:159], v[172:175], v[208:211], v[156:159]
  ds_read_b64_tr_b16 v[194:195], v14 offset:13952
  s_waitcnt lgkmcnt(8)
  v_mfma_f32_16x16x32_bf16 v[16:19], v[160:163], v[176:179], v[16:19]
  ds_read_b64_tr_b16 v[196:197], v14 offset:9376
  v_mfma_f32_16x16x32_bf16 v[20:23], v[164:167], v[176:179], v[20:23]
  ds_read_b64_tr_b16 v[198:199], v14 offset:13984
  s_waitcnt lgkmcnt(8)
  v_mfma_f32_16x16x32_bf16 v[24:27], v[160:163], v[180:183], v[24:27]
  ds_read_b64_tr_b16 v[200:201], v14 offset:9408
  v_mfma_f32_16x16x32_bf16 v[28:31], v[164:167], v[180:183], v[28:31]
  ds_read_b64_tr_b16 v[202:203], v14 offset:14016
  s_waitcnt lgkmcnt(8)
  v_mfma_f32_16x16x32_bf16 v[32:35], v[160:163], v[184:187], v[32:35]
  ds_read_b64_tr_b16 v[204:205], v14 offset:9440
  v_mfma_f32_16x16x32_bf16 v[36:39], v[164:167], v[184:187], v[36:39]
  ds_read_b64_tr_b16 v[206:207], v14 offset:14048
  s_waitcnt lgkmcnt(8)
  v_mfma_f32_16x16x32_bf16 v[40:43], v[160:163], v[188:191], v[40:43]
  ds_read_b64_tr_b16 v[208:209], v14 offset:9472
  v_mfma_f32_16x16x32_bf16 v[44:47], v[164:167], v[188:191], v[44:47]
  ds_read_b64_tr_b16 v[210:211], v14 offset:14080
  s_waitcnt lgkmcnt(8)
  v_mfma_f32_16x16x32_bf16 v[48:51], v[160:163], v[192:195], v[48:51]
  ds_read_b64_tr_b16 v[176:177], v14 offset:18432
  v_mfma_f32_16x16x32_bf16 v[52:55], v[164:167], v[192:195], v[52:55]
  ds_read_b64_tr_b16 v[178:179], v14 offset:23040
  s_waitcnt lgkmcnt(8)
  v_mfma_f32_16x16x32_bf16 v[56:59], v[160:163], v[196:199], v[56:59]
  ds_read_b64_tr_b16 v[180:181], v14 offset:18464
  v_mfma_f32_16x16x32_bf16 v[60:63], v[164:167], v[196:199], v[60:63]
  ds_read_b64_tr_b16 v[182:183], v14 offset:23072
  s_waitcnt lgkmcnt(8)
  v_mfma_f32_16x16x32_bf16 v[64:67], v[160:163], v[200:203], v[64:67]
  ds_read_b64_tr_b16 v[184:185], v14 offset:18496
  v_mfma_f32_16x16x32_bf16 v[68:71], v[164:167], v[200:203], v[68:71]
  ds_read_b64_tr_b16 v[186:187], v14 offset:23104
  s_waitcnt lgkmcnt(8)
  v_mfma_f32_16x16x32_bf16 v[72:75], v[160:163], v[204:207], v[72:75]
  ds_read_b64_tr_b16 v[188:189], v14 offset:18528
  v_mfma_f32_16x16x32_bf16 v[76:79], v[164:167], v[204:207], v[76:79]
  ds_read_b64_tr_b16 v[190:191], v14 offset:23136
  s_waitcnt lgkmcnt(8)
  v_mfma_f32_16x16x32_bf16 v[80:83], v[160:163], v[208:211], v[80:83]
  ds_read_b64_tr_b16 v[192:193], v14 offset:18560
  v_mfma_f32_16x16x32_bf16 v[84:87], v[164:167], v[208:211], v[84:87]
  ds_read_b64_tr_b16 v[194:195], v14 offset:23168
  s_waitcnt lgkmcnt(8)
  v_mfma_f32_16x16x32_bf16 v[88:91], v[160:163], v[176:179], v[88:91]
  ds_read_b64_tr_b16 v[196:197], v14 offset:18592
  v_mfma_f32_16x16x32_bf16 v[92:95], v[164:167], v[176:179], v[92:95]
  ds_read_b64_tr_b16 v[198:199], v14 offset:23200
  s_waitcnt lgkmcnt(8)
  v_mfma_f32_16x16x32_bf16 v[96:99], v[160:163], v[180:183], v[96:99]
  ds_read_b64_tr_b16 v[200:201], v14 offset:18624
  v_mfma_f32_16x16x32_bf16 v[100:103], v[164:167], v[180:183], v[100:103]
  ds_read_b64_tr_b16 v[202:203], v14 offset:23232
  s_waitcnt lgkmcnt(8)
  v_mfma_f32_16x16x32_bf16 v[104:107], v[160:163], v[184:187], v[104:107]
  ds_read_b64_tr_b16 v[204:205], v14 offset:18656
  v_mfma_f32_16x16x32_bf16 v[108:111], v[164:167], v[184:187], v[108:111]
  ds_read_b64_tr_b16 v[206:207], v14 offset:23264
  s_waitcnt lgkmcnt(8)
  v_mfma_f32_16x16x32_bf16 v[112:115], v[160:163], v[188:191], v[112:115]
  ds_read_b64_tr_b16 v[208:209], v14 offset:18688
  v_mfma_f32_16x16x32_bf16 v[116:119], v[164:167], v[188:191], v[116:119]
  ds_read_b64_tr_b16 v[210:211], v14 offset:23296
  s_barrier
  v_add_u32 v13, s44, v10
  v_add_u32 v14, s44, v11
  s_add_u32 s44, s44, 35840
  s_cmp_eq_u32 s44, 143360
  s_cselect_b32 s44, 0, s44
  s_waitcnt lgkmcnt(8)
  v_mfma_f32_16x16x32_bf16 v[120:123], v[160:163], v[192:195], v[120:123]
  ds_read_b128 v[168:171], v13 offset:0
  ds_read_b128 v[172:175], v13 offset:256
  v_mfma_f32_16x16x32_bf16 v[124:127], v[164:167], v[192:195], v[124:127]
  ds_read_b64_tr_b16 v[176:177], v14 offset:9216
  ds_read_b64_tr_b16 v[178:179], v14 offset:13824
  s_waitcnt lgkmcnt(10)
  v_mfma_f32_16x16x32_bf16 v[128:131], v[160:163], v[196:199], v[128:131]
  ds_read_b64_tr_b16 v[180:181], v14 offset:9248
  v_mfma_f32_16x16x32_bf16 v[132:135], v[164:167], v[196:199], v[132:135]
  ds_read_b64_tr_b16 v[182:183], v14 offset:13856
  s_waitcnt lgkmcnt(10)
  v_mfma_f32_16x16x32_bf16 v[136:139], v[160:163], v[200:203], v[136:139]
  ds_read_b64_tr_b16 v[184:185], v14 offset:9280
  v_mfma_f32_16x16x32_bf16 v[140:143], v[164:167], v[200:203], v[140:143]
  ds_read_b64_tr_b16 v[186:187], v14 offset:13888
  s_waitcnt lgkmcnt(10)
  v_mfma_f32_16x16x32_bf16 v[144:147], v[160:163], v[204:207], v[144:147]
  ds_read_b64_tr_b16 v[188:189], v14 offset:9312
  v_mfma_f32_16x16x32_bf16 v[148:151], v[164:167], v[204:207], v[148:151]
  ds_read_b64_tr_b16 v[190:191], v14 offset:13920
  s_waitcnt lgkmcnt(10)
  v_mfma_f32_16x16x32_bf16 v[152:155], v[160:163], v[208:211], v[152:155]
  ds_read_b64_tr_b16 v[192:193], v14 offset:9344
  v_mfma_f32_16x16x32_bf16 v[156:159], v[164:167], v[208:211], v[156:159]
  ds_read_b64_tr_b16 v[194:195], v14 offset:13952
  s_add_u32 s47, s47, 1
  s_cmp_lt_u32 s47, 8
  s_cbranch_scc1 L_kv_cr_49
  s_waitcnt lgkmcnt(8)
  v_mfma_f32_16x16x32_bf16 v[16:19], v[168:171], v[176:179], v[16:19]
  ds_read_b64_tr_b16 v[196:197], v14 offset:9376
  v_mfma_f32_16x16x32_bf16 v[20:23], v[172:175], v[176:179], v[20:23]
  ds_read_b64_tr_b16 v[198:199], v14 offset:13984
  s_waitcnt lgkmcnt(8)
  v_mfma_f32_16x16x32_bf16 v[24:27], v[168:171], v[180:183], v[24:27]
  ds_read_b64_tr_b16 v[200:201], v14 offset:9408
  v_mfma_f32_16x16x32_bf16 v[28:31], v[172:175], v[180:183], v[28:31]
  ds_read_b64_tr_b16 v[202:203], v14 offset:14016
  s_waitcnt lgkmcnt(8)
  v_mfma_f32_16x16x32_bf16 v[32:35], v[168:171], v[184:187], v[32:35]
  ds_read_b64_tr_b16 v[204:205], v14 offset:9440
  v_mfma_f32_16x16x32_bf16 v[36:39], v[172:175], v[184:187], v[36:39]
  ds_read_b64_tr_b16 v[206:207], v14 offset:14048
  s_waitcnt lgkmcnt(8)
  v_mfma_f32_16x16x32_bf16 v[40:43], v[168:171], v[188:191], v[40:43]
  ds_read_b64_tr_b16 v[208:209], v14 offset:9472
  v_mfma_f32_16x16x32_bf16 v[44:47], v[172:175], v[188:191], v[44:47]
  ds_read_b64_tr_b16 v[210:211], v14 offset:14080
  s_waitcnt lgkmcnt(8)
  v_mfma_f32_16x16x32_bf16 v[48:51], v[168:171], v[192:195], v[48:51]
  ds_read_b64_tr_b16 v[176:177], v14 offset:18432
  v_mfma_f32_16x16x32_bf16 v[52:55], v[172:175], v[192:195], v[52:55]
  ds_read_b64_tr_b16 v[178:179], v14 offset:23040
  s_waitcnt lgkmcnt(8)
  v_mfma_f32_16x16x32_bf16 v[56:59], v[168:171], v[196:199], v[56:59]
  ds_read_b64_tr_b16 v[180:181], v14 offset:18464
  v_mfma_f32_16x16x32_bf16 v[60:63], v[172:175], v[196:199], v[60:63]
  ds_read_b64_tr_b16 v[182:183], v14 offset:23072
  s_waitcnt lgkmcnt(8)
  v_mfma_f32_16x16x32_bf16 v[64:67], v[168:171], v[200:203], v[64:67]
  ds_read_b64_tr_b16 v[184:185], v14 offset:18496
  v_mfma_f32_16x16x32_bf16 v[68:71], v[172:175], v[200:203], v[68:71]
  ds_read_b64_tr_b16 v[186:187], v14 offset:23104
  s_waitcnt lgkmcnt(8)
  v_mfma_f32_16x16x32_bf16 v[72:75], v[168:171], v[204:207], v[72:75]
  ds_read_b64_tr_b16 v[188:189], v14 offset:18528
  v_mfma_f32_16x16x32_bf16 v[76:79], v[172:175], v[204:207], v[76:79]
  ds_read_b64_tr_b16 v[190:191], v14 offset:23136
  s_waitcnt lgkmcnt(8)
  v_mfma_f32_16x16x32_bf16 v[80:83], v[168:171], v[208:211], v[80:83]
  ds_read_b64_tr_b16 v[192:193], v14 offset:18560
  v_mfma_f32_16x16x32_bf16 v[84:87], v[172:175], v[208:211], v[84:87]
  ds_read_b64_tr_b16 v[194:195], v14 offset:23168
  s_waitcnt lgkmcnt(8)
  v_mfma_f32_16x16x32_bf16 v[88:91], v[168:171], v[176:179], v[88:91]
  ds_read_b64_tr_b16 v[196:197], v14 offset:18592
  v_mfma_f32_16x16x32_bf16 v[92:95], v[172:175], v[176:179], v[92:95]
  ds_read_b64_tr_b16 v[198:199], v14 offset:23200
  s_waitcnt lgkmcnt(8)
  v_mfma_f32_16x16x32_bf16 v[96:99], v[168:171], v[180:183], v[96:99]
  ds_read_b64_tr_b16 v[200:201], v14 offset:18624
  v_mfma_f32_16x16x32_bf16 v[100:103], v[172:175], v[180:183], v[100:103]
  ds_read_b64_tr_b16 v[202:203], v14 offset:23232
  s_waitcnt lgkmcnt(8)
  v_mfma_f32_16x16x32_bf16 v[104:107], v[168:171], v[184:187], v[104:107]
  ds_read_b64_tr_b16 v[204:205], v14 offset:18656
  v_mfma_f32_16x16x32_bf16 v[108:111], v[172:175], v[184:187], v[108:111]
  ds_read_b64_tr_b16 v[206:207], v14 offset:23264
  s_waitcnt lgkmcnt(8)
  v_mfma_f32_16x16x32_bf16 v[112:115], v[168:171], v[188:191], v[112:115]
  ds_read_b64_tr_b16 v[208:209], v14 offset:18688
  v_mfma_f32_16x16x32_bf16 v[116:119], v[172:175], v[188:191], v[116:119]
  ds_read_b64_tr_b16 v[210:211], v14 offset:23296
  s_barrier
  s_waitcnt lgkmcnt(8)
  v_mfma_f32_16x16x32_bf16 v[120:123], v[168:171], v[192:195], v[120:123]
  v_mfma_f32_16x16x32_bf16 v[124:127], v[172:175], v[192:195], v[124:127]
  s_waitcnt lgkmcnt(6)
  v_mfma_f32_16x16x32_bf16 v[128:131], v[168:171], v[196:199], v[128:131]
  v_mfma_f32_16x16x32_bf16 v[132:135], v[172:175], v[196:199], v[132:135]
  s_waitcnt lgkmcnt(4)
  v_mfma_f32_16x16x32_bf16 v[136:139], v[168:171], v[200:203], v[136:139]
  v_mfma_f32_16x16x32_bf16 v[140:143], v[172:175], v[200:203], v[140:143]
  s_waitcnt lgkmcnt(2)
  v_mfma_f32_16x16x32_bf16 v[144:147], v[168:171], v[204:207], v[144:147]
  v_mfma_f32_16x16x32_bf16 v[148:151], v[172:175], v[204:207], v[148:151]
  s_waitcnt lgkmcnt(0)
  v_mfma_f32_16x16x32_bf16 v[152:155], v[168:171], v[208:211], v[152:155]
  v_mfma_f32_16x16x32_bf16 v[156:159], v[172:175], v[208:211], v[156:159]
  s_barrier
  s_nop 7
  s_load_dwordx2 s[6:7], s[0:1], 48
  v_lshrrev_b32 v254, 4, v0
  v_and_b32 v3, 15, v0
  v_lshlrev_b32 v254, 12, v254
  v_lshl_add_u32 v254, v3, 7, v254
  s_lshr_b32 s58, s28, 1
  s_mul_i32 s58, s58, 4718592
  s_and_b32 s35, s28, 1
  s_lshl_b32 s35, s35, 11
  s_add_u32 s58, s58, s35
  s_lshl_b32 s35, s29, 16
  s_add_u32 s58, s58, s35
  s_add_u32 s58, s58, 0
  s_mov_b32 s59, 0
  s_waitcnt lgkmcnt(0)
  s_mov_b32 s60, s6
  s_and_b32 s61, s7, 0xffff
  s_mov_b32 s62, 18874368
  s_mov_b32 s63, 0x20000
  buffer_load_dword v255, v254, s[60:63], s58 offen
  s_add_u32 s58, s58, 524288
  buffer_load_dword v255, v254, s[60:63], s58 offen
  s_add_u32 s58, s58, 524288
  buffer_load_dword v255, v254, s[60:63], s58 offen
  s_add_u32 s58, s58, 524288
  v_pk_mul_f32 v[232:233], v[16:17], s[50:51]
  v_pk_mul_f32 v[234:235], v[18:19], s[50:51]
  v_pk_mul_f32 v[236:237], v[20:21], s[50:51]
  v_pk_mul_f32 v[238:239], v[22:23], s[50:51]
  v_exp_f32_e64 v232, v232 clamp
  v_exp_f32_e64 v233, v233 clamp
  v_exp_f32_e64 v234, v234 clamp
  v_exp_f32_e64 v235, v235 clamp
  v_exp_f32_e64 v236, v236 clamp
  v_exp_f32_e64 v237, v237 clamp
  v_exp_f32_e64 v238, v238 clamp
  v_exp_f32_e64 v239, v239 clamp
  v_max_f32 v16, s56, v16
  v_max_f32 v17, s56, v17
  v_max_f32 v18, s56, v18
  v_max_f32 v19, s56, v19
  v_max_f32 v20, s56, v20
  v_max_f32 v21, s56, v21
  v_max_f32 v22, s56, v22
  v_max_f32 v23, s56, v23
  v_pk_add_f32 v[16:17], v[16:17], v[232:233]
  v_pk_add_f32 v[18:19], v[18:19], v[234:235]
  v_pk_add_f32 v[20:21], v[20:21], v[236:237]
  v_pk_add_f32 v[22:23], v[22:23], v[238:239]
  v_cvt_pk_bf16_f32 v160, v16, v17
  v_cvt_pk_bf16_f32 v161, v18, v19
  v_cvt_pk_bf16_f32 v162, v20, v21
  v_cvt_pk_bf16_f32 v163, v22, v23
  v_pk_mul_f32 v[232:233], v[24:25], s[50:51]
  v_pk_mul_f32 v[234:235], v[26:27], s[50:51]
  v_pk_mul_f32 v[236:237], v[28:29], s[50:51]
  v_pk_mul_f32 v[238:239], v[30:31], s[50:51]
  v_exp_f32_e64 v232, v232 clamp
  v_exp_f32_e64 v233, v233 clamp
  v_exp_f32_e64 v234, v234 clamp
  v_exp_f32_e64 v235, v235 clamp
  v_exp_f32_e64 v236, v236 clamp
  v_exp_f32_e64 v237, v237 clamp
  v_exp_f32_e64 v238, v238 clamp
  v_exp_f32_e64 v239, v239 clamp
  v_max_f32 v24, s56, v24
  v_max_f32 v25, s56, v25
  v_max_f32 v26, s56, v26
  v_max_f32 v27, s56, v27
  v_max_f32 v28, s56, v28
  v_max_f32 v29, s56, v29
  v_max_f32 v30, s56, v30
  v_max_f32 v31, s56, v31
  v_pk_add_f32 v[24:25], v[24:25], v[232:233]
  v_pk_add_f32 v[26:27], v[26:27], v[234:235]
  v_pk_add_f32 v[28:29], v[28:29], v[236:237]
  v_pk_add_f32 v[30:31], v[30:31], v[238:239]
  v_cvt_pk_bf16_f32 v164, v24, v25
  v_cvt_pk_bf16_f32 v165, v26, v27
  v_cvt_pk_bf16_f32 v166, v28, v29
  v_cvt_pk_bf16_f32 v167, v30, v31
  v_pk_mul_f32 v[232:233], v[32:33], s[50:51]
  v_pk_mul_f32 v[234:235], v[34:35], s[50:51]
  v_pk_mul_f32 v[236:237], v[36:37], s[50:51]
  v_pk_mul_f32 v[238:239], v[38:39], s[50:51]
  v_exp_f32_e64 v232, v232 clamp
  v_exp_f32_e64 v233, v233 clamp
  v_exp_f32_e64 v234, v234 clamp
  v_exp_f32_e64 v235, v235 clamp
  v_exp_f32_e64 v236, v236 clamp
  v_exp_f32_e64 v237, v237 clamp
  v_exp_f32_e64 v238, v238 clamp
  v_exp_f32_e64 v239, v239 clamp
  v_max_f32 v32, s56, v32
  v_max_f32 v33, s56, v33
  v_max_f32 v34, s56, v34
  v_max_f32 v35, s56, v35
  v_max_f32 v36, s56, v36
  v_max_f32 v37, s56, v37
  v_max_f32 v38, s56, v38
  v_max_f32 v39, s56, v39
  v_pk_add_f32 v[32:33], v[32:33], v[232:233]
  v_pk_add_f32 v[34:35], v[34:35], v[234:235]
  v_pk_add_f32 v[36:37], v[36:37], v[236:237]
  v_pk_add_f32 v[38:39], v[38:39], v[238:239]
  v_cvt_pk_bf16_f32 v168, v32, v33
  v_cvt_pk_bf16_f32 v169, v34, v35
  v_cvt_pk_bf16_f32 v170, v36, v37
  v_cvt_pk_bf16_f32 v171, v38, v39
  v_pk_mul_f32 v[232:233], v[40:41], s[50:51]
  v_pk_mul_f32 v[234:235], v[42:43], s[50:51]
  v_pk_mul_f32 v[236:237], v[44:45], s[50:51]
  v_pk_mul_f32 v[238:239], v[46:47], s[50:51]
  v_exp_f32_e64 v232, v232 clamp
  v_exp_f32_e64 v233, v233 clamp
  v_exp_f32_e64 v234, v234 clamp
  v_exp_f32_e64 v235, v235 clamp
  v_exp_f32_e64 v236, v236 clamp
  v_exp_f32_e64 v237, v237 clamp
  v_exp_f32_e64 v238, v238 clamp
  v_exp_f32_e64 v239, v239 clamp
  v_max_f32 v40, s56, v40
  v_max_f32 v41, s56, v41
  v_max_f32 v42, s56, v42
  v_max_f32 v43, s56, v43
  v_max_f32 v44, s56, v44
  v_max_f32 v45, s56, v45
  v_max_f32 v46, s56, v46
  v_max_f32 v47, s56, v47
  v_pk_add_f32 v[40:41], v[40:41], v[232:233]
  v_pk_add_f32 v[42:43], v[42:43], v[234:235]
  v_pk_add_f32 v[44:45], v[44:45], v[236:237]
  v_pk_add_f32 v[46:47], v[46:47], v[238:239]
  v_cvt_pk_bf16_f32 v172, v40, v41
  v_cvt_pk_bf16_f32 v173, v42, v43
  v_cvt_pk_bf16_f32 v174, v44, v45
  v_cvt_pk_bf16_f32 v175, v46, v47
  v_pk_mul_f32 v[232:233], v[48:49], s[50:51]
  v_pk_mul_f32 v[234:235], v[50:51], s[50:51]
  v_pk_mul_f32 v[236:237], v[52:53], s[50:51]
  v_pk_mul_f32 v[238:239], v[54:55], s[50:51]
  v_exp_f32_e64 v232, v232 clamp
  v_exp_f32_e64 v233, v233 clamp
  v_exp_f32_e64 v234, v234 clamp
  v_exp_f32_e64 v235, v235 clamp
  v_exp_f32_e64 v236, v236 clamp
  v_exp_f32_e64 v237, v237 clamp
  v_exp_f32_e64 v238, v238 clamp
  v_exp_f32_e64 v239, v239 clamp
  v_max_f32 v48, s56, v48
  v_max_f32 v49, s56, v49
  v_max_f32 v50, s56, v50
  v_max_f32 v51, s56, v51
  v_max_f32 v52, s56, v52
  v_max_f32 v53, s56, v53
  v_max_f32 v54, s56, v54
  v_max_f32 v55, s56, v55
  v_pk_add_f32 v[48:49], v[48:49], v[232:233]
  v_pk_add_f32 v[50:51], v[50:51], v[234:235]
  v_pk_add_f32 v[52:53], v[52:53], v[236:237]
  v_pk_add_f32 v[54:55], v[54:55], v[238:239]
  v_cvt_pk_bf16_f32 v176, v48, v49
  v_cvt_pk_bf16_f32 v177, v50, v51
  v_cvt_pk_bf16_f32 v178, v52, v53
  v_cvt_pk_bf16_f32 v179, v54, v55
  v_pk_mul_f32 v[232:233], v[56:57], s[50:51]
  v_pk_mul_f32 v[234:235], v[58:59], s[50:51]
  v_pk_mul_f32 v[236:237], v[60:61], s[50:51]
  v_pk_mul_f32 v[238:239], v[62:63], s[50:51]
  v_exp_f32_e64 v232, v232 clamp
  v_exp_f32_e64 v233, v233 clamp
  v_exp_f32_e64 v234, v234 clamp
  v_exp_f32_e64 v235, v235 clamp
  v_exp_f32_e64 v236, v236 clamp
  v_exp_f32_e64 v237, v237 clamp
  v_exp_f32_e64 v238, v238 clamp
  v_exp_f32_e64 v239, v239 clamp
  v_max_f32 v56, s56, v56
  v_max_f32 v57, s56, v57
  v_max_f32 v58, s56, v58
  v_max_f32 v59, s56, v59
  v_max_f32 v60, s56, v60
  v_max_f32 v61, s56, v61
  v_max_f32 v62, s56, v62
  v_max_f32 v63, s56, v63
  v_pk_add_f32 v[56:57], v[56:57], v[232:233]
  v_pk_add_f32 v[58:59], v[58:59], v[234:235]
  v_pk_add_f32 v[60:61], v[60:61], v[236:237]
  v_pk_add_f32 v[62:63], v[62:63], v[238:239]
  v_cvt_pk_bf16_f32 v180, v56, v57
  v_cvt_pk_bf16_f32 v181, v58, v59
  v_cvt_pk_bf16_f32 v182, v60, v61
  v_cvt_pk_bf16_f32 v183, v62, v63
  v_pk_mul_f32 v[232:233], v[64:65], s[50:51]
  v_pk_mul_f32 v[234:235], v[66:67], s[50:51]
  v_pk_mul_f32 v[236:237], v[68:69], s[50:51]
  v_pk_mul_f32 v[238:239], v[70:71], s[50:51]
  v_exp_f32_e64 v232, v232 clamp
  v_exp_f32_e64 v233, v233 clamp
  v_exp_f32_e64 v234, v234 clamp
  v_exp_f32_e64 v235, v235 clamp
  v_exp_f32_e64 v236, v236 clamp
  v_exp_f32_e64 v237, v237 clamp
  v_exp_f32_e64 v238, v238 clamp
  v_exp_f32_e64 v239, v239 clamp
  v_max_f32 v64, s56, v64
  v_max_f32 v65, s56, v65
  v_max_f32 v66, s56, v66
  v_max_f32 v67, s56, v67
  v_max_f32 v68, s56, v68
  v_max_f32 v69, s56, v69
  v_max_f32 v70, s56, v70
  v_max_f32 v71, s56, v71
  v_pk_add_f32 v[64:65], v[64:65], v[232:233]
  v_pk_add_f32 v[66:67], v[66:67], v[234:235]
  v_pk_add_f32 v[68:69], v[68:69], v[236:237]
  v_pk_add_f32 v[70:71], v[70:71], v[238:239]
  v_cvt_pk_bf16_f32 v184, v64, v65
  v_cvt_pk_bf16_f32 v185, v66, v67
  v_cvt_pk_bf16_f32 v186, v68, v69
  v_cvt_pk_bf16_f32 v187, v70, v71
  v_pk_mul_f32 v[232:233], v[72:73], s[50:51]
  v_pk_mul_f32 v[234:235], v[74:75], s[50:51]
  v_pk_mul_f32 v[236:237], v[76:77], s[50:51]
  v_pk_mul_f32 v[238:239], v[78:79], s[50:51]
  v_exp_f32_e64 v232, v232 clamp
  v_exp_f32_e64 v233, v233 clamp
  v_exp_f32_e64 v234, v234 clamp
  v_exp_f32_e64 v235, v235 clamp
  v_exp_f32_e64 v236, v236 clamp
  v_exp_f32_e64 v237, v237 clamp
  v_exp_f32_e64 v238, v238 clamp
  v_exp_f32_e64 v239, v239 clamp
  v_max_f32 v72, s56, v72
  v_max_f32 v73, s56, v73
  v_max_f32 v74, s56, v74
  v_max_f32 v75, s56, v75
  v_max_f32 v76, s56, v76
  v_max_f32 v77, s56, v77
  v_max_f32 v78, s56, v78
  v_max_f32 v79, s56, v79
  v_pk_add_f32 v[72:73], v[72:73], v[232:233]
  v_pk_add_f32 v[74:75], v[74:75], v[234:235]
  v_pk_add_f32 v[76:77], v[76:77], v[236:237]
  v_pk_add_f32 v[78:79], v[78:79], v[238:239]
  v_cvt_pk_bf16_f32 v188, v72, v73
  v_cvt_pk_bf16_f32 v189, v74, v75
  v_cvt_pk_bf16_f32 v190, v76, v77
  v_cvt_pk_bf16_f32 v191, v78, v79
  v_pk_mul_f32 v[232:233], v[80:81], s[50:51]
  v_pk_mul_f32 v[234:235], v[82:83], s[50:51]
  v_pk_mul_f32 v[236:237], v[84:85], s[50:51]
  v_pk_mul_f32 v[238:239], v[86:87], s[50:51]
  v_exp_f32_e64 v232, v232 clamp
  v_exp_f32_e64 v233, v233 clamp
  v_exp_f32_e64 v234, v234 clamp
  v_exp_f32_e64 v235, v235 clamp
  v_exp_f32_e64 v236, v236 clamp
  v_exp_f32_e64 v237, v237 clamp
  v_exp_f32_e64 v238, v238 clamp
  v_exp_f32_e64 v239, v239 clamp
  v_max_f32 v80, s56, v80
  v_max_f32 v81, s56, v81
  v_max_f32 v82, s56, v82
  v_max_f32 v83, s56, v83
  v_max_f32 v84, s56, v84
  v_max_f32 v85, s56, v85
  v_max_f32 v86, s56, v86
  v_max_f32 v87, s56, v87
  v_pk_add_f32 v[80:81], v[80:81], v[232:233]
  v_pk_add_f32 v[82:83], v[82:83], v[234:235]
  v_pk_add_f32 v[84:85], v[84:85], v[236:237]
  v_pk_add_f32 v[86:87], v[86:87], v[238:239]
  v_cvt_pk_bf16_f32 v192, v80, v81
  v_cvt_pk_bf16_f32 v193, v82, v83
  v_cvt_pk_bf16_f32 v194, v84, v85
  v_cvt_pk_bf16_f32 v195, v86, v87
  v_cvt_pk_bf16_f32 v196, v88, v89
  v_cvt_pk_bf16_f32 v197, v90, v91
  v_cvt_pk_bf16_f32 v198, v92, v93
  v_cvt_pk_bf16_f32 v199, v94, v95
  v_cvt_pk_bf16_f32 v200, v96, v97
  v_cvt_pk_bf16_f32 v201, v98, v99
  v_cvt_pk_bf16_f32 v202, v100, v101
  v_cvt_pk_bf16_f32 v203, v102, v103
  v_cvt_pk_bf16_f32 v204, v104, v105
  v_cvt_pk_bf16_f32 v205, v106, v107
  v_cvt_pk_bf16_f32 v206, v108, v109
  v_cvt_pk_bf16_f32 v207, v110, v111
  v_cvt_pk_bf16_f32 v208, v112, v113
  v_cvt_pk_bf16_f32 v209, v114, v115
  v_cvt_pk_bf16_f32 v210, v116, v117
  v_cvt_pk_bf16_f32 v211, v118, v119
  v_cvt_pk_bf16_f32 v212, v120, v121
  v_cvt_pk_bf16_f32 v213, v122, v123
  v_cvt_pk_bf16_f32 v214, v124, v125
  v_cvt_pk_bf16_f32 v215, v126, v127
  v_cvt_pk_bf16_f32 v216, v128, v129
  v_cvt_pk_bf16_f32 v217, v130, v131
  v_cvt_pk_bf16_f32 v218, v132, v133
  v_cvt_pk_bf16_f32 v219, v134, v135
  v_cvt_pk_bf16_f32 v220, v136, v137
  v_cvt_pk_bf16_f32 v221, v138, v139
  v_cvt_pk_bf16_f32 v222, v140, v141
  v_cvt_pk_bf16_f32 v223, v142, v143
  v_cvt_pk_bf16_f32 v224, v144, v145
  v_cvt_pk_bf16_f32 v225, v146, v147
  v_cvt_pk_bf16_f32 v226, v148, v149
  v_cvt_pk_bf16_f32 v227, v150, v151
  v_cvt_pk_bf16_f32 v228, v152, v153
  v_cvt_pk_bf16_f32 v229, v154, v155
  v_cvt_pk_bf16_f32 v230, v156, v157
  v_cvt_pk_bf16_f32 v231, v158, v159
  v_mov_b32 v232, 0x3f803f80
  v_mov_b32 v233, 0x3f803f80
  v_mov_b32 v234, 0x3f803f80
  v_mov_b32 v235, 0x3f803f80
  s_mul_i32 s34, s33, 26624
  v_lshlrev_b32 v2, 4, v1
  v_add_u32 v2, s34, v2
  v_lshlrev_b32 v3, 2, v1
  v_add_u32 v3, s34, v3
  v_mfma_f32_16x16x32_bf16 v[116:119], v[232:235], v[160:163], 0
  v_mfma_f32_16x16x32_bf16 v[120:123], v[232:235], v[164:167], 0
  v_mfma_f32_16x16x32_bf16 v[124:127], v[232:235], v[168:171], 0
  v_mfma_f32_16x16x32_bf16 v[128:131], v[232:235], v[172:175], 0
  v_mfma_f32_16x16x32_bf16 v[132:135], v[232:235], v[176:179], 0
  v_mfma_f32_16x16x32_bf16 v[136:139], v[232:235], v[180:183], 0
  v_mfma_f32_16x16x32_bf16 v[140:143], v[232:235], v[184:187], 0
  v_mfma_f32_16x16x32_bf16 v[144:147], v[232:235], v[188:191], 0
  v_mfma_f32_16x16x32_bf16 v[148:151], v[232:235], v[192:195], 0
  s_mov_b64 exec, 0xffff
  ds_write_b32 v3, v116 offset:25600
  s_mov_b64 exec, -1
  v_mfma_f32_16x16x32_bf16 v[16:19], v[160:163], v[196:199], 0
  s_mov_b64 exec, 0xffff
  ds_write_b32 v3, v120 offset:25664
  s_mov_b64 exec, -1
  v_mfma_f32_16x16x32_bf16 v[20:23], v[160:163], v[200:203], 0
  s_mov_b64 exec, 0xffff
  ds_write_b32 v3, v124 offset:25728
  s_mov_b64 exec, -1
  v_mfma_f32_16x16x32_bf16 v[24:27], v[164:167], v[196:199], 0
  s_mov_b64 exec, 0xffff
  ds_write_b32 v3, v128 offset:25792
  s_mov_b64 exec, -1
  v_mfma_f32_16x16x32_bf16 v[28:31], v[164:167], v[200:203], 0
  s_mov_b64 exec, 0xffff
  ds_write_b32 v3, v132 offset:25856
  s_mov_b64 exec, -1
  v_mfma_f32_16x16x32_bf16 v[32:35], v[164:167], v[204:207], 0
  s_mov_b64 exec, 0xffff
  ds_write_b32 v3, v136 offset:25920
  s_mov_b64 exec, -1
  v_mfma_f32_16x16x32_bf16 v[36:39], v[168:171], v[200:203], 0
  s_mov_b64 exec, 0xffff
  ds_write_b32 v3, v140 offset:25984
  s_mov_b64 exec, -1
  v_mfma_f32_16x16x32_bf16 v[40:43], v[168:171], v[204:207], 0
  s_mov_b64 exec, 0xffff
  ds_write_b32 v3, v144 offset:26048
  s_mov_b64 exec, -1
  v_mfma_f32_16x16x32_bf16 v[44:47], v[168:171], v[208:211], 0
  s_mov_b64 exec, 0xffff
  ds_write_b32 v3, v148 offset:26112
  s_mov_b64 exec, -1
  v_mfma_f32_16x16x32_bf16 v[48:51], v[172:175], v[204:207], 0
  ds_write_b128 v2, v[16:19] offset:0
  v_mfma_f32_16x16x32_bf16 v[52:55], v[172:175], v[208:211], 0
  ds_write_b128 v2, v[20:23] offset:1024
  v_mfma_f32_16x16x32_bf16 v[56:59], v[172:175], v[212:215], 0
  ds_write_b128 v2, v[24:27] offset:2048
  v_mfma_f32_16x16x32_bf16 v[60:63], v[176:179], v[208:211], 0
  ds_write_b128 v2, v[28:31] offset:3072
  v_mfma_f32_16x16x32_bf16 v[64:67], v[176:179], v[212:215], 0
  ds_write_b128 v2, v[32:35] offset:4096
  v_mfma_f32_16x16x32_bf16 v[68:71], v[176:179], v[216:219], 0
  ds_write_b128 v2, v[36:39] offset:5120
  v_mfma_f32_16x16x32_bf16 v[72:75], v[180:183], v[212:215], 0
  ds_write_b128 v2, v[40:43] offset:6144
  v_mfma_f32_16x16x32_bf16 v[76:79], v[180:183], v[216:219], 0
  ds_write_b128 v2, v[44:47] offset:7168
  v_mfma_f32_16x16x32_bf16 v[80:83], v[180:183], v[220:223], 0
  ds_write_b128 v2, v[48:51] offset:8192
  v_mfma_f32_16x16x32_bf16 v[84:87], v[184:187], v[216:219], 0
  ds_write_b128 v2, v[52:55] offset:9216
  v_mfma_f32_16x16x32_bf16 v[88:91], v[184:187], v[220:223], 0
  ds_write_b128 v2, v[56:59] offset:10240
  v_mfma_f32_16x16x32_bf16 v[92:95], v[184:187], v[224:227], 0
  ds_write_b128 v2, v[60:63] offset:11264
  v_mfma_f32_16x16x32_bf16 v[96:99], v[188:191], v[220:223], 0
  ds_write_b128 v2, v[64:67] offset:12288
  v_mfma_f32_16x16x32_bf16 v[100:103], v[188:191], v[224:227], 0
  ds_write_b128 v2, v[68:71] offset:13312
  v_mfma_f32_16x16x32_bf16 v[104:107], v[188:191], v[228:231], 0
  ds_write_b128 v2, v[72:75] offset:14336
  v_mfma_f32_16x16x32_bf16 v[108:111], v[192:195], v[224:227], 0
  ds_write_b128 v2, v[76:79] offset:15360
  v_mfma_f32_16x16x32_bf16 v[112:115], v[192:195], v[228:231], 0
  ds_write_b128 v2, v[80:83] offset:16384
  s_nop 7
  ds_write_b128 v2, v[84:87] offset:17408
  ds_write_b128 v2, v[88:91] offset:18432
  ds_write_b128 v2, v[92:95] offset:19456
  ds_write_b128 v2, v[96:99] offset:20480
  ds_write_b128 v2, v[100:103] offset:21504
  ds_write_b128 v2, v[104:107] offset:22528
  ds_write_b128 v2, v[108:111] offset:23552
  ds_write_b128 v2, v[112:115] offset:24576
  s_waitcnt lgkmcnt(0)
  s_barrier
  v_mov_b32 v200, v244
  v_mov_b32 v201, v245
  v_mov_b32 v202, v246
  v_mov_b32 v203, v247
  v_mov_b32 v204, v248
  v_mov_b32 v205, v249
  v_mov_b32 v206, v250
  s_branch L_qfin_47
L_a_load:
  s_load_dwordx4 s[8:11], s[0:1], 8
  s_and_b32 s28, s99, 7
  s_lshr_b32 s29, s99, 3
  s_mov_b32 s30, s100
  v_and_b32 v1, 63, v0
  s_lshr_b32 s31, s28, 1
  s_and_b32 s32, s28, 1
  s_lshl_b32 s32, s32, 3
  s_add_u32 s32, s32, s29
  s_mov_b32 s50, 0x3fb8aa3b
  s_mov_b32 s51, 0x3fb8aa3b
  s_mov_b32 s56, 0x358637bd
  s_and_b32 s33, s30, 3
  v_and_b32 v2, 15, v1
  v_lshrrev_b32 v3, 4, v1
  v_lshrrev_b32 v4, 2, v2
  v_lshlrev_b32 v5, 11, v3
  v_lshl_add_u32 v10, v2, 4, v5
  s_lshl_b32 s34, s33, 9
  v_add_u32 v10, s34, v10
  v_lshl_add_u32 v4, v3, 2, v4
  v_mul_u32_u24 v4, 288, v4
  v_and_b32 v5, 3, v2
  v_lshl_add_u32 v4, v5, 3, v4
  v_add_u32 v11, 8192, v4
  s_add_u32 s12, s76, 0
  s_addc_u32 s13, s77, 0
  s_and_b32 s13, s13, 0xffff
  s_mov_b32 s14, 2359296
  s_mov_b32 s15, 0x20000
  s_add_u32 s24, s76, 10027008
  s_addc_u32 s25, s77, 0
  s_and_b32 s25, s25, 0xffff
  s_mov_b32 s26, 51200
  s_mov_b32 s27, 0x20000
  v_lshlrev_b32 v20, 4, v1
  s_lshl_b32 s34, s33, 15
  v_add_u32 v20, s34, v20
  s_mul_i32 s52, s33, 7
  s_mov_b32 s38, 238609295
  s_add_u32 s35, s52, 0
  s_min_u32 s35, s35, 26
  s_mov_b32 s37, 477218589
  s_mul_hi_u32 s36, s35, s37
  s_mul_i32 s37, s36, 9
  s_sub_u32 s37, s35, s37
  s_lshl_b32 s37, s37, 6
  v_add_u32 v3, s37, v1
  v_mul_hi_u32 v4, v3, s38
  v_mul_u32_u24 v4, 3168, v4
  v_lshl_add_u32 v4, v3, 4, v4
  s_mul_i32 s36, s36, 1152
  v_add_u32 v21, s36, v4
  s_add_u32 s35, s52, 1
  s_min_u32 s35, s35, 26
  s_mov_b32 s37, 477218589
  s_mul_hi_u32 s36, s35, s37
  s_mul_i32 s37, s36, 9
  s_sub_u32 s37, s35, s37
  s_lshl_b32 s37, s37, 6
  v_add_u32 v3, s37, v1
  v_mul_hi_u32 v4, v3, s38
  v_mul_u32_u24 v4, 3168, v4
  v_lshl_add_u32 v4, v3, 4, v4
  s_mul_i32 s36, s36, 1152
  v_add_u32 v22, s36, v4
  s_add_u32 s35, s52, 2
  s_min_u32 s35, s35, 26
  s_mov_b32 s37, 477218589
  s_mul_hi_u32 s36, s35, s37
  s_mul_i32 s37, s36, 9
  s_sub_u32 s37, s35, s37
  s_lshl_b32 s37, s37, 6
  v_add_u32 v3, s37, v1
  v_mul_hi_u32 v4, v3, s38
  v_mul_u32_u24 v4, 3168, v4
  v_lshl_add_u32 v4, v3, 4, v4
  s_mul_i32 s36, s36, 1152
  v_add_u32 v23, s36, v4
  s_add_u32 s35, s52, 3
  s_min_u32 s35, s35, 26
  s_mov_b32 s37, 477218589
  s_mul_hi_u32 s36, s35, s37
  s_mul_i32 s37, s36, 9
  s_sub_u32 s37, s35, s37
  s_lshl_b32 s37, s37, 6
  v_add_u32 v3, s37, v1
  v_mul_hi_u32 v4, v3, s38
  v_mul_u32_u24 v4, 3168, v4
  v_lshl_add_u32 v4, v3, 4, v4
  s_mul_i32 s36, s36, 1152
  v_add_u32 v24, s36, v4
  s_add_u32 s35, s52, 4
  s_min_u32 s35, s35, 26
  s_mov_b32 s37, 477218589
  s_mul_hi_u32 s36, s35, s37
  s_mul_i32 s37, s36, 9
  s_sub_u32 s37, s35, s37
  s_lshl_b32 s37, s37, 6
  v_add_u32 v3, s37, v1
  v_mul_hi_u32 v4, v3, s38
  v_mul_u32_u24 v4, 3168, v4
  v_lshl_add_u32 v4, v3, 4, v4
  s_mul_i32 s36, s36, 1152
  v_add_u32 v25, s36, v4
  s_add_u32 s35, s52, 5
  s_min_u32 s35, s35, 26
  s_mov_b32 s37, 477218589
  s_mul_hi_u32 s36, s35, s37
  s_mul_i32 s37, s36, 9
  s_sub_u32 s37, s35, s37
  s_lshl_b32 s37, s37, 6
  v_add_u32 v3, s37, v1
  v_mul_hi_u32 v4, v3, s38
  v_mul_u32_u24 v4, 3168, v4
  v_lshl_add_u32 v4, v3, 4, v4
  s_mul_i32 s36, s36, 1152
  v_add_u32 v26, s36, v4
  s_add_u32 s35, s52, 6
  s_min_u32 s35, s35, 26
  s_mov_b32 s37, 477218589
  s_mul_hi_u32 s36, s35, s37
  s_mul_i32 s37, s36, 9
  s_sub_u32 s37, s35, s37
  s_lshl_b32 s37, s37, 6
  v_add_u32 v3, s37, v1
  v_mul_hi_u32 v4, v3, s38
  v_mul_u32_u24 v4, 3168, v4
  v_lshl_add_u32 v4, v3, 4, v4
  s_mul_i32 s36, s36, 1152
  v_add_u32 v27, s36, v4
  s_lshl_b32 s53, s33, 11
  s_lshl_b32 s54, s52, 10
  s_add_u32 s54, s54, 8192
  s_lshl_b32 s55, s35, 10
  s_add_u32 s55, s55, 8192
  s_lshl_b32 s45, s32, 11
  s_mul_i32 s46, s31, 288
  s_mov_b32 s40, 0
  s_mov_b32 s41, 0
  s_waitcnt lgkmcnt(0)
  s_add_u32 s98, s98, 1
  s_mov_b32 s16, s8
  s_and_b32 s17, s9, 0xffff
  s_mov_b32 s18, 1990656
  s_mov_b32 s19, 0x20000
  s_add_u32 m0, s41, s54
  s_add_u32 s42, s41, s54
  buffer_load_dwordx4 v21, s[16:19], s46 offen lds
  s_add_u32 m0, s42, 1024
  s_nop 0
  buffer_load_dwordx4 v22, s[16:19], s46 offen lds
  s_add_u32 m0, s42, 2048
  s_nop 0
  buffer_load_dwordx4 v23, s[16:19], s46 offen lds
  s_add_u32 m0, s42, 3072
  s_nop 0
  buffer_load_dwordx4 v24, s[16:19], s46 offen lds
  s_add_u32 m0, s42, 4096
  s_nop 0
  buffer_load_dwordx4 v25, s[16:19], s46 offen lds
  s_add_u32 m0, s42, 5120
  s_nop 0
  buffer_load_dwordx4 v26, s[16:19], s46 offen lds
  s_add_u32 m0, s41, s55
  s_add_u32 s40, s40, 1
  buffer_load_dwordx4 v27, s[16:19], s46 offen lds
  s_add_u32 s41, s41, 35840
  s_cmp_eq_u32 s41, 143360
  s_cselect_b32 s41, 0, s41
  s_add_u32 s45, s45, 131072
  s_add_u32 s46, s46, 110592
  s_cmp_ge_u32 s40, 18
  s_cselect_b32 s45, 0x7ff00000, s45
  s_cselect_b32 s46, 0x7ff00000, s46
  s_barrier
  s_barrier
  v_mov_b32 v29, 2147483632
  v_mov_b32 v19, 256
  s_add_u32 m0, s41, s54
  s_add_u32 s42, s41, s54
  buffer_load_dwordx4 v21, s[16:19], s46 offen lds
  s_add_u32 m0, s42, 1024
  s_nop 0
  buffer_load_dwordx4 v22, s[16:19], s46 offen lds
  s_add_u32 m0, s42, 2048
  s_nop 0
  buffer_load_dwordx4 v23, s[16:19], s46 offen lds
  s_add_u32 m0, s42, 3072
  s_nop 0
  buffer_load_dwordx4 v24, s[16:19], s46 offen lds
  s_add_u32 m0, s42, 4096
  s_nop 0
  buffer_load_dwordx4 v25, s[16:19], s46 offen lds
  s_add_u32 m0, s42, 5120
  s_nop 0
  buffer_load_dwordx4 v26, s[16:19], s46 offen lds
  s_add_u32 m0, s41, s55
  s_add_u32 s40, s40, 1
  buffer_load_dwordx4 v27, s[16:19], s46 offen lds
  s_add_u32 s41, s41, 35840
  s_cmp_eq_u32 s41, 143360
  s_cselect_b32 s41, 0, s41
  s_add_u32 s45, s45, 131072
  s_add_u32 s46, s46, 110592
  s_cmp_ge_u32 s40, 18
  s_cselect_b32 s45, 0x7ff00000, s45
  s_cselect_b32 s46, 0x7ff00000, s46
  s_add_u32 m0, s41, s54
  s_add_u32 s42, s41, s54
  buffer_load_dwordx4 v21, s[16:19], s46 offen lds
  s_add_u32 m0, s42, 1024
  s_nop 0
  buffer_load_dwordx4 v22, s[16:19], s46 offen lds
  s_add_u32 m0, s42, 2048
  s_nop 0
  buffer_load_dwordx4 v23, s[16:19], s46 offen lds
  s_add_u32 m0, s42, 3072
  s_nop 0
  buffer_load_dwordx4 v24, s[16:19], s46 offen lds
  s_add_u32 m0, s42, 4096
  s_nop 0
  buffer_load_dwordx4 v25, s[16:19], s46 offen lds
  s_add_u32 m0, s42, 5120
  s_nop 0
  buffer_load_dwordx4 v26, s[16:19], s46 offen lds
  s_add_u32 m0, s41, s55
  s_add_u32 s40, s40, 1
  buffer_load_dwordx4 v27, s[16:19], s46 offen lds
  s_add_u32 s41, s41, 35840
  s_cmp_eq_u32 s41, 143360
  s_cselect_b32 s41, 0, s41
  s_add_u32 s45, s45, 131072
  s_add_u32 s46, s46, 110592
  s_cmp_ge_u32 s40, 18
  s_cselect_b32 s45, 0x7ff00000, s45
  s_cselect_b32 s46, 0x7ff00000, s46
  s_cmp_lg_u32 s30, 4
  s_cbranch_scc1 L_qw4_50
  v_lshrrev_b32 v3, 1, v1
  v_and_b32 v8, 1, v1
  v_lshlrev_b32 v3, 7, v3
  v_lshl_add_u32 v3, v8, 4, v3
  v_add_u32 v8, 57344, v3
  s_mov_b32 exec_lo, -1
  s_mov_b32 exec_hi, -1
  s_mov_b32 s78, 0
L_poll_52:
  buffer_load_dwordx4 v[4:7], v8, s[72:75], 0 offen sc1
  s_add_u32 s78, s78, 1
  s_waitcnt vmcnt(0)
  v_xor_b32 v4, s98, v4
  v_xor_b32 v5, s98, v5
  v_xor_b32 v6, s98, v6
  v_xor_b32 v7, s98, v7
  v_or_b32 v4, v4, v5
  v_or_b32 v4, v4, v6
  v_or_b32 v4, v4, v7
  v_cmp_ne_u32 vcc, 0, v4
  s_cmp_gt_u32 s78, 60000
  s_cbranch_scc1 L_poll_52_x
  s_cmp_eq_u64 vcc, 0
  s_cbranch_scc1 L_poll_52_x
  s_sleep 2
  s_branch L_poll_52
L_poll_52_x:
  s_mov_b64 exec, -1
  s_cmp_lg_u32 s99, 0
  s_cbranch_scc1 L_qw4_50
  s_mov_b32 s34, 69632
  v_mov_b32 v3, s34
  v_mov_b32 v4, s98
  s_mov_b64 exec, 1
  buffer_store_dword v4, v3, s[72:75], 0 offen sc1
  s_mov_b64 exec, -1
L_qw4_50:
  s_barrier
  s_add_u32 m0, s53, 0
  s_sub_u32 s34, s45, 393216
  buffer_load_dwordx4 v20, s[12:15], s34 offen sc1 lds
  buffer_load_dwordx4 v20, s[12:15], s34 offen offset:1024 sc1 lds
  s_add_u32 m0, s53, 35840
  s_sub_u32 s34, s45, 262144
  buffer_load_dwordx4 v20, s[12:15], s34 offen sc1 lds
  buffer_load_dwordx4 v20, s[12:15], s34 offen offset:1024 sc1 lds
  s_add_u32 m0, s53, 71680
  s_sub_u32 s34, s45, 131072
  buffer_load_dwordx4 v20, s[12:15], s34 offen sc1 lds
  buffer_load_dwordx4 v20, s[12:15], s34 offen offset:1024 sc1 lds
  s_getpc_b64 s[60:61]
L_pc_53:
  s_add_u32 s60, s60, L_tab_gather-L_pc_53
  s_addc_u32 s61, s61, 0
  s_add_u32 s62, s60, L_tab_pq-L_tab_gather
  s_addc_u32 s63, s61, 0
  s_mul_i32 s35, s32, 171
  s_sub_u32 s35, s35, 256
  v_add_u32 v18, s35, v0
  v_cmp_gt_u32 vcc, 432, v0
  v_mov_b32 v4, 2736
  v_add_u32 v2, 0, v18
  v_subrev_u32 v3, 2736, v2
  v_min_u32 v2, v2, v3
  v_lshlrev_b32 v2, 3, v2
  global_load_dwordx2 v[160:161], v2, s[60:61]
  v_add_u32 v2, 256, v18
  v_subrev_u32 v3, 2736, v2
  v_min_u32 v2, v2, v3
  v_lshlrev_b32 v2, 3, v2
  global_load_dwordx2 v[162:163], v2, s[60:61]
  v_add_u32 v2, 512, v18
  v_subrev_u32 v3, 2736, v2
  v_min_u32 v2, v2, v3
  v_lshlrev_b32 v2, 3, v2
  global_load_dwordx2 v[164:165], v2, s[60:61]
  v_add_u32 v2, 768, v18
  v_subrev_u32 v3, 2736, v2
  v_min_u32 v2, v2, v3
  v_lshlrev_b32 v2, 3, v2
  global_load_dwordx2 v[166:167], v2, s[60:61]
  v_add_u32 v2, 1024, v18
  v_subrev_u32 v3, 2736, v2
  v_min_u32 v2, v2, v3
  v_lshlrev_b32 v2, 3, v2
  global_load_dwordx2 v[168:169], v2, s[60:61]
  v_add_u32 v2, 1280, v18
  v_subrev_u32 v3, 2736, v2
  v_min_u32 v2, v2, v3
  v_lshlrev_b32 v2, 3, v2
  global_load_dwordx2 v[170:171], v2, s[60:61]
  v_add_u32 v2, 1536, v18
  v_subrev_u32 v3, 2736, v2
  v_min_u32 v2, v2, v3
  v_lshlrev_b32 v2, 3, v2
  global_load_dwordx2 v[172:173], v2, s[60:61]
  v_add_u32 v2, 1792, v18
  v_subrev_u32 v3, 2736, v2
  v_min_u32 v2, v2, v3
  v_lshlrev_b32 v2, 3, v2
  global_load_dwordx2 v[174:175], v2, s[60:61]
  v_add_u32 v2, 2048, v18
  v_subrev_u32 v3, 2736, v2
  v_min_u32 v2, v2, v3
  v_lshlrev_b32 v2, 3, v2
  global_load_dwordx2 v[176:177], v2, s[60:61]
  v_add_u32 v2, 2304, v18
  v_subrev_u32 v3, 2736, v2
  v_min_u32 v2, v2, v3
  v_lshlrev_b32 v2, 3, v2
  global_load_dwordx2 v[178:179], v2, s[60:61]
  v_add_u32 v2, 2560, v18
  v_subrev_u32 v3, 2736, v2
  v_min_u32 v2, v2, v3
  v_cndmask_b32 v2, v4, v2, vcc
  v_lshlrev_b32 v2, 3, v2
  global_load_dwordx2 v[180:181], v2, s[60:61]
  s_mul_i32 s35, s33, 5120
  v_lshlrev_b32 v2, 4, v1
  v_add_u32 v2, s35, v2
  global_load_dwordx4 v[240:243], v2, s[62:63] offset:0
  global_load_dwordx4 v[244:247], v2, s[62:63] offset:1024
  global_load_dwordx4 v[248:251], v2, s[62:63] offset:2048
  global_load_dwordx4 v[252:255], v2, s[62:63] offset:3072
  v_add_u32 v2, 4096, v2
  global_load_dwordx2 v[228:229], v2, s[62:63]
  s_getpc_b64 s[62:63]
L_pc_54:
  s_add_u32 s62, s62, L_tab_wo-L_pc_54
  s_addc_u32 s63, s63, 0
  s_lshl_b32 s35, s30, 11
  v_lshlrev_b32 v2, 4, v1
  v_add_u32 v2, s35, v2
  global_load_dwordx4 v[182:185], v2, s[62:63]
  global_load_dwordx4 v[186:189], v2, s[62:63] offset:1024
  s_mul_i32 s34, s29, 648
  s_sub_u32 s34, s34, 256
  s_mul_i32 s36, s31, 288
  s_and_b32 s36, s36, 0xffffff80
  s_mov_b32 s37, 477218589
  s_mov_b32 s39, 1431655766
  v_mov_b32 v29, 2147483632
  s_mov_b32 s60, s10
  s_and_b32 s61, s11, 0xffff
  s_mov_b32 s62, 663552
  s_mov_b32 s63, 0x20000
  v_subrev_u32 v3, 256, v0
  v_lshlrev_b32 v4, 7, v3
  v_cmp_gt_u32 vcc, 81, v3
  s_lshl_b32 s34, s28, 3
  s_add_u32 s34, s34, s29
  s_mul_i32 s34, s34, 10368
  v_cndmask_b32 v4, v29, v4, vcc
  buffer_load_dword v28, v4, s[60:63], s34 offen
  s_setprio 1
  s_mov_b32 s44, 0
  s_waitcnt vmcnt(23)
  s_barrier
  v_add_u32 v13, s44, v10
  v_add_u32 v14, s44, v11
  s_add_u32 s44, s44, 35840
  s_cmp_eq_u32 s44, 143360
  s_cselect_b32 s44, 0, s44
  ds_read_b128 v[104:107], v13 offset:0
  ds_read_b128 v[108:111], v13 offset:256
  ds_read_b64_tr_b16 v[120:121], v14 offset:0
  ds_read_b64_tr_b16 v[122:123], v14 offset:4608
  ds_read_b64_tr_b16 v[124:125], v14 offset:32
  ds_read_b64_tr_b16 v[126:127], v14 offset:4640
  ds_read_b64_tr_b16 v[128:129], v14 offset:64
  ds_read_b64_tr_b16 v[130:131], v14 offset:4672
  ds_read_b64_tr_b16 v[132:133], v14 offset:96
  ds_read_b64_tr_b16 v[134:135], v14 offset:4704
  ds_read_b64_tr_b16 v[136:137], v14 offset:128
  ds_read_b64_tr_b16 v[138:139], v14 offset:4736
  s_waitcnt lgkmcnt(8)
  v_mfma_f32_16x16x32_bf16 v[32:35], v[120:123], v[104:107], 0
  ds_read_b64_tr_b16 v[140:141], v14 offset:160
  v_mfma_f32_16x16x32_bf16 v[36:39], v[120:123], v[108:111], 0
  ds_read_b64_tr_b16 v[142:143], v14 offset:4768
  s_waitcnt lgkmcnt(8)
  v_mfma_f32_16x16x32_bf16 v[40:43], v[124:127], v[104:107], 0
  ds_read_b64_tr_b16 v[144:145], v14 offset:192
  v_mfma_f32_16x16x32_bf16 v[44:47], v[124:127], v[108:111], 0
  ds_read_b64_tr_b16 v[146:147], v14 offset:4800
  s_waitcnt lgkmcnt(8)
  v_mfma_f32_16x16x32_bf16 v[48:51], v[128:131], v[104:107], 0
  ds_read_b64_tr_b16 v[148:149], v14 offset:224
  v_mfma_f32_16x16x32_bf16 v[52:55], v[128:131], v[108:111], 0
  ds_read_b64_tr_b16 v[150:151], v14 offset:4832
  s_waitcnt lgkmcnt(8)
  v_mfma_f32_16x16x32_bf16 v[56:59], v[132:135], v[104:107], 0
  ds_read_b64_tr_b16 v[152:153], v14 offset:256
  v_mfma_f32_16x16x32_bf16 v[60:63], v[132:135], v[108:111], 0
  ds_read_b64_tr_b16 v[154:155], v14 offset:4864
  s_waitcnt vmcnt(21)
  s_barrier
  v_add_u32 v13, s44, v10
  v_add_u32 v14, s44, v11
  s_add_u32 s44, s44, 35840
  s_cmp_eq_u32 s44, 143360
  s_cselect_b32 s44, 0, s44
  s_waitcnt lgkmcnt(8)
  v_mfma_f32_16x16x32_bf16 v[64:67], v[136:139], v[104:107], 0
  ds_read_b128 v[112:115], v13 offset:0
  ds_read_b128 v[116:119], v13 offset:256
  v_mfma_f32_16x16x32_bf16 v[68:71], v[136:139], v[108:111], 0
  ds_read_b64_tr_b16 v[120:121], v14 offset:0
  ds_read_b64_tr_b16 v[122:123], v14 offset:4608
  s_add_u32 m0, s41, s53
  s_nop 0
  buffer_load_dwordx4 v20, s[12:15], s45 offen sc1 lds
  s_waitcnt lgkmcnt(10)
  v_mfma_f32_16x16x32_bf16 v[72:75], v[140:143], v[104:107], 0
  ds_read_b64_tr_b16 v[124:125], v14 offset:32
  v_mfma_f32_16x16x32_bf16 v[76:79], v[140:143], v[108:111], 0
  ds_read_b64_tr_b16 v[126:127], v14 offset:4640
  buffer_load_dwordx4 v20, s[12:15], s45 offen offset:1024 sc1 lds
  s_waitcnt lgkmcnt(10)
  v_mfma_f32_16x16x32_bf16 v[80:83], v[144:147], v[104:107], 0
  ds_read_b64_tr_b16 v[128:129], v14 offset:64
  v_mfma_f32_16x16x32_bf16 v[84:87], v[144:147], v[108:111], 0
  ds_read_b64_tr_b16 v[130:131], v14 offset:4672
  s_add_u32 m0, s41, s54
  s_add_u32 s42, s41, s54
  buffer_load_dwordx4 v21, s[16:19], s46 offen lds
  s_waitcnt lgkmcnt(10)
  v_mfma_f32_16x16x32_bf16 v[88:91], v[148:151], v[104:107], 0
  ds_read_b64_tr_b16 v[132:133], v14 offset:96
  v_mfma_f32_16x16x32_bf16 v[92:95], v[148:151], v[108:111], 0
  ds_read_b64_tr_b16 v[134:135], v14 offset:4704
  s_add_u32 m0, s42, 1024
  s_nop 0
  buffer_load_dwordx4 v22, s[16:19], s46 offen lds
  s_waitcnt lgkmcnt(10)
  v_mfma_f32_16x16x32_bf16 v[96:99], v[152:155], v[104:107], 0
  ds_read_b64_tr_b16 v[136:137], v14 offset:128
  v_mfma_f32_16x16x32_bf16 v[100:103], v[152:155], v[108:111], 0
  ds_read_b64_tr_b16 v[138:139], v14 offset:4736
  s_add_u32 m0, s42, 2048
  s_nop 0
  buffer_load_dwordx4 v23, s[16:19], s46 offen lds
  s_mov_b32 s47, 0
L_q_cr_55:
  s_waitcnt lgkmcnt(8)
  v_mfma_f32_16x16x32_bf16 v[32:35], v[120:123], v[112:115], v[32:35]
  ds_read_b64_tr_b16 v[140:141], v14 offset:160
  v_mfma_f32_16x16x32_bf16 v[36:39], v[120:123], v[116:119], v[36:39]
  ds_read_b64_tr_b16 v[142:143], v14 offset:4768
  s_add_u32 m0, s42, 3072
  s_nop 0
  buffer_load_dwordx4 v24, s[16:19], s46 offen lds
  s_waitcnt lgkmcnt(8)
  v_mfma_f32_16x16x32_bf16 v[40:43], v[124:127], v[112:115], v[40:43]
  ds_read_b64_tr_b16 v[144:145], v14 offset:192
  v_mfma_f32_16x16x32_bf16 v[44:47], v[124:127], v[116:119], v[44:47]
  ds_read_b64_tr_b16 v[146:147], v14 offset:4800
  s_add_u32 m0, s42, 4096
  s_nop 0
  buffer_load_dwordx4 v25, s[16:19], s46 offen lds
  s_waitcnt lgkmcnt(8)
  v_mfma_f32_16x16x32_bf16 v[48:51], v[128:131], v[112:115], v[48:51]
  ds_read_b64_tr_b16 v[148:149], v14 offset:224
  v_mfma_f32_16x16x32_bf16 v[52:55], v[128:131], v[116:119], v[52:55]
  ds_read_b64_tr_b16 v[150:151], v14 offset:4832
  s_add_u32 m0, s42, 5120
  s_nop 0
  buffer_load_dwordx4 v26, s[16:19], s46 offen lds
  s_waitcnt lgkmcnt(8)
  v_mfma_f32_16x16x32_bf16 v[56:59], v[132:135], v[112:115], v[56:59]
  ds_read_b64_tr_b16 v[152:153], v14 offset:256
  v_mfma_f32_16x16x32_bf16 v[60:63], v[132:135], v[116:119], v[60:63]
  ds_read_b64_tr_b16 v[154:155], v14 offset:4864
  s_add_u32 m0, s41, s55
  s_add_u32 s40, s40, 1
  buffer_load_dwordx4 v27, s[16:19], s46 offen lds
  s_add_u32 s41, s41, 35840
  s_cmp_eq_u32 s41, 143360
  s_cselect_b32 s41, 0, s41
  s_add_u32 s45, s45, 131072
  s_add_u32 s46, s46, 110592
  s_cmp_ge_u32 s40, 18
  s_cselect_b32 s45, 0x7ff00000, s45
  s_cselect_b32 s46, 0x7ff00000, s46
  s_waitcnt vmcnt(9)
  s_barrier
  v_add_u32 v13, s44, v10
  v_add_u32 v14, s44, v11
  s_add_u32 s44, s44, 35840
  s_cmp_eq_u32 s44, 143360
  s_cselect_b32 s44, 0, s44
  s_waitcnt lgkmcnt(8)
  v_mfma_f32_16x16x32_bf16 v[64:67], v[136:139], v[112:115], v[64:67]
  ds_read_b128 v[104:107], v13 offset:0
  ds_read_b128 v[108:111], v13 offset:256
  v_mfma_f32_16x16x32_bf16 v[68:71], v[136:139], v[116:119], v[68:71]
  ds_read_b64_tr_b16 v[120:121], v14 offset:0
  ds_read_b64_tr_b16 v[122:123], v14 offset:4608
  s_add_u32 m0, s41, s53
  s_nop 0
  buffer_load_dwordx4 v20, s[12:15], s45 offen sc1 lds
  s_waitcnt lgkmcnt(10)
  v_mfma_f32_16x16x32_bf16 v[72:75], v[140:143], v[112:115], v[72:75]
  ds_read_b64_tr_b16 v[124:125], v14 offset:32
  v_mfma_f32_16x16x32_bf16 v[76:79], v[140:143], v[116:119], v[76:79]
  ds_read_b64_tr_b16 v[126:127], v14 offset:4640
  buffer_load_dwordx4 v20, s[12:15], s45 offen offset:1024 sc1 lds
  s_waitcnt lgkmcnt(10)
  v_mfma_f32_16x16x32_bf16 v[80:83], v[144:147], v[112:115], v[80:83]
  ds_read_b64_tr_b16 v[128:129], v14 offset:64
  v_mfma_f32_16x16x32_bf16 v[84:87], v[144:147], v[116:119], v[84:87]
  ds_read_b64_tr_b16 v[130:131], v14 offset:4672
  s_add_u32 m0, s41, s54
  s_add_u32 s42, s41, s54
  buffer_load_dwordx4 v21, s[16:19], s46 offen lds
  s_waitcnt lgkmcnt(10)
  v_mfma_f32_16x16x32_bf16 v[88:91], v[148:151], v[112:115], v[88:91]
  ds_read_b64_tr_b16 v[132:133], v14 offset:96
  v_mfma_f32_16x16x32_bf16 v[92:95], v[148:151], v[116:119], v[92:95]
  ds_read_b64_tr_b16 v[134:135], v14 offset:4704
  s_add_u32 m0, s42, 1024
  s_nop 0
  buffer_load_dwordx4 v22, s[16:19], s46 offen lds
  s_waitcnt lgkmcnt(10)
  v_mfma_f32_16x16x32_bf16 v[96:99], v[152:155], v[112:115], v[96:99]
  ds_read_b64_tr_b16 v[136:137], v14 offset:128
  v_mfma_f32_16x16x32_bf16 v[100:103], v[152:155], v[116:119], v[100:103]
  ds_read_b64_tr_b16 v[138:139], v14 offset:4736
  s_add_u32 m0, s42, 2048
  s_nop 0
  buffer_load_dwordx4 v23, s[16:19], s46 offen lds
  s_waitcnt lgkmcnt(8)
  v_mfma_f32_16x16x32_bf16 v[32:35], v[120:123], v[104:107], v[32:35]
  ds_read_b64_tr_b16 v[140:141], v14 offset:160
  v_mfma_f32_16x16x32_bf16 v[36:39], v[120:123], v[108:111], v[36:39]
  ds_read_b64_tr_b16 v[142:143], v14 offset:4768
  s_add_u32 m0, s42, 3072
  s_nop 0
  buffer_load_dwordx4 v24, s[16:19], s46 offen lds
  s_waitcnt lgkmcnt(8)
  v_mfma_f32_16x16x32_bf16 v[40:43], v[124:127], v[104:107], v[40:43]
  ds_read_b64_tr_b16 v[144:145], v14 offset:192
  v_mfma_f32_16x16x32_bf16 v[44:47], v[124:127], v[108:111], v[44:47]
  ds_read_b64_tr_b16 v[146:147], v14 offset:4800
  s_add_u32 m0, s42, 4096
  s_nop 0
  buffer_load_dwordx4 v25, s[16:19], s46 offen lds
  s_waitcnt lgkmcnt(8)
  v_mfma_f32_16x16x32_bf16 v[48:51], v[128:131], v[104:107], v[48:51]
  ds_read_b64_tr_b16 v[148:149], v14 offset:224
  v_mfma_f32_16x16x32_bf16 v[52:55], v[128:131], v[108:111], v[52:55]
  ds_read_b64_tr_b16 v[150:151], v14 offset:4832
  s_add_u32 m0, s42, 5120
  s_nop 0
  buffer_load_dwordx4 v26, s[16:19], s46 offen lds
  s_waitcnt lgkmcnt(8)
  v_mfma_f32_16x16x32_bf16 v[56:59], v[132:135], v[104:107], v[56:59]
  ds_read_b64_tr_b16 v[152:153], v14 offset:256
  v_mfma_f32_16x16x32_bf16 v[60:63], v[132:135], v[108:111], v[60:63]
  ds_read_b64_tr_b16 v[154:155], v14 offset:4864
  s_add_u32 m0, s41, s55
  s_add_u32 s40, s40, 1
  buffer_load_dwordx4 v27, s[16:19], s46 offen lds
  s_add_u32 s41, s41, 35840
  s_cmp_eq_u32 s41, 143360
  s_cselect_b32 s41, 0, s41
  s_add_u32 s45, s45, 131072
  s_add_u32 s46, s46, 110592
  s_cmp_ge_u32 s40, 18
  s_cselect_b32 s45, 0x7ff00000, s45
  s_cselect_b32 s46, 0x7ff00000, s46
  s_waitcnt vmcnt(9)
  s_barrier
  v_add_u32 v13, s44, v10
  v_add_u32 v14, s44, v11
  s_add_u32 s44, s44, 35840
  s_cmp_eq_u32 s44, 143360
  s_cselect_b32 s44, 0, s44
  s_waitcnt lgkmcnt(8)
  v_mfma_f32_16x16x32_bf16 v[64:67], v[136:139], v[104:107], v[64:67]
  ds_read_b128 v[112:115], v13 offset:0
  ds_read_b128 v[116:119], v13 offset:256
  v_mfma_f32_16x16x32_bf16 v[68:71], v[136:139], v[108:111], v[68:71]
  ds_read_b64_tr_b16 v[120:121], v14 offset:0
  ds_read_b64_tr_b16 v[122:123], v14 offset:4608
  s_add_u32 m0, s41, s53
  s_nop 0
  buffer_load_dwordx4 v20, s[12:15], s45 offen sc1 lds
  s_waitcnt lgkmcnt(10)
  v_mfma_f32_16x16x32_bf16 v[72:75], v[140:143], v[104:107], v[72:75]
  ds_read_b64_tr_b16 v[124:125], v14 offset:32
  v_mfma_f32_16x16x32_bf16 v[76:79], v[140:143], v[108:111], v[76:79]
  ds_read_b64_tr_b16 v[126:127], v14 offset:4640
  buffer_load_dwordx4 v20, s[12:15], s45 offen offset:1024 sc1 lds
  s_waitcnt lgkmcnt(10)
  v_mfma_f32_16x16x32_bf16 v[80:83], v[144:147], v[104:107], v[80:83]
  ds_read_b64_tr_b16 v[128:129], v14 offset:64
  v_mfma_f32_16x16x32_bf16 v[84:87], v[144:147], v[108:111], v[84:87]
  ds_read_b64_tr_b16 v[130:131], v14 offset:4672
  s_add_u32 m0, s41, s54
  s_add_u32 s42, s41, s54
  buffer_load_dwordx4 v21, s[16:19], s46 offen lds
  s_waitcnt lgkmcnt(10)
  v_mfma_f32_16x16x32_bf16 v[88:91], v[148:151], v[104:107], v[88:91]
  ds_read_b64_tr_b16 v[132:133], v14 offset:96
  v_mfma_f32_16x16x32_bf16 v[92:95], v[148:151], v[108:111], v[92:95]
  ds_read_b64_tr_b16 v[134:135], v14 offset:4704
  s_add_u32 m0, s42, 1024
  s_nop 0
  buffer_load_dwordx4 v22, s[16:19], s46 offen lds
  s_waitcnt lgkmcnt(10)
  v_mfma_f32_16x16x32_bf16 v[96:99], v[152:155], v[104:107], v[96:99]
  ds_read_b64_tr_b16 v[136:137], v14 offset:128
  v_mfma_f32_16x16x32_bf16 v[100:103], v[152:155], v[108:111], v[100:103]
  ds_read_b64_tr_b16 v[138:139], v14 offset:4736
  s_add_u32 m0, s42, 2048
  s_nop 0
  buffer_load_dwordx4 v23, s[16:19], s46 offen lds
  s_add_u32 s47, s47, 1
  s_cmp_lt_u32 s47, 8
  s_cbranch_scc1 L_q_cr_55
  s_waitcnt lgkmcnt(8)
  v_mfma_f32_16x16x32_bf16 v[32:35], v[120:123], v[112:115], v[32:35]
  ds_read_b64_tr_b16 v[140:141], v14 offset:160
  v_mfma_f32_16x16x32_bf16 v[36:39], v[120:123], v[116:119], v[36:39]
  ds_read_b64_tr_b16 v[142:143], v14 offset:4768
  s_waitcnt lgkmcnt(8)
  v_mfma_f32_16x16x32_bf16 v[40:43], v[124:127], v[112:115], v[40:43]
  ds_read_b64_tr_b16 v[144:145], v14 offset:192
  v_mfma_f32_16x16x32_bf16 v[44:47], v[124:127], v[116:119], v[44:47]
  ds_read_b64_tr_b16 v[146:147], v14 offset:4800
  s_waitcnt lgkmcnt(8)
  v_mfma_f32_16x16x32_bf16 v[48:51], v[128:131], v[112:115], v[48:51]
  ds_read_b64_tr_b16 v[148:149], v14 offset:224
  v_mfma_f32_16x16x32_bf16 v[52:55], v[128:131], v[116:119], v[52:55]
  ds_read_b64_tr_b16 v[150:151], v14 offset:4832
  s_waitcnt lgkmcnt(8)
  v_mfma_f32_16x16x32_bf16 v[56:59], v[132:135], v[112:115], v[56:59]
  ds_read_b64_tr_b16 v[152:153], v14 offset:256
  v_mfma_f32_16x16x32_bf16 v[60:63], v[132:135], v[116:119], v[60:63]
  ds_read_b64_tr_b16 v[154:155], v14 offset:4864
  s_barrier
  s_waitcnt lgkmcnt(8)
  v_mfma_f32_16x16x32_bf16 v[64:67], v[136:139], v[112:115], v[64:67]
  v_mfma_f32_16x16x32_bf16 v[68:71], v[136:139], v[116:119], v[68:71]
  s_waitcnt lgkmcnt(6)
  v_mfma_f32_16x16x32_bf16 v[72:75], v[140:143], v[112:115], v[72:75]
  v_mfma_f32_16x16x32_bf16 v[76:79], v[140:143], v[116:119], v[76:79]
  s_waitcnt lgkmcnt(4)
  v_mfma_f32_16x16x32_bf16 v[80:83], v[144:147], v[112:115], v[80:83]
  v_mfma_f32_16x16x32_bf16 v[84:87], v[144:147], v[116:119], v[84:87]
  s_waitcnt lgkmcnt(2)
  v_mfma_f32_16x16x32_bf16 v[88:91], v[148:151], v[112:115], v[88:91]
  v_mfma_f32_16x16x32_bf16 v[92:95], v[148:151], v[116:119], v[92:95]
  s_waitcnt lgkmcnt(0)
  v_mfma_f32_16x16x32_bf16 v[96:99], v[152:155], v[112:115], v[96:99]
  v_mfma_f32_16x16x32_bf16 v[100:103], v[152:155], v[116:119], v[100:103]
  s_setprio 0
  s_waitcnt vmcnt(0)
  s_barrier
  v_pk_mul_f32 v[232:233], v[32:33], s[50:51]
  v_pk_mul_f32 v[234:235], v[34:35], s[50:51]
  v_pk_mul_f32 v[236:237], v[36:37], s[50:51]
  v_pk_mul_f32 v[238:239], v[38:39], s[50:51]
  v_exp_f32_e64 v232, v232 clamp
  v_exp_f32_e64 v233, v233 clamp
  v_exp_f32_e64 v234, v234 clamp
  v_exp_f32_e64 v235, v235 clamp
  v_exp_f32_e64 v236, v236 clamp
  v_exp_f32_e64 v237, v237 clamp
  v_exp_f32_e64 v238, v238 clamp
  v_exp_f32_e64 v239, v239 clamp
  v_max_f32 v32, s56, v32
  v_max_f32 v33, s56, v33
  v_max_f32 v34, s56, v34
  v_max_f32 v35, s56, v35
  v_max_f32 v36, s56, v36
  v_max_f32 v37, s56, v37
  v_max_f32 v38, s56, v38
  v_max_f32 v39, s56, v39
  v_pk_add_f32 v[32:33], v[32:33], v[232:233]
  v_pk_add_f32 v[34:35], v[34:35], v[234:235]
  v_pk_add_f32 v[36:37], v[36:37], v[236:237]
  v_pk_add_f32 v[38:39], v[38:39], v[238:239]
  v_cvt_pk_bf16_f32 v192, v32, v33
  v_cvt_pk_bf16_f32 v193, v34, v35
  v_cvt_pk_bf16_f32 v194, v36, v37
  v_cvt_pk_bf16_f32 v195, v38, v39
  ds_write_b32 v240, v192 offset:0
  ds_write_b32 v241, v193 offset:0
  ds_write_b32 v240, v194 offset:4864
  ds_write_b32 v241, v195 offset:4864
  v_pk_mul_f32 v[232:233], v[40:41], s[50:51]
  v_pk_mul_f32 v[234:235], v[42:43], s[50:51]
  v_pk_mul_f32 v[236:237], v[44:45], s[50:51]
  v_pk_mul_f32 v[238:239], v[46:47], s[50:51]
  v_exp_f32_e64 v232, v232 clamp
  v_exp_f32_e64 v233, v233 clamp
  v_exp_f32_e64 v234, v234 clamp
  v_exp_f32_e64 v235, v235 clamp
  v_exp_f32_e64 v236, v236 clamp
  v_exp_f32_e64 v237, v237 clamp
  v_exp_f32_e64 v238, v238 clamp
  v_exp_f32_e64 v239, v239 clamp
  v_max_f32 v40, s56, v40
  v_max_f32 v41, s56, v41
  v_max_f32 v42, s56, v42
  v_max_f32 v43, s56, v43
  v_max_f32 v44, s56, v44
  v_max_f32 v45, s56, v45
  v_max_f32 v46, s56, v46
  v_max_f32 v47, s56, v47
  v_pk_add_f32 v[40:41], v[40:41], v[232:233]
  v_pk_add_f32 v[42:43], v[42:43], v[234:235]
  v_pk_add_f32 v[44:45], v[44:45], v[236:237]
  v_pk_add_f32 v[46:47], v[46:47], v[238:239]
  v_cvt_pk_bf16_f32 v196, v40, v41
  v_cvt_pk_bf16_f32 v197, v42, v43
  v_cvt_pk_bf16_f32 v198, v44, v45
  v_cvt_pk_bf16_f32 v199, v46, v47
  ds_write_b32 v242, v196 offset:0
  ds_write_b32 v243, v197 offset:0
  ds_write_b32 v242, v198 offset:4864
  ds_write_b32 v243, v199 offset:4864
  v_pk_mul_f32 v[232:233], v[48:49], s[50:51]
  v_pk_mul_f32 v[234:235], v[50:51], s[50:51]
  v_pk_mul_f32 v[236:237], v[52:53], s[50:51]
  v_pk_mul_f32 v[238:239], v[54:55], s[50:51]
  v_exp_f32_e64 v232, v232 clamp
  v_exp_f32_e64 v233, v233 clamp
  v_exp_f32_e64 v234, v234 clamp
  v_exp_f32_e64 v235, v235 clamp
  v_exp_f32_e64 v236, v236 clamp
  v_exp_f32_e64 v237, v237 clamp
  v_exp_f32_e64 v238, v238 clamp
  v_exp_f32_e64 v239, v239 clamp
  v_max_f32 v48, s56, v48
  v_max_f32 v49, s56, v49
  v_max_f32 v50, s56, v50
  v_max_f32 v51, s56, v51
  v_max_f32 v52, s56, v52
  v_max_f32 v53, s56, v53
  v_max_f32 v54, s56, v54
  v_max_f32 v55, s56, v55
  v_pk_add_f32 v[48:49], v[48:49], v[232:233]
  v_pk_add_f32 v[50:51], v[50:51], v[234:235]
  v_pk_add_f32 v[52:53], v[52:53], v[236:237]
  v_pk_add_f32 v[54:55], v[54:55], v[238:239]
  v_cvt_pk_bf16_f32 v200, v48, v49
  v_cvt_pk_bf16_f32 v201, v50, v51
  v_cvt_pk_bf16_f32 v202, v52, v53
  v_cvt_pk_bf16_f32 v203, v54, v55
  ds_write_b32 v244, v200 offset:0
  ds_write_b32 v245, v201 offset:0
  ds_write_b32 v244, v202 offset:4864
  ds_write_b32 v245, v203 offset:4864
  v_pk_mul_f32 v[232:233], v[56:57], s[50:51]
  v_pk_mul_f32 v[234:235], v[58:59], s[50:51]
  v_pk_mul_f32 v[236:237], v[60:61], s[50:51]
  v_pk_mul_f32 v[238:239], v[62:63], s[50:51]
  v_exp_f32_e64 v232, v232 clamp
  v_exp_f32_e64 v233, v233 clamp
  v_exp_f32_e64 v234, v234 clamp
  v_exp_f32_e64 v235, v235 clamp
  v_exp_f32_e64 v236, v236 clamp
  v_exp_f32_e64 v237, v237 clamp
  v_exp_f32_e64 v238, v238 clamp
  v_exp_f32_e64 v239, v239 clamp
  v_max_f32 v56, s56, v56
  v_max_f32 v57, s56, v57
  v_max_f32 v58, s56, v58
  v_max_f32 v59, s56, v59
  v_max_f32 v60, s56, v60
  v_max_f32 v61, s56, v61
  v_max_f32 v62, s56, v62
  v_max_f32 v63, s56, v63
  v_pk_add_f32 v[56:57], v[56:57], v[232:233]
  v_pk_add_f32 v[58:59], v[58:59], v[234:235]
  v_pk_add_f32 v[60:61], v[60:61], v[236:237]
  v_pk_add_f32 v[62:63], v[62:63], v[238:239]
  v_cvt_pk_bf16_f32 v204, v56, v57
  v_cvt_pk_bf16_f32 v205, v58, v59
  v_cvt_pk_bf16_f32 v206, v60, v61
  v_cvt_pk_bf16_f32 v207, v62, v63
  ds_write_b32 v246, v204 offset:0
  ds_write_b32 v247, v205 offset:0
  ds_write_b32 v246, v206 offset:4864
  ds_write_b32 v247, v207 offset:4864
  v_pk_mul_f32 v[232:233], v[64:65], s[50:51]
  v_pk_mul_f32 v[234:235], v[66:67], s[50:51]
  v_pk_mul_f32 v[236:237], v[68:69], s[50:51]
  v_pk_mul_f32 v[238:239], v[70:71], s[50:51]
  v_exp_f32_e64 v232, v232 clamp
  v_exp_f32_e64 v233, v233 clamp
  v_exp_f32_e64 v234, v234 clamp
  v_exp_f32_e64 v235, v235 clamp
  v_exp_f32_e64 v236, v236 clamp
  v_exp_f32_e64 v237, v237 clamp
  v_exp_f32_e64 v238, v238 clamp
  v_exp_f32_e64 v239, v239 clamp
  v_max_f32 v64, s56, v64
  v_max_f32 v65, s56, v65
  v_max_f32 v66, s56, v66
  v_max_f32 v67, s56, v67
  v_max_f32 v68, s56, v68
  v_max_f32 v69, s56, v69
  v_max_f32 v70, s56, v70
  v_max_f32 v71, s56, v71
  v_pk_add_f32 v[64:65], v[64:65], v[232:233]
  v_pk_add_f32 v[66:67], v[66:67], v[234:235]
  v_pk_add_f32 v[68:69], v[68:69], v[236:237]
  v_pk_add_f32 v[70:71], v[70:71], v[238:239]
  v_cvt_pk_bf16_f32 v208, v64, v65
  v_cvt_pk_bf16_f32 v209, v66, v67
  v_cvt_pk_bf16_f32 v210, v68, v69
  v_cvt_pk_bf16_f32 v211, v70, v71
  ds_write_b32 v248, v208 offset:0
  ds_write_b32 v249, v209 offset:0
  ds_write_b32 v248, v210 offset:4864
  ds_write_b32 v249, v211 offset:4864
  v_pk_mul_f32 v[232:233], v[72:73], s[50:51]
  v_pk_mul_f32 v[234:235], v[74:75], s[50:51]
  v_pk_mul_f32 v[236:237], v[76:77], s[50:51]
  v_pk_mul_f32 v[238:239], v[78:79], s[50:51]
  v_exp_f32_e64 v232, v232 clamp
  v_exp_f32_e64 v233, v233 clamp
  v_exp_f32_e64 v234, v234 clamp
  v_exp_f32_e64 v235, v235 clamp
  v_exp_f32_e64 v236, v236 clamp
  v_exp_f32_e64 v237, v237 clamp
  v_exp_f32_e64 v238, v238 clamp
  v_exp_f32_e64 v239, v239 clamp
  v_max_f32 v72, s56, v72
  v_max_f32 v73, s56, v73
  v_max_f32 v74, s56, v74
  v_max_f32 v75, s56, v75
  v_max_f32 v76, s56, v76
  v_max_f32 v77, s56, v77
  v_max_f32 v78, s56, v78
  v_max_f32 v79, s56, v79
  v_pk_add_f32 v[72:73], v[72:73], v[232:233]
  v_pk_add_f32 v[74:75], v[74:75], v[234:235]
  v_pk_add_f32 v[76:77], v[76:77], v[236:237]
  v_pk_add_f32 v[78:79], v[78:79], v[238:239]
  v_cvt_pk_bf16_f32 v212, v72, v73
  v_cvt_pk_bf16_f32 v213, v74, v75
  v_cvt_pk_bf16_f32 v214, v76, v77
  v_cvt_pk_bf16_f32 v215, v78, v79
  ds_write_b32 v250, v212 offset:0
  ds_write_b32 v251, v213 offset:0
  ds_write_b32 v250, v214 offset:4864
  ds_write_b32 v251, v215 offset:4864
  v_pk_mul_f32 v[232:233], v[80:81], s[50:51]
  v_pk_mul_f32 v[234:235], v[82:83], s[50:51]
  v_pk_mul_f32 v[236:237], v[84:85], s[50:51]
  v_pk_mul_f32 v[238:239], v[86:87], s[50:51]
  v_exp_f32_e64 v232, v232 clamp
  v_exp_f32_e64 v233, v233 clamp
  v_exp_f32_e64 v234, v234 clamp
  v_exp_f32_e64 v235, v235 clamp
  v_exp_f32_e64 v236, v236 clamp
  v_exp_f32_e64 v237, v237 clamp
  v_exp_f32_e64 v238, v238 clamp
  v_exp_f32_e64 v239, v239 clamp
  v_max_f32 v80, s56, v80
  v_max_f32 v81, s56, v81
  v_max_f32 v82, s56, v82
  v_max_f32 v83, s56, v83
  v_max_f32 v84, s56, v84
  v_max_f32 v85, s56, v85
  v_max_f32 v86, s56, v86
  v_max_f32 v87, s56, v87
  v_pk_add_f32 v[80:81], v[80:81], v[232:233]
  v_pk_add_f32 v[82:83], v[82:83], v[234:235]
  v_pk_add_f32 v[84:85], v[84:85], v[236:237]
  v_pk_add_f32 v[86:87], v[86:87], v[238:239]
  v_cvt_pk_bf16_f32 v216, v80, v81
  v_cvt_pk_bf16_f32 v217, v82, v83
  v_cvt_pk_bf16_f32 v218, v84, v85
  v_cvt_pk_bf16_f32 v219, v86, v87
  ds_write_b32 v252, v216 offset:0
  ds_write_b32 v253, v217 offset:0
  ds_write_b32 v252, v218 offset:4864
  ds_write_b32 v253, v219 offset:4864
  v_pk_mul_f32 v[232:233], v[88:89], s[50:51]
  v_pk_mul_f32 v[234:235], v[90:91], s[50:51]
  v_pk_mul_f32 v[236:237], v[92:93], s[50:51]
  v_pk_mul_f32 v[238:239], v[94:95], s[50:51]
  v_exp_f32_e64 v232, v232 clamp
  v_exp_f32_e64 v233, v233 clamp
  v_exp_f32_e64 v234, v234 clamp
  v_exp_f32_e64 v235, v235 clamp
  v_exp_f32_e64 v236, v236 clamp
  v_exp_f32_e64 v237, v237 clamp
  v_exp_f32_e64 v238, v238 clamp
  v_exp_f32_e64 v239, v239 clamp
  v_max_f32 v88, s56, v88
  v_max_f32 v89, s56, v89
  v_max_f32 v90, s56, v90
  v_max_f32 v91, s56, v91
  v_max_f32 v92, s56, v92
  v_max_f32 v93, s56, v93
  v_max_f32 v94, s56, v94
  v_max_f32 v95, s56, v95
  v_pk_add_f32 v[88:89], v[88:89], v[232:233]
  v_pk_add_f32 v[90:91], v[90:91], v[234:235]
  v_pk_add_f32 v[92:93], v[92:93], v[236:237]
  v_pk_add_f32 v[94:95], v[94:95], v[238:239]
  v_cvt_pk_bf16_f32 v220, v88, v89
  v_cvt_pk_bf16_f32 v221, v90, v91
  v_cvt_pk_bf16_f32 v222, v92, v93
  v_cvt_pk_bf16_f32 v223, v94, v95
  ds_write_b32 v254, v220 offset:0
  ds_write_b32 v255, v221 offset:0
  ds_write_b32 v254, v222 offset:4864
  ds_write_b32 v255, v223 offset:4864
  v_pk_mul_f32 v[232:233], v[96:97], s[50:51]
  v_pk_mul_f32 v[234:235], v[98:99], s[50:51]
  v_pk_mul_f32 v[236:237], v[100:101], s[50:51]
  v_pk_mul_f32 v[238:239], v[102:103], s[50:51]
  v_exp_f32_e64 v232, v232 clamp
  v_exp_f32_e64 v233, v233 clamp
  v_exp_f32_e64 v234, v234 clamp
  v_exp_f32_e64 v235, v235 clamp
  v_exp_f32_e64 v236, v236 clamp
  v_exp_f32_e64 v237, v237 clamp
  v_exp_f32_e64 v238, v238 clamp
  v_exp_f32_e64 v239, v239 clamp
  v_max_f32 v96, s56, v96
  v_max_f32 v97, s56, v97
  v_max_f32 v98, s56, v98
  v_max_f32 v99, s56, v99
  v_max_f32 v100, s56, v100
  v_max_f32 v101, s56, v101
  v_max_f32 v102, s56, v102
  v_max_f32 v103, s56, v103
  v_pk_add_f32 v[96:97], v[96:97], v[232:233]
  v_pk_add_f32 v[98:99], v[98:99], v[234:235]
  v_pk_add_f32 v[100:101], v[100:101], v[236:237]
  v_pk_add_f32 v[102:103], v[102:103], v[238:239]
  v_cvt_pk_bf16_f32 v224, v96, v97
  v_cvt_pk_bf16_f32 v225, v98, v99
  v_cvt_pk_bf16_f32 v226, v100, v101
  v_cvt_pk_bf16_f32 v227, v102, v103
  ds_write_b32 v228, v224 offset:0
  ds_write_b32 v229, v225 offset:0
  ds_write_b32 v228, v226 offset:4864
  ds_write_b32 v229, v227 offset:4864
  s_mul_i32 s34, s31, 12800
  s_waitcnt lgkmcnt(0)
  s_barrier
  v_add_u32 v17, 53248, v160
  ds_read_b32 v32, v160
  ds_read_b32 v33, v160 offset:26624
  ds_read_b32 v34, v17
  ds_read_b32 v35, v17 offset:26624
  v_add_u32 v17, 53248, v162
  ds_read_b32 v36, v162
  ds_read_b32 v37, v162 offset:26624
  ds_read_b32 v38, v17
  ds_read_b32 v39, v17 offset:26624
  v_add_u32 v17, 53248, v164
  ds_read_b32 v40, v164
  ds_read_b32 v41, v164 offset:26624
  ds_read_b32 v42, v17
  ds_read_b32 v43, v17 offset:26624
  s_waitcnt lgkmcnt(8)
  v_add_f32 v32, v32, v33
  v_add_f32 v34, v34, v35
  v_add_f32 v48, v32, v34
  buffer_atomic_add_f32 v48, v161, s[24:27], s34 offen
  s_waitcnt lgkmcnt(4)
  v_add_f32 v36, v36, v37
  v_add_f32 v38, v38, v39
  v_add_f32 v49, v36, v38
  buffer_atomic_add_f32 v49, v163, s[24:27], s34 offen
  s_waitcnt lgkmcnt(0)
  v_add_f32 v40, v40, v41
  v_add_f32 v42, v42, v43
  v_add_f32 v50, v40, v42
  buffer_atomic_add_f32 v50, v165, s[24:27], s34 offen
  v_add_u32 v17, 53248, v166
  ds_read_b32 v32, v166
  ds_read_b32 v33, v166 offset:26624
  ds_read_b32 v34, v17
  ds_read_b32 v35, v17 offset:26624
  v_add_u32 v17, 53248, v168
  ds_read_b32 v36, v168
  ds_read_b32 v37, v168 offset:26624
  ds_read_b32 v38, v17
  ds_read_b32 v39, v17 offset:26624
  v_add_u32 v17, 53248, v170
  ds_read_b32 v40, v170
  ds_read_b32 v41, v170 offset:26624
  ds_read_b32 v42, v17
  ds_read_b32 v43, v17 offset:26624
  s_waitcnt lgkmcnt(8)
  v_add_f32 v32, v32, v33
  v_add_f32 v34, v34, v35
  v_add_f32 v51, v32, v34
  buffer_atomic_add_f32 v51, v167, s[24:27], s34 offen
  s_waitcnt lgkmcnt(4)
  v_add_f32 v36, v36, v37
  v_add_f32 v38, v38, v39
  v_add_f32 v52, v36, v38
  buffer_atomic_add_f32 v52, v169, s[24:27], s34 offen
  s_waitcnt lgkmcnt(0)
  v_add_f32 v40, v40, v41
  v_add_f32 v42, v42, v43
  v_add_f32 v53, v40, v42
  buffer_atomic_add_f32 v53, v171, s[24:27], s34 offen
  v_add_u32 v17, 53248, v172
  ds_read_b32 v32, v172
  ds_read_b32 v33, v172 offset:26624
  ds_read_b32 v34, v17
  ds_read_b32 v35, v17 offset:26624
  v_add_u32 v17, 53248, v174
  ds_read_b32 v36, v174
  ds_read_b32 v37, v174 offset:26624
  ds_read_b32 v38, v17
  ds_read_b32 v39, v17 offset:26624
  v_add_u32 v17, 53248, v176
  ds_read_b32 v40, v176
  ds_read_b32 v41, v176 offset:26624
  ds_read_b32 v42, v17
  ds_read_b32 v43, v17 offset:26624
  s_waitcnt lgkmcnt(8)
  v_add_f32 v32, v32, v33
  v_add_f32 v34, v34, v35
  v_add_f32 v54, v32, v34
  buffer_atomic_add_f32 v54, v173, s[24:27], s34 offen
  s_waitcnt lgkmcnt(4)
  v_add_f32 v36, v36, v37
  v_add_f32 v38, v38, v39
  v_add_f32 v55, v36, v38
  buffer_atomic_add_f32 v55, v175, s[24:27], s34 offen
  s_waitcnt lgkmcnt(0)
  v_add_f32 v40, v40, v41
  v_add_f32 v42, v42, v43
  v_add_f32 v56, v40, v42
  buffer_atomic_add_f32 v56, v177, s[24:27], s34 offen
  v_add_u32 v17, 53248, v178
  ds_read_b32 v32, v178
  ds_read_b32 v33, v178 offset:26624
  ds_read_b32 v34, v17
  ds_read_b32 v35, v17 offset:26624
  v_add_u32 v17, 53248, v180
  ds_read_b32 v36, v180
  ds_read_b32 v37, v180 offset:26624
  ds_read_b32 v38, v17
  ds_read_b32 v39, v17 offset:26624
  s_waitcnt lgkmcnt(4)
  v_add_f32 v32, v32, v33
  v_add_f32 v34, v34, v35
  v_add_f32 v57, v32, v34
  buffer_atomic_add_f32 v57, v179, s[24:27], s34 offen
  s_waitcnt lgkmcnt(0)
  v_add_f32 v36, v36, v37
  v_add_f32 v38, v38, v39
  v_add_f32 v58, v36, v38
  buffer_atomic_add_f32 v58, v181, s[24:27], s34 offen
  v_mov_b32 v200, v182
  v_mov_b32 v201, v183
  v_mov_b32 v202, v184
  v_mov_b32 v203, v185
  v_mov_b32 v204, v186
  v_mov_b32 v205, v187
  v_mov_b32 v206, v188
  s_lshl_b32 s79, s31, 11
  s_lshl_b32 s34, s32, 7
  s_add_u32 s79, s79, s34
  s_lshl_b32 s34, s33, 2
  s_add_u32 s79, s79, s34
  s_add_u32 s79, s79, 73728
L_qfin_47:
  s_barrier
L_at_4:
  s_load_dwordx2 s[10:11], s[0:1], 16
  s_waitcnt lgkmcnt(0)
  s_mov_b32 s16, s10
  s_and_b32 s17, s11, 0xffff
  s_mov_b32 s18, 663552
  s_mov_b32 s19, 0x20000
  s_cmp_ge_u32 s30, 4
  s_cbranch_scc1 L_atq_56
  s_waitcnt vmcnt(0)
  s_lshl_b32 s34, s30, 10
  s_mul_i32 s35, s31, 165888
  s_add_u32 m0, s34, 0
  s_nop 0
  buffer_load_dwordx4 v200, s[16:19], s35 offen lds
  s_add_u32 m0, s34, 8192
  s_nop 0
  buffer_load_dwordx4 v201, s[16:19], s35 offen lds
  s_add_u32 m0, s34, 16384
  s_nop 0
  buffer_load_dwordx4 v202, s[16:19], s35 offen lds
  s_add_u32 m0, s34, 24576
  s_nop 0
  buffer_load_dwordx4 v203, s[16:19], s35 offen lds
  s_add_u32 m0, s34, 32768
  s_nop 0
  buffer_load_dwordx4 v204, s[16:19], s35 offen lds
  s_add_u32 m0, s34, 40960
  s_nop 0
  buffer_load_dwordx4 v205, s[16:19], s35 offen lds
  s_cmp_ge_u32 s30, 6
  s_cbranch_scc1 L_wg_59
  s_add_u32 m0, s34, 49152
  s_nop 0
  buffer_load_dwordx4 v206, s[16:19], s35 offen lds
L_wg_59:
  s_lshl_b32 s34, s30, 10
  s_mul_i32 s35, s31, 165888
  s_add_u32 s35, s35, 384
  s_add_u32 m0, s34, 55296
  s_nop 0
  buffer_load_dwordx4 v200, s[16:19], s35 offen lds
  s_add_u32 m0, s34, 63488
  s_nop 0
  buffer_load_dwordx4 v201, s[16:19], s35 offen lds
  s_add_u32 m0, s34, 71680
  s_nop 0
  buffer_load_dwordx4 v202, s[16:19], s35 offen lds
  s_add_u32 m0, s34, 79872
  s_nop 0
  buffer_load_dwordx4 v203, s[16:19], s35 offen lds
  s_add_u32 m0, s34, 88064
  s_nop 0
  buffer_load_dwordx4 v204, s[16:19], s35 offen lds
  s_add_u32 m0, s34, 96256
  s_nop 0
  buffer_load_dwordx4 v205, s[16:19], s35 offen lds
  s_cmp_ge_u32 s30, 6
  s_cbranch_scc1 L_wg_60
  s_add_u32 m0, s34, 104448
  s_nop 0
  buffer_load_dwordx4 v206, s[16:19], s35 offen lds
L_wg_60:
  s_barrier
  s_barrier
  s_branch L_atj_57
L_atq_56:
  s_waitcnt vmcnt(0)
  v_mov_b32 v3, s79
  v_mov_b32 v4, s98
  s_mov_b64 exec, 1
  buffer_store_dword v4, v3, s[72:75], 0 offen sc1
  s_mov_b64 exec, -1
  s_lshl_b32 s34, s30, 10
  s_mul_i32 s35, s31, 165888
  s_add_u32 m0, s34, 0
  s_nop 0
  buffer_load_dwordx4 v200, s[16:19], s35 offen lds
  s_add_u32 m0, s34, 8192
  s_nop 0
  buffer_load_dwordx4 v201, s[16:19], s35 offen lds
  s_add_u32 m0, s34, 16384
  s_nop 0
  buffer_load_dwordx4 v202, s[16:19], s35 offen lds
  s_add_u32 m0, s34, 24576
  s_nop 0
  buffer_load_dwordx4 v203, s[16:19], s35 offen lds
  s_add_u32 m0, s34, 32768
  s_nop 0
  buffer_load_dwordx4 v204, s[16:19], s35 offen lds
  s_add_u32 m0, s34, 40960
  s_nop 0
  buffer_load_dwordx4 v205, s[16:19], s35 offen lds
  s_cmp_ge_u32 s30, 6
  s_cbranch_scc1 L_wg_61
  s_add_u32 m0, s34, 49152
  s_nop 0
  buffer_load_dwordx4 v206, s[16:19], s35 offen lds
L_wg_61:
  s_lshl_b32 s34, s30, 10
  s_mul_i32 s35, s31, 165888
  s_add_u32 s35, s35, 384
  s_add_u32 m0, s34, 55296
  s_nop 0
  buffer_load_dwordx4 v200, s[16:19], s35 offen lds
  s_add_u32 m0, s34, 63488
  s_nop 0
  buffer_load_dwordx4 v201, s[16:19], s35 offen lds
  s_add_u32 m0, s34, 71680
  s_nop 0
  buffer_load_dwordx4 v202, s[16:19], s35 offen lds
  s_add_u32 m0, s34, 79872
  s_nop 0
  buffer_load_dwordx4 v203, s[16:19], s35 offen lds
  s_add_u32 m0, s34, 88064
  s_nop 0
  buffer_load_dwordx4 v204, s[16:19], s35 offen lds
  s_add_u32 m0, s34, 96256
  s_nop 0
  buffer_load_dwordx4 v205, s[16:19], s35 offen lds
  s_cmp_ge_u32 s30, 6
  s_cbranch_scc1 L_wg_62
  s_add_u32 m0, s34, 104448
  s_nop 0
  buffer_load_dwordx4 v206, s[16:19], s35 offen lds
L_wg_62:
  s_cmp_lg_u32 s30, 4
  s_cbranch_scc1 L_at4_58
  v_lshrrev_b32 v3, 2, v1
  v_and_b32 v8, 3, v1
  v_lshlrev_b32 v3, 7, v3
  v_lshl_add_u32 v3, v8, 2, v3
  s_lshl_b32 s34, s31, 11
  s_add_u32 s34, s34, 73728
  v_add_u32 v8, s34, v3
  s_mov_b32 exec_lo, -1
  s_mov_b32 exec_hi, -1
  s_mov_b32 s78, 0
L_poll_63:
  buffer_load_dword v4, v8, s[72:75], 0 offen sc1
  s_add_u32 s78, s78, 1
  s_waitcnt vmcnt(0)
  v_xor_b32 v4, s98, v4
  v_cmp_ne_u32 vcc, 0, v4
  s_cmp_gt_u32 s78, 60000
  s_cbranch_scc1 L_poll_63_x
  s_cmp_eq_u64 vcc, 0
  s_cbranch_scc1 L_poll_63_x
  s_sleep 1
  s_branch L_poll_63
L_poll_63_x:
  s_mov_b64 exec, -1
L_at4_58:
  v_subrev_u32 v2, 256, v0
  v_lshlrev_b32 v2, 4, v2
  v_mov_b32 v4, 2147483632
  v_cmp_gt_u32 vcc, 512, v2
  s_lshl_b32 s34, s30, 10
  s_add_u32 s34, s34, 145408
  s_mul_i32 s35, s31, 12800
  v_cndmask_b32 v3, v4, v2, vcc
  s_barrier
  s_add_u32 m0, s34, 0
  s_add_u32 s36, s35, 0
  buffer_load_dwordx4 v2, s[24:27], s36 offen sc1 lds
  s_add_u32 m0, s34, 4096
  s_add_u32 s36, s35, 4096
  buffer_load_dwordx4 v2, s[24:27], s36 offen sc1 lds
  s_add_u32 m0, s34, 8192
  s_add_u32 s36, s35, 8192
  buffer_load_dwordx4 v2, s[24:27], s36 offen sc1 lds
  s_cmp_lg_u32 s30, 4
  s_cbranch_scc1 L_atk_64
  s_add_u32 m0, s34, 12288
  s_add_u32 s36, s35, 12288
  buffer_load_dwordx4 v3, s[24:27], s36 offen sc1 lds
L_atk_64:
  s_waitcnt vmcnt(0)
  s_barrier
L_atj_57:
  v_and_b32 v2, 31, v1
  v_lshrrev_b32 v3, 5, v1
  v_min_u32 v4, 19, v2
  v_cmp_eq_u32 vcc, 20, v2
  v_mul_u32_u24 v6, 304, v2
  s_lshl_b32 s36, s30, 2
  v_cndmask_b32_e64 v4, v4, 18, vcc
  v_cmp_eq_u32 vcc, 1, v3
  s_add_u32 s36, s36, 110848
  v_add_u32 v7, s36, v6
  v_cndmask_b32_e64 v5, v4, 19, vcc
  s_lshl_b32 s36, s30, 5
  s_add_u32 s36, s36, 110592
  v_add_u32 v6, s36, v6
  v_lshl_add_u32 v6, v3, 4, v6
  v_mul_u32_u24 v4, 80, v4
  v_lshl_add_u32 v4, v3, 5, v4
  v_mul_u32_u24 v5, 80, v5
  s_mul_i32 s36, s30, 1600
  s_add_u32 s36, s36, 149504
  v_add_u32 v4, s36, v4
  v_add_u32 v5, s36, v5
  s_mov_b64 s[68:69], vcc
  ds_read_b128 v[16:19], v4
  ds_read_b128 v[20:23], v4 offset:16
  ds_read_b128 v[24:27], v5 offset:64
  ds_read_b128 v[40:43], v6 offset:0
  ds_read_b32 v44, v7 offset:0
  ds_read_b128 v[48:51], v6 offset:9728
  ds_read_b32 v52, v7 offset:9728
  ds_read_b128 v[56:59], v6 offset:19456
  ds_read_b32 v60, v7 offset:19456
  ds_read_b128 v[64:67], v6 offset:29184
  ds_read_b32 v68, v7 offset:29184
  v_mov_b32 v45, 0
  v_mov_b32 v46, 0
  v_mov_b32 v47, 0
  v_mov_b32 v53, 0
  v_mov_b32 v54, 0
  v_mov_b32 v55, 0
  v_mov_b32 v61, 0
  v_mov_b32 v62, 0
  v_mov_b32 v63, 0
  v_mov_b32 v69, 0
  v_mov_b32 v70, 0
  v_mov_b32 v71, 0
  v_mov_b32 v34, 0
  v_mov_b32 v35, 0
  s_waitcnt lgkmcnt(8)
  v_cvt_pk_bf16_f32 v28, v16, v17
  v_cvt_pk_bf16_f32 v29, v18, v19
  v_cvt_pk_bf16_f32 v30, v20, v21
  v_cvt_pk_bf16_f32 v31, v22, v23
  v_cvt_pk_bf16_f32 v32, v24, v25
  v_cvt_pk_bf16_f32 v33, v26, v27
  s_waitcnt lgkmcnt(6)
  s_nop 0
  v_mfma_f32_32x32x16_bf16 v[80:95], v[28:31], v[40:43], 0
  v_mfma_f32_32x32x16_bf16 v[80:95], v[32:35], v[44:47], v[80:95]
  s_waitcnt lgkmcnt(4)
  s_nop 0
  v_mfma_f32_32x32x16_bf16 v[96:111], v[28:31], v[48:51], 0
  v_mfma_f32_32x32x16_bf16 v[96:111], v[32:35], v[52:55], v[96:111]
  s_waitcnt lgkmcnt(2)
  s_nop 0
  v_mfma_f32_32x32x16_bf16 v[112:127], v[28:31], v[56:59], 0
  v_mfma_f32_32x32x16_bf16 v[112:127], v[32:35], v[60:63], v[112:127]
  s_waitcnt lgkmcnt(0)
  s_nop 0
  v_mfma_f32_32x32x16_bf16 v[128:143], v[28:31], v[64:67], 0
  v_mfma_f32_32x32x16_bf16 v[128:143], v[32:35], v[68:71], v[128:143]
  s_and_b32 s33, s30, 1
  s_lshr_b32 s37, s30, 1
  v_and_b32 v16, 15, v1
  v_lshrrev_b32 v17, 4, v1
  s_lshl_b32 s34, s37, 5
  v_add_u32 v18, s34, v16
  v_mul_u32_u24 v18, 304, v18
  v_add_u32 v18, 110592, v18
  v_lshl_add_u32 v9, v17, 4, v18
  v_lshl_add_u32 v10, v17, 3, v18
  v_lshrrev_b32 v19, 2, v16
  v_and_b32 v20, 3, v16
  v_lshlrev_b32 v20, 3, v20
  v_lshl_add_u32 v21, v17, 3, v19
  v_mul_u32_u24 v21, 384, v21
  v_add_u32 v21, v21, v20
  v_lshrrev_b32 v22, 3, v16
  v_and_b32 v23, 1, v17
  v_lshl_add_u32 v22, v23, 1, v22
  v_lshl_add_u32 v24, v17, 2, v19
  v_mul_u32_u24 v25, 384, v24
  v_add_u32 v25, v25, v20
  v_bfe_u32 v26, v24, 1, 1
  v_lshrrev_b32 v24, 3, v24
  v_lshl_add_u32 v26, v24, 1, v26
  s_mul_i32 s34, s33, 6
  s_and_b32 s35, s34, 3
  s_and_b32 s36, s34, 0xfc
  s_lshl_b32 s36, s36, 5
  v_xor_b32 v27, s35, v22
  v_lshl_add_u32 v27, v27, 5, v21
  v_add_u32 v144, s36, v27
  v_xor_b32 v27, s35, v26
  v_lshl_add_u32 v27, v27, 5, v25
  s_add_u32 s36, s36, 49152
  v_add_u32 v148, s36, v27
  s_add_u32 s34, s34, 1
  s_and_b32 s35, s34, 3
  s_and_b32 s36, s34, 0xfc
  s_lshl_b32 s36, s36, 5
  v_xor_b32 v27, s35, v22
  v_lshl_add_u32 v27, v27, 5, v21
  v_add_u32 v145, s36, v27
  v_xor_b32 v27, s35, v26
  v_lshl_add_u32 v27, v27, 5, v25
  s_add_u32 s36, s36, 49152
  v_add_u32 v149, s36, v27
  s_add_u32 s34, s34, 1
  s_and_b32 s35, s34, 3
  s_and_b32 s36, s34, 0xfc
  s_lshl_b32 s36, s36, 5
  v_xor_b32 v27, s35, v22
  v_lshl_add_u32 v27, v27, 5, v21
  v_add_u32 v146, s36, v27
  v_xor_b32 v27, s35, v26
  v_lshl_add_u32 v27, v27, 5, v25
  s_add_u32 s36, s36, 49152
  v_add_u32 v150, s36, v27
  s_add_u32 s34, s34, 1
  s_and_b32 s35, s34, 3
  s_and_b32 s36, s34, 0xfc
  s_lshl_b32 s36, s36, 5
  v_xor_b32 v27, s35, v22
  v_lshl_add_u32 v27, v27, 5, v21
  v_add_u32 v147, s36, v27
  v_xor_b32 v27, s35, v26
  v_lshl_add_u32 v27, v27, 5, v25
  s_add_u32 s36, s36, 49152
  v_add_u32 v151, s36, v27
  s_add_u32 s34, s34, 1
  v_cndmask_b32 v94, v90, v88, s[68:69]
  v_add_f32 v94, 0x358637bd, v94
  v_rcp_f32 v94, v94
  v_cndmask_b32 v110, v106, v104, s[68:69]
  v_add_f32 v110, 0x358637bd, v110
  v_rcp_f32 v110, v110
  v_cndmask_b32 v126, v122, v120, s[68:69]
  v_add_f32 v126, 0x358637bd, v126
  v_rcp_f32 v126, v126
  v_cndmask_b32 v142, v138, v136, s[68:69]
  v_add_f32 v142, 0x358637bd, v142
  v_rcp_f32 v142, v142
  s_nop 0
  v_mov_b32 v95, v94
  v_pk_mul_f32 v[80:81], v[80:81], v[94:95]
  v_pk_mul_f32 v[82:83], v[82:83], v[94:95]
  v_pk_mul_f32 v[84:85], v[84:85], v[94:95]
  v_pk_mul_f32 v[86:87], v[86:87], v[94:95]
  v_pk_mul_f32 v[88:89], v[88:89], v[94:95]
  v_cvt_pk_bf16_f32 v90, v80, v81
  v_cvt_pk_bf16_f32 v91, v82, v83
  v_cvt_pk_bf16_f32 v92, v84, v85
  v_cvt_pk_bf16_f32 v93, v86, v87
  v_cvt_pk_bf16_f32 v80, v88, v89
  s_nop 0
  v_permlane32_swap_b32 v90, v92
  v_permlane32_swap_b32 v91, v93
  ds_write_b128 v6, v[90:93] offset:0
  s_mov_b32 exec_hi, 0
  ds_write_b32 v7, v80 offset:0
  s_mov_b32 exec_hi, -1
  s_nop 0
  v_mov_b32 v111, v110
  v_pk_mul_f32 v[96:97], v[96:97], v[110:111]
  v_pk_mul_f32 v[98:99], v[98:99], v[110:111]
  v_pk_mul_f32 v[100:101], v[100:101], v[110:111]
  v_pk_mul_f32 v[102:103], v[102:103], v[110:111]
  v_pk_mul_f32 v[104:105], v[104:105], v[110:111]
  v_cvt_pk_bf16_f32 v106, v96, v97
  v_cvt_pk_bf16_f32 v107, v98, v99
  v_cvt_pk_bf16_f32 v108, v100, v101
  v_cvt_pk_bf16_f32 v109, v102, v103
  v_cvt_pk_bf16_f32 v96, v104, v105
  s_nop 0
  v_permlane32_swap_b32 v106, v108
  v_permlane32_swap_b32 v107, v109
  ds_write_b128 v6, v[106:109] offset:9728
  s_mov_b32 exec_hi, 0
  ds_write_b32 v7, v96 offset:9728
  s_mov_b32 exec_hi, -1
  s_nop 0
  v_mov_b32 v127, v126
  v_pk_mul_f32 v[112:113], v[112:113], v[126:127]
  v_pk_mul_f32 v[114:115], v[114:115], v[126:127]
  v_pk_mul_f32 v[116:117], v[116:117], v[126:127]
  v_pk_mul_f32 v[118:119], v[118:119], v[126:127]
  v_pk_mul_f32 v[120:121], v[120:121], v[126:127]
  v_cvt_pk_bf16_f32 v122, v112, v113
  v_cvt_pk_bf16_f32 v123, v114, v115
  v_cvt_pk_bf16_f32 v124, v116, v117
  v_cvt_pk_bf16_f32 v125, v118, v119
  v_cvt_pk_bf16_f32 v112, v120, v121
  s_nop 0
  v_permlane32_swap_b32 v122, v124
  v_permlane32_swap_b32 v123, v125
  ds_write_b128 v6, v[122:125] offset:19456
  s_mov_b32 exec_hi, 0
  ds_write_b32 v7, v112 offset:19456
  s_mov_b32 exec_hi, -1
  s_nop 0
  v_mov_b32 v143, v142
  v_pk_mul_f32 v[128:129], v[128:129], v[142:143]
  v_pk_mul_f32 v[130:131], v[130:131], v[142:143]
  v_pk_mul_f32 v[132:133], v[132:133], v[142:143]
  v_pk_mul_f32 v[134:135], v[134:135], v[142:143]
  v_pk_mul_f32 v[136:137], v[136:137], v[142:143]
  v_cvt_pk_bf16_f32 v138, v128, v129
  v_cvt_pk_bf16_f32 v139, v130, v131
  v_cvt_pk_bf16_f32 v140, v132, v133
  v_cvt_pk_bf16_f32 v141, v134, v135
  v_cvt_pk_bf16_f32 v128, v136, v137
  s_nop 0
  v_permlane32_swap_b32 v138, v140
  v_permlane32_swap_b32 v139, v141
  ds_write_b128 v6, v[138:141] offset:29184
  s_mov_b32 exec_hi, 0
  ds_write_b32 v7, v128 offset:29184
  s_mov_b32 exec_hi, -1
  s_add_u32 s20, s76, 24969216
  s_addc_u32 s21, s77, 0
  s_and_b32 s21, s21, 0xffff
  s_mov_b32 s22, 9437184
  s_mov_b32 s23, 0x20000
  s_lshl_b32 s38, s31, 7
  s_lshl_b32 s35, s32, 3
  s_add_u32 s38, s38, s35
  s_lshl_b32 s35, s37, 1
  s_add_u32 s38, s38, s35
  s_mul_i32 s38, s38, 18
  s_mul_i32 s35, s33, 3
  s_add_u32 s38, s38, s35
  s_lshl_b32 s38, s38, 10
  s_add_u32 s39, s38, 18432
  v_lshlrev_b32 v8, 4, v1
  s_waitcnt vmcnt(6) lgkmcnt(0)
  s_barrier
  ds_read_b128 v[152:155], v9 offset:0
  ds_read_b128 v[156:159], v9 offset:64
  ds_read_b128 v[160:163], v9 offset:128
  ds_read_b128 v[164:167], v9 offset:192
  ds_read_b64 v[184:185], v10 offset:256
  ds_read_b128 v[168:171], v9 offset:4864
  ds_read_b128 v[172:175], v9 offset:4928
  ds_read_b128 v[176:179], v9 offset:4992
  ds_read_b128 v[180:183], v9 offset:5056
  ds_read_b64 v[186:187], v10 offset:5120
  v_add_u32 v2, 0, v144
  v_add_u32 v11, 0, v148
  v_add_u32 v3, 0, v145
  v_add_u32 v12, 0, v149
  v_add_u32 v4, 0, v146
  v_add_u32 v13, 0, v150
  v_add_u32 v5, 0, v147
  v_add_u32 v14, 0, v151
  ds_read_b64_tr_b16 v[112:113], v2 offset:0
  ds_read_b64_tr_b16 v[114:115], v2 offset:1536
  ds_read_b64_tr_b16 v[116:117], v2 offset:12288
  ds_read_b64_tr_b16 v[118:119], v2 offset:13824
  s_waitcnt lgkmcnt(4)
  ds_read_b64_tr_b16 v[120:121], v2 offset:24576
  ds_read_b64_tr_b16 v[122:123], v2 offset:26112
  ds_read_b64_tr_b16 v[124:125], v2 offset:36864
  ds_read_b64_tr_b16 v[126:127], v2 offset:38400
  ds_read_b64_tr_b16 v[128:129], v11 offset:0
  ds_read_b64_tr_b16 v[132:133], v3 offset:0
  ds_read_b64_tr_b16 v[134:135], v3 offset:1536
  s_waitcnt lgkmcnt(9)
  v_mfma_f32_16x16x32_bf16 v[16:19], v[112:115], v[152:155], 0
  v_mfma_f32_16x16x32_bf16 v[20:23], v[112:115], v[168:171], 0
  ds_read_b64_tr_b16 v[136:137], v3 offset:12288
  ds_read_b64_tr_b16 v[138:139], v3 offset:13824
  s_waitcnt lgkmcnt(9)
  v_mfma_f32_16x16x32_bf16 v[16:19], v[116:119], v[156:159], v[16:19]
  v_mfma_f32_16x16x32_bf16 v[20:23], v[116:119], v[172:175], v[20:23]
  ds_read_b64_tr_b16 v[140:141], v3 offset:24576
  ds_read_b64_tr_b16 v[142:143], v3 offset:26112
  s_waitcnt lgkmcnt(9)
  v_mfma_f32_16x16x32_bf16 v[16:19], v[120:123], v[160:163], v[16:19]
  v_mfma_f32_16x16x32_bf16 v[20:23], v[120:123], v[176:179], v[20:23]
  ds_read_b64_tr_b16 v[112:113], v3 offset:36864
  ds_read_b64_tr_b16 v[114:115], v3 offset:38400
  s_waitcnt lgkmcnt(9)
  v_mfma_f32_16x16x32_bf16 v[16:19], v[124:127], v[164:167], v[16:19]
  v_mfma_f32_16x16x32_bf16 v[20:23], v[124:127], v[180:183], v[20:23]
  ds_read_b64_tr_b16 v[116:117], v12 offset:0
  s_waitcnt lgkmcnt(9)
  v_mfma_f32_16x16x16_bf16 v[16:19], v[128:129], v[184:185], v[16:19]
  v_mfma_f32_16x16x16_bf16 v[20:23], v[128:129], v[186:187], v[20:23]
  ds_read_b64_tr_b16 v[120:121], v4 offset:0
  ds_read_b64_tr_b16 v[122:123], v4 offset:1536
  s_waitcnt lgkmcnt(9)
  v_mfma_f32_16x16x32_bf16 v[24:27], v[132:135], v[152:155], 0
  v_mfma_f32_16x16x32_bf16 v[28:31], v[132:135], v[168:171], 0
  ds_read_b64_tr_b16 v[124:125], v4 offset:12288
  ds_read_b64_tr_b16 v[126:127], v4 offset:13824
  s_waitcnt lgkmcnt(9)
  v_mfma_f32_16x16x32_bf16 v[24:27], v[136:139], v[156:159], v[24:27]
  v_mfma_f32_16x16x32_bf16 v[28:31], v[136:139], v[172:175], v[28:31]
  ds_read_b64_tr_b16 v[128:129], v4 offset:24576
  ds_read_b64_tr_b16 v[130:131], v4 offset:26112
  s_waitcnt lgkmcnt(9)
  v_mfma_f32_16x16x32_bf16 v[24:27], v[140:143], v[160:163], v[24:27]
  v_mfma_f32_16x16x32_bf16 v[28:31], v[140:143], v[176:179], v[28:31]
  ds_read_b64_tr_b16 v[132:133], v4 offset:36864
  ds_read_b64_tr_b16 v[134:135], v4 offset:38400
  s_waitcnt lgkmcnt(9)
  v_mfma_f32_16x16x32_bf16 v[24:27], v[112:115], v[164:167], v[24:27]
  v_mfma_f32_16x16x32_bf16 v[28:31], v[112:115], v[180:183], v[28:31]
  ds_read_b64_tr_b16 v[136:137], v13 offset:0
  s_waitcnt lgkmcnt(9)
  v_mfma_f32_16x16x16_bf16 v[24:27], v[116:117], v[184:185], v[24:27]
  v_mfma_f32_16x16x16_bf16 v[28:31], v[116:117], v[186:187], v[28:31]
  ds_read_b64_tr_b16 v[140:141], v5 offset:0
  ds_read_b64_tr_b16 v[142:143], v5 offset:1536
  s_waitcnt lgkmcnt(9)
  v_mfma_f32_16x16x32_bf16 v[32:35], v[120:123], v[152:155], 0
  v_mfma_f32_16x16x32_bf16 v[36:39], v[120:123], v[168:171], 0
  ds_read_b64_tr_b16 v[112:113], v5 offset:12288
  ds_read_b64_tr_b16 v[114:115], v5 offset:13824
  s_waitcnt lgkmcnt(9)
  v_mfma_f32_16x16x32_bf16 v[32:35], v[124:127], v[156:159], v[32:35]
  v_mfma_f32_16x16x32_bf16 v[36:39], v[124:127], v[172:175], v[36:39]
  ds_read_b64_tr_b16 v[116:117], v5 offset:24576
  ds_read_b64_tr_b16 v[118:119], v5 offset:26112
  s_waitcnt lgkmcnt(9)
  v_mfma_f32_16x16x32_bf16 v[32:35], v[128:131], v[160:163], v[32:35]
  v_mfma_f32_16x16x32_bf16 v[36:39], v[128:131], v[176:179], v[36:39]
  ds_read_b64_tr_b16 v[120:121], v5 offset:36864
  ds_read_b64_tr_b16 v[122:123], v5 offset:38400
  s_waitcnt lgkmcnt(9)
  v_mfma_f32_16x16x32_bf16 v[32:35], v[132:135], v[164:167], v[32:35]
  v_mfma_f32_16x16x32_bf16 v[36:39], v[132:135], v[180:183], v[36:39]
  v_cvt_pk_bf16_f32 v16, v16, v17
  v_cvt_pk_bf16_f32 v17, v18, v19
  v_cvt_pk_bf16_f32 v18, v24, v25
  v_cvt_pk_bf16_f32 v19, v26, v27
  s_nop 1
  v_permlane16_swap_b32 v16, v18
  v_permlane16_swap_b32 v17, v19
  buffer_store_dwordx4 v[16:19], v8, s[20:23], s38 offen offset:0 sc1
  ds_read_b64_tr_b16 v[124:125], v14 offset:0
  s_waitcnt lgkmcnt(9)
  v_mfma_f32_16x16x16_bf16 v[32:35], v[136:137], v[184:185], v[32:35]
  v_mfma_f32_16x16x16_bf16 v[36:39], v[136:137], v[186:187], v[36:39]
  v_cvt_pk_bf16_f32 v20, v20, v21
  v_cvt_pk_bf16_f32 v21, v22, v23
  v_cvt_pk_bf16_f32 v22, v28, v29
  v_cvt_pk_bf16_f32 v23, v30, v31
  s_nop 1
  v_permlane16_swap_b32 v20, v22
  v_permlane16_swap_b32 v21, v23
  buffer_store_dwordx4 v[20:23], v8, s[20:23], s39 offen offset:0 sc1
  ds_read_b64_tr_b16 v[128:129], v2 offset:128
  ds_read_b64_tr_b16 v[130:131], v2 offset:1664
  s_waitcnt lgkmcnt(9)
  v_mfma_f32_16x16x32_bf16 v[40:43], v[140:143], v[152:155], 0
  v_mfma_f32_16x16x32_bf16 v[44:47], v[140:143], v[168:171], 0
  ds_read_b64_tr_b16 v[132:133], v2 offset:12416
  ds_read_b64_tr_b16 v[134:135], v2 offset:13952
  s_waitcnt lgkmcnt(9)
  v_mfma_f32_16x16x32_bf16 v[40:43], v[112:115], v[156:159], v[40:43]
  v_mfma_f32_16x16x32_bf16 v[44:47], v[112:115], v[172:175], v[44:47]
  ds_read_b64_tr_b16 v[136:137], v2 offset:24704
  ds_read_b64_tr_b16 v[138:139], v2 offset:26240
  s_waitcnt lgkmcnt(9)
  v_mfma_f32_16x16x32_bf16 v[40:43], v[116:119], v[160:163], v[40:43]
  v_mfma_f32_16x16x32_bf16 v[44:47], v[116:119], v[176:179], v[44:47]
  ds_read_b64_tr_b16 v[140:141], v2 offset:36992
  ds_read_b64_tr_b16 v[142:143], v2 offset:38528
  s_waitcnt lgkmcnt(9)
  v_mfma_f32_16x16x32_bf16 v[40:43], v[120:123], v[164:167], v[40:43]
  v_mfma_f32_16x16x32_bf16 v[44:47], v[120:123], v[180:183], v[44:47]
  ds_read_b64_tr_b16 v[112:113], v11 offset:128
  s_waitcnt lgkmcnt(9)
  v_mfma_f32_16x16x16_bf16 v[40:43], v[124:125], v[184:185], v[40:43]
  v_mfma_f32_16x16x16_bf16 v[44:47], v[124:125], v[186:187], v[44:47]
  ds_read_b64_tr_b16 v[116:117], v3 offset:128
  ds_read_b64_tr_b16 v[118:119], v3 offset:1664
  s_waitcnt lgkmcnt(9)
  v_mfma_f32_16x16x32_bf16 v[48:51], v[128:131], v[152:155], 0
  v_mfma_f32_16x16x32_bf16 v[52:55], v[128:131], v[168:171], 0
  ds_read_b64_tr_b16 v[120:121], v3 offset:12416
  ds_read_b64_tr_b16 v[122:123], v3 offset:13952
  s_waitcnt lgkmcnt(9)
  v_mfma_f32_16x16x32_bf16 v[48:51], v[132:135], v[156:159], v[48:51]
  v_mfma_f32_16x16x32_bf16 v[52:55], v[132:135], v[172:175], v[52:55]
  ds_read_b64_tr_b16 v[124:125], v3 offset:24704
  ds_read_b64_tr_b16 v[126:127], v3 offset:26240
  s_waitcnt lgkmcnt(9)
  v_mfma_f32_16x16x32_bf16 v[48:51], v[136:139], v[160:163], v[48:51]
  v_mfma_f32_16x16x32_bf16 v[52:55], v[136:139], v[176:179], v[52:55]
  ds_read_b64_tr_b16 v[128:129], v3 offset:36992
  ds_read_b64_tr_b16 v[130:131], v3 offset:38528
  s_waitcnt lgkmcnt(9)
  v_mfma_f32_16x16x32_bf16 v[48:51], v[140:143], v[164:167], v[48:51]
  v_mfma_f32_16x16x32_bf16 v[52:55], v[140:143], v[180:183], v[52:55]
  v_cvt_pk_bf16_f32 v32, v32, v33
  v_cvt_pk_bf16_f32 v33, v34, v35
  v_cvt_pk_bf16_f32 v34, v40, v41
  v_cvt_pk_bf16_f32 v35, v42, v43
  s_nop 1
  v_permlane16_swap_b32 v32, v34
  v_permlane16_swap_b32 v33, v35
  buffer_store_dwordx4 v[32:35], v8, s[20:23], s38 offen offset:1024 sc1
  ds_read_b64_tr_b16 v[132:133], v12 offset:128
  s_waitcnt lgkmcnt(9)
  v_mfma_f32_16x16x16_bf16 v[48:51], v[112:113], v[184:185], v[48:51]
  v_mfma_f32_16x16x16_bf16 v[52:55], v[112:113], v[186:187], v[52:55]
  v_cvt_pk_bf16_f32 v36, v36, v37
  v_cvt_pk_bf16_f32 v37, v38, v39
  v_cvt_pk_bf16_f32 v38, v44, v45
  v_cvt_pk_bf16_f32 v39, v46, v47
  s_nop 1
  v_permlane16_swap_b32 v36, v38
  v_permlane16_swap_b32 v37, v39
  buffer_store_dwordx4 v[36:39], v8, s[20:23], s39 offen offset:1024 sc1
  s_waitcnt vmcnt(4)
  s_barrier
  v_add_u32 v2, 55296, v144
  v_add_u32 v11, 55296, v148
  v_add_u32 v3, 55296, v145
  v_add_u32 v12, 55296, v149
  v_add_u32 v4, 55296, v146
  v_add_u32 v13, 55296, v150
  v_add_u32 v5, 55296, v147
  v_add_u32 v14, 55296, v151
  ds_read_b64_tr_b16 v[136:137], v2 offset:0
  ds_read_b64_tr_b16 v[138:139], v2 offset:1536
  s_waitcnt lgkmcnt(9)
  v_mfma_f32_16x16x32_bf16 v[56:59], v[116:119], v[152:155], 0
  v_mfma_f32_16x16x32_bf16 v[60:63], v[116:119], v[168:171], 0
  ds_read_b64_tr_b16 v[140:141], v2 offset:12288
  ds_read_b64_tr_b16 v[142:143], v2 offset:13824
  s_waitcnt lgkmcnt(9)
  v_mfma_f32_16x16x32_bf16 v[56:59], v[120:123], v[156:159], v[56:59]
  v_mfma_f32_16x16x32_bf16 v[60:63], v[120:123], v[172:175], v[60:63]
  ds_read_b64_tr_b16 v[112:113], v2 offset:24576
  ds_read_b64_tr_b16 v[114:115], v2 offset:26112
  s_waitcnt lgkmcnt(9)
  v_mfma_f32_16x16x32_bf16 v[56:59], v[124:127], v[160:163], v[56:59]
  v_mfma_f32_16x16x32_bf16 v[60:63], v[124:127], v[176:179], v[60:63]
  ds_read_b64_tr_b16 v[116:117], v2 offset:36864
  ds_read_b64_tr_b16 v[118:119], v2 offset:38400
  s_waitcnt lgkmcnt(9)
  v_mfma_f32_16x16x32_bf16 v[56:59], v[128:131], v[164:167], v[56:59]
  v_mfma_f32_16x16x32_bf16 v[60:63], v[128:131], v[180:183], v[60:63]
  ds_read_b64_tr_b16 v[120:121], v11 offset:0
  s_waitcnt lgkmcnt(9)
  v_mfma_f32_16x16x16_bf16 v[56:59], v[132:133], v[184:185], v[56:59]
  v_mfma_f32_16x16x16_bf16 v[60:63], v[132:133], v[186:187], v[60:63]
  ds_read_b64_tr_b16 v[124:125], v3 offset:0
  ds_read_b64_tr_b16 v[126:127], v3 offset:1536
  s_waitcnt lgkmcnt(9)
  v_mfma_f32_16x16x32_bf16 v[64:67], v[136:139], v[152:155], 0
  v_mfma_f32_16x16x32_bf16 v[68:71], v[136:139], v[168:171], 0
  ds_read_b64_tr_b16 v[128:129], v3 offset:12288
  ds_read_b64_tr_b16 v[130:131], v3 offset:13824
  s_waitcnt lgkmcnt(9)
  v_mfma_f32_16x16x32_bf16 v[64:67], v[140:143], v[156:159], v[64:67]
  v_mfma_f32_16x16x32_bf16 v[68:71], v[140:143], v[172:175], v[68:71]
  ds_read_b64_tr_b16 v[132:133], v3 offset:24576
  ds_read_b64_tr_b16 v[134:135], v3 offset:26112
  s_waitcnt lgkmcnt(9)
  v_mfma_f32_16x16x32_bf16 v[64:67], v[112:115], v[160:163], v[64:67]
  v_mfma_f32_16x16x32_bf16 v[68:71], v[112:115], v[176:179], v[68:71]
  ds_read_b64_tr_b16 v[136:137], v3 offset:36864
  ds_read_b64_tr_b16 v[138:139], v3 offset:38400
  s_waitcnt lgkmcnt(9)
  v_mfma_f32_16x16x32_bf16 v[64:67], v[116:119], v[164:167], v[64:67]
  v_mfma_f32_16x16x32_bf16 v[68:71], v[116:119], v[180:183], v[68:71]
  v_cvt_pk_bf16_f32 v48, v48, v49
  v_cvt_pk_bf16_f32 v49, v50, v51
  v_cvt_pk_bf16_f32 v50, v56, v57
  v_cvt_pk_bf16_f32 v51, v58, v59
  s_nop 1
  v_permlane16_swap_b32 v48, v50
  v_permlane16_swap_b32 v49, v51
  buffer_store_dwordx4 v[48:51], v8, s[20:23], s38 offen offset:2048 sc1
  s_add_u32 s38, s38, 6144
  ds_read_b64_tr_b16 v[140:141], v12 offset:0
  s_waitcnt lgkmcnt(9)
  v_mfma_f32_16x16x16_bf16 v[64:67], v[120:121], v[184:185], v[64:67]
  v_mfma_f32_16x16x16_bf16 v[68:71], v[120:121], v[186:187], v[68:71]
  v_cvt_pk_bf16_f32 v52, v52, v53
  v_cvt_pk_bf16_f32 v53, v54, v55
  v_cvt_pk_bf16_f32 v54, v60, v61
  v_cvt_pk_bf16_f32 v55, v62, v63
  s_nop 1
  v_permlane16_swap_b32 v52, v54
  v_permlane16_swap_b32 v53, v55
  buffer_store_dwordx4 v[52:55], v8, s[20:23], s39 offen offset:2048 sc1
  s_add_u32 s39, s39, 6144
  ds_read_b64_tr_b16 v[112:113], v4 offset:0
  ds_read_b64_tr_b16 v[114:115], v4 offset:1536
  s_waitcnt lgkmcnt(9)
  v_mfma_f32_16x16x32_bf16 v[72:75], v[124:127], v[152:155], 0
  v_mfma_f32_16x16x32_bf16 v[76:79], v[124:127], v[168:171], 0
  s_barrier
  s_lshl_b32 s34, s30, 10
  s_mul_i32 s35, s31, 165888
  s_add_u32 s35, s35, 768
  s_add_u32 m0, s34, 0
  s_nop 0
  buffer_load_dwordx4 v200, s[16:19], s35 offen lds
  s_add_u32 m0, s34, 8192
  s_nop 0
  buffer_load_dwordx4 v201, s[16:19], s35 offen lds
  s_add_u32 m0, s34, 16384
  s_nop 0
  buffer_load_dwordx4 v202, s[16:19], s35 offen lds
  s_add_u32 m0, s34, 24576
  s_nop 0
  buffer_load_dwordx4 v203, s[16:19], s35 offen lds
  s_add_u32 m0, s34, 32768
  s_nop 0
  buffer_load_dwordx4 v204, s[16:19], s35 offen lds
  s_add_u32 m0, s34, 40960
  s_nop 0
  buffer_load_dwordx4 v205, s[16:19], s35 offen lds
  s_cmp_ge_u32 s30, 6
  s_cbranch_scc1 L_wg_65
  s_add_u32 m0, s34, 49152
  s_nop 0
  buffer_load_dwordx4 v206, s[16:19], s35 offen lds
L_wg_65:
  ds_read_b64_tr_b16 v[116:117], v4 offset:12288
  ds_read_b64_tr_b16 v[118:119], v4 offset:13824
  s_waitcnt lgkmcnt(9)
  v_mfma_f32_16x16x32_bf16 v[72:75], v[128:131], v[156:159], v[72:75]
  v_mfma_f32_16x16x32_bf16 v[76:79], v[128:131], v[172:175], v[76:79]
  ds_read_b64_tr_b16 v[120:121], v4 offset:24576
  ds_read_b64_tr_b16 v[122:123], v4 offset:26112
  s_waitcnt lgkmcnt(9)
  v_mfma_f32_16x16x32_bf16 v[72:75], v[132:135], v[160:163], v[72:75]
  v_mfma_f32_16x16x32_bf16 v[76:79], v[132:135], v[176:179], v[76:79]
  ds_read_b64_tr_b16 v[124:125], v4 offset:36864
  ds_read_b64_tr_b16 v[126:127], v4 offset:38400
  s_waitcnt lgkmcnt(9)
  v_mfma_f32_16x16x32_bf16 v[72:75], v[136:139], v[164:167], v[72:75]
  v_mfma_f32_16x16x32_bf16 v[76:79], v[136:139], v[180:183], v[76:79]
  ds_read_b64_tr_b16 v[128:129], v13 offset:0
  s_waitcnt lgkmcnt(9)
  v_mfma_f32_16x16x16_bf16 v[72:75], v[140:141], v[184:185], v[72:75]
  v_mfma_f32_16x16x16_bf16 v[76:79], v[140:141], v[186:187], v[76:79]
  ds_read_b64_tr_b16 v[132:133], v5 offset:0
  ds_read_b64_tr_b16 v[134:135], v5 offset:1536
  s_waitcnt lgkmcnt(9)
  v_mfma_f32_16x16x32_bf16 v[80:83], v[112:115], v[152:155], 0
  v_mfma_f32_16x16x32_bf16 v[84:87], v[112:115], v[168:171], 0
  ds_read_b64_tr_b16 v[136:137], v5 offset:12288
  ds_read_b64_tr_b16 v[138:139], v5 offset:13824
  s_waitcnt lgkmcnt(9)
  v_mfma_f32_16x16x32_bf16 v[80:83], v[116:119], v[156:159], v[80:83]
  v_mfma_f32_16x16x32_bf16 v[84:87], v[116:119], v[172:175], v[84:87]
  ds_read_b64_tr_b16 v[140:141], v5 offset:24576
  ds_read_b64_tr_b16 v[142:143], v5 offset:26112
  s_waitcnt lgkmcnt(9)
  v_mfma_f32_16x16x32_bf16 v[80:83], v[120:123], v[160:163], v[80:83]
  v_mfma_f32_16x16x32_bf16 v[84:87], v[120:123], v[176:179], v[84:87]
  ds_read_b64_tr_b16 v[112:113], v5 offset:36864
  ds_read_b64_tr_b16 v[114:115], v5 offset:38400
  s_waitcnt lgkmcnt(9)
  v_mfma_f32_16x16x32_bf16 v[80:83], v[124:127], v[164:167], v[80:83]
  v_mfma_f32_16x16x32_bf16 v[84:87], v[124:127], v[180:183], v[84:87]
  v_cvt_pk_bf16_f32 v64, v64, v65
  v_cvt_pk_bf16_f32 v65, v66, v67
  v_cvt_pk_bf16_f32 v66, v72, v73
  v_cvt_pk_bf16_f32 v67, v74, v75
  s_nop 1
  v_permlane16_swap_b32 v64, v66
  v_permlane16_swap_b32 v65, v67
  buffer_store_dwordx4 v[64:67], v8, s[20:23], s38 offen offset:0 sc1
  ds_read_b64_tr_b16 v[116:117], v14 offset:0
  s_waitcnt lgkmcnt(9)
  v_mfma_f32_16x16x16_bf16 v[80:83], v[128:129], v[184:185], v[80:83]
  v_mfma_f32_16x16x16_bf16 v[84:87], v[128:129], v[186:187], v[84:87]
  v_cvt_pk_bf16_f32 v68, v68, v69
  v_cvt_pk_bf16_f32 v69, v70, v71
  v_cvt_pk_bf16_f32 v70, v76, v77
  v_cvt_pk_bf16_f32 v71, v78, v79
  s_nop 1
  v_permlane16_swap_b32 v68, v70
  v_permlane16_swap_b32 v69, v71
  buffer_store_dwordx4 v[68:71], v8, s[20:23], s39 offen offset:0 sc1
  ds_read_b64_tr_b16 v[120:121], v2 offset:128
  ds_read_b64_tr_b16 v[122:123], v2 offset:1664
  s_waitcnt lgkmcnt(9)
  v_mfma_f32_16x16x32_bf16 v[88:91], v[132:135], v[152:155], 0
  v_mfma_f32_16x16x32_bf16 v[92:95], v[132:135], v[168:171], 0
  ds_read_b64_tr_b16 v[124:125], v2 offset:12416
  ds_read_b64_tr_b16 v[126:127], v2 offset:13952
  s_waitcnt lgkmcnt(9)
  v_mfma_f32_16x16x32_bf16 v[88:91], v[136:139], v[156:159], v[88:91]
  v_mfma_f32_16x16x32_bf16 v[92:95], v[136:139], v[172:175], v[92:95]
  ds_read_b64_tr_b16 v[128:129], v2 offset:24704
  ds_read_b64_tr_b16 v[130:131], v2 offset:26240
  s_waitcnt lgkmcnt(9)
  v_mfma_f32_16x16x32_bf16 v[88:91], v[140:143], v[160:163], v[88:91]
  v_mfma_f32_16x16x32_bf16 v[92:95], v[140:143], v[176:179], v[92:95]
  ds_read_b64_tr_b16 v[132:133], v2 offset:36992
  ds_read_b64_tr_b16 v[134:135], v2 offset:38528
  s_waitcnt lgkmcnt(9)
  v_mfma_f32_16x16x32_bf16 v[88:91], v[112:115], v[164:167], v[88:91]
  v_mfma_f32_16x16x32_bf16 v[92:95], v[112:115], v[180:183], v[92:95]
  ds_read_b64_tr_b16 v[136:137], v11 offset:128
  s_waitcnt lgkmcnt(9)
  v_mfma_f32_16x16x16_bf16 v[88:91], v[116:117], v[184:185], v[88:91]
  v_mfma_f32_16x16x16_bf16 v[92:95], v[116:117], v[186:187], v[92:95]
  ds_read_b64_tr_b16 v[140:141], v3 offset:128
  ds_read_b64_tr_b16 v[142:143], v3 offset:1664
  s_waitcnt lgkmcnt(9)
  v_mfma_f32_16x16x32_bf16 v[96:99], v[120:123], v[152:155], 0
  v_mfma_f32_16x16x32_bf16 v[100:103], v[120:123], v[168:171], 0
  ds_read_b64_tr_b16 v[112:113], v3 offset:12416
  ds_read_b64_tr_b16 v[114:115], v3 offset:13952
  s_waitcnt lgkmcnt(9)
  v_mfma_f32_16x16x32_bf16 v[96:99], v[124:127], v[156:159], v[96:99]
  v_mfma_f32_16x16x32_bf16 v[100:103], v[124:127], v[172:175], v[100:103]
  ds_read_b64_tr_b16 v[116:117], v3 offset:24704
  ds_read_b64_tr_b16 v[118:119], v3 offset:26240
  s_waitcnt lgkmcnt(9)
  v_mfma_f32_16x16x32_bf16 v[96:99], v[128:131], v[160:163], v[96:99]
  v_mfma_f32_16x16x32_bf16 v[100:103], v[128:131], v[176:179], v[100:103]
  ds_read_b64_tr_b16 v[120:121], v3 offset:36992
  ds_read_b64_tr_b16 v[122:123], v3 offset:38528
  s_waitcnt lgkmcnt(9)
  v_mfma_f32_16x16x32_bf16 v[96:99], v[132:135], v[164:167], v[96:99]
  v_mfma_f32_16x16x32_bf16 v[100:103], v[132:135], v[180:183], v[100:103]
  v_cvt_pk_bf16_f32 v80, v80, v81
  v_cvt_pk_bf16_f32 v81, v82, v83
  v_cvt_pk_bf16_f32 v82, v88, v89
  v_cvt_pk_bf16_f32 v83, v90, v91
  s_nop 1
  v_permlane16_swap_b32 v80, v82
  v_permlane16_swap_b32 v81, v83
  buffer_store_dwordx4 v[80:83], v8, s[20:23], s38 offen offset:1024 sc1
  ds_read_b64_tr_b16 v[124:125], v12 offset:128
  s_waitcnt lgkmcnt(9)
  v_mfma_f32_16x16x16_bf16 v[96:99], v[136:137], v[184:185], v[96:99]
  v_mfma_f32_16x16x16_bf16 v[100:103], v[136:137], v[186:187], v[100:103]
  v_cvt_pk_bf16_f32 v84, v84, v85
  v_cvt_pk_bf16_f32 v85, v86, v87
  v_cvt_pk_bf16_f32 v86, v92, v93
  v_cvt_pk_bf16_f32 v87, v94, v95
  s_nop 1
  v_permlane16_swap_b32 v84, v86
  v_permlane16_swap_b32 v85, v87
  buffer_store_dwordx4 v[84:87], v8, s[20:23], s39 offen offset:1024 sc1
  s_waitcnt vmcnt(4)
  s_barrier
  v_add_u32 v2, 0, v144
  v_add_u32 v11, 0, v148
  v_add_u32 v3, 0, v145
  v_add_u32 v12, 0, v149
  v_add_u32 v4, 0, v146
  v_add_u32 v13, 0, v150
  v_add_u32 v5, 0, v147
  v_add_u32 v14, 0, v151
  ds_read_b64_tr_b16 v[128:129], v2 offset:0
  ds_read_b64_tr_b16 v[130:131], v2 offset:1536
  s_waitcnt lgkmcnt(9)
  v_mfma_f32_16x16x32_bf16 v[104:107], v[140:143], v[152:155], 0
  v_mfma_f32_16x16x32_bf16 v[108:111], v[140:143], v[168:171], 0
  ds_read_b64_tr_b16 v[132:133], v2 offset:12288
  ds_read_b64_tr_b16 v[134:135], v2 offset:13824
  s_waitcnt lgkmcnt(9)
  v_mfma_f32_16x16x32_bf16 v[104:107], v[112:115], v[156:159], v[104:107]
  v_mfma_f32_16x16x32_bf16 v[108:111], v[112:115], v[172:175], v[108:111]
  ds_read_b64_tr_b16 v[136:137], v2 offset:24576
  ds_read_b64_tr_b16 v[138:139], v2 offset:26112
  s_waitcnt lgkmcnt(9)
  v_mfma_f32_16x16x32_bf16 v[104:107], v[116:119], v[160:163], v[104:107]
  v_mfma_f32_16x16x32_bf16 v[108:111], v[116:119], v[176:179], v[108:111]
  ds_read_b64_tr_b16 v[140:141], v2 offset:36864
  ds_read_b64_tr_b16 v[142:143], v2 offset:38400
  s_waitcnt lgkmcnt(9)
  v_mfma_f32_16x16x32_bf16 v[104:107], v[120:123], v[164:167], v[104:107]
  v_mfma_f32_16x16x32_bf16 v[108:111], v[120:123], v[180:183], v[108:111]
  ds_read_b64_tr_b16 v[112:113], v11 offset:0
  s_waitcnt lgkmcnt(9)
  v_mfma_f32_16x16x16_bf16 v[104:107], v[124:125], v[184:185], v[104:107]
  v_mfma_f32_16x16x16_bf16 v[108:111], v[124:125], v[186:187], v[108:111]
  ds_read_b64_tr_b16 v[116:117], v3 offset:0
  ds_read_b64_tr_b16 v[118:119], v3 offset:1536
  s_waitcnt lgkmcnt(9)
  v_mfma_f32_16x16x32_bf16 v[16:19], v[128:131], v[152:155], 0
  v_mfma_f32_16x16x32_bf16 v[20:23], v[128:131], v[168:171], 0
  ds_read_b64_tr_b16 v[120:121], v3 offset:12288
  ds_read_b64_tr_b16 v[122:123], v3 offset:13824
  s_waitcnt lgkmcnt(9)
  v_mfma_f32_16x16x32_bf16 v[16:19], v[132:135], v[156:159], v[16:19]
  v_mfma_f32_16x16x32_bf16 v[20:23], v[132:135], v[172:175], v[20:23]
  ds_read_b64_tr_b16 v[124:125], v3 offset:24576
  ds_read_b64_tr_b16 v[126:127], v3 offset:26112
  s_waitcnt lgkmcnt(9)
  v_mfma_f32_16x16x32_bf16 v[16:19], v[136:139], v[160:163], v[16:19]
  v_mfma_f32_16x16x32_bf16 v[20:23], v[136:139], v[176:179], v[20:23]
  ds_read_b64_tr_b16 v[128:129], v3 offset:36864
  ds_read_b64_tr_b16 v[130:131], v3 offset:38400
  s_waitcnt lgkmcnt(9)
  v_mfma_f32_16x16x32_bf16 v[16:19], v[140:143], v[164:167], v[16:19]
  v_mfma_f32_16x16x32_bf16 v[20:23], v[140:143], v[180:183], v[20:23]
  v_cvt_pk_bf16_f32 v96, v96, v97
  v_cvt_pk_bf16_f32 v97, v98, v99
  v_cvt_pk_bf16_f32 v98, v104, v105
  v_cvt_pk_bf16_f32 v99, v106, v107
  s_nop 1
  v_permlane16_swap_b32 v96, v98
  v_permlane16_swap_b32 v97, v99
  buffer_store_dwordx4 v[96:99], v8, s[20:23], s38 offen offset:2048 sc1
  s_add_u32 s38, s38, 6144
  ds_read_b64_tr_b16 v[132:133], v12 offset:0
  s_waitcnt lgkmcnt(9)
  v_mfma_f32_16x16x16_bf16 v[16:19], v[112:113], v[184:185], v[16:19]
  v_mfma_f32_16x16x16_bf16 v[20:23], v[112:113], v[186:187], v[20:23]
  v_cvt_pk_bf16_f32 v100, v100, v101
  v_cvt_pk_bf16_f32 v101, v102, v103
  v_cvt_pk_bf16_f32 v102, v108, v109
  v_cvt_pk_bf16_f32 v103, v110, v111
  s_nop 1
  v_permlane16_swap_b32 v100, v102
  v_permlane16_swap_b32 v101, v103
  buffer_store_dwordx4 v[100:103], v8, s[20:23], s39 offen offset:2048 sc1
  s_add_u32 s39, s39, 6144
  ds_read_b64_tr_b16 v[136:137], v4 offset:0
  ds_read_b64_tr_b16 v[138:139], v4 offset:1536
  s_waitcnt lgkmcnt(9)
  v_mfma_f32_16x16x32_bf16 v[24:27], v[116:119], v[152:155], 0
  v_mfma_f32_16x16x32_bf16 v[28:31], v[116:119], v[168:171], 0
  ds_read_b64_tr_b16 v[140:141], v4 offset:12288
  ds_read_b64_tr_b16 v[142:143], v4 offset:13824
  s_waitcnt lgkmcnt(9)
  v_mfma_f32_16x16x32_bf16 v[24:27], v[120:123], v[156:159], v[24:27]
  v_mfma_f32_16x16x32_bf16 v[28:31], v[120:123], v[172:175], v[28:31]
  ds_read_b64_tr_b16 v[112:113], v4 offset:24576
  ds_read_b64_tr_b16 v[114:115], v4 offset:26112
  s_waitcnt lgkmcnt(9)
  v_mfma_f32_16x16x32_bf16 v[24:27], v[124:127], v[160:163], v[24:27]
  v_mfma_f32_16x16x32_bf16 v[28:31], v[124:127], v[176:179], v[28:31]
  ds_read_b64_tr_b16 v[116:117], v4 offset:36864
  ds_read_b64_tr_b16 v[118:119], v4 offset:38400
  s_waitcnt lgkmcnt(9)
  v_mfma_f32_16x16x32_bf16 v[24:27], v[128:131], v[164:167], v[24:27]
  v_mfma_f32_16x16x32_bf16 v[28:31], v[128:131], v[180:183], v[28:31]
  ds_read_b64_tr_b16 v[120:121], v13 offset:0
  s_waitcnt lgkmcnt(9)
  v_mfma_f32_16x16x16_bf16 v[24:27], v[132:133], v[184:185], v[24:27]
  v_mfma_f32_16x16x16_bf16 v[28:31], v[132:133], v[186:187], v[28:31]
  ds_read_b64_tr_b16 v[124:125], v5 offset:0
  ds_read_b64_tr_b16 v[126:127], v5 offset:1536
  s_waitcnt lgkmcnt(9)
  v_mfma_f32_16x16x32_bf16 v[32:35], v[136:139], v[152:155], 0
  v_mfma_f32_16x16x32_bf16 v[36:39], v[136:139], v[168:171], 0
  ds_read_b64_tr_b16 v[128:129], v5 offset:12288
  ds_read_b64_tr_b16 v[130:131], v5 offset:13824
  s_waitcnt lgkmcnt(9)
  v_mfma_f32_16x16x32_bf16 v[32:35], v[140:143], v[156:159], v[32:35]
  v_mfma_f32_16x16x32_bf16 v[36:39], v[140:143], v[172:175], v[36:39]
  ds_read_b64_tr_b16 v[132:133], v5 offset:24576
  ds_read_b64_tr_b16 v[134:135], v5 offset:26112
  s_waitcnt lgkmcnt(9)
  v_mfma_f32_16x16x32_bf16 v[32:35], v[112:115], v[160:163], v[32:35]
  v_mfma_f32_16x16x32_bf16 v[36:39], v[112:115], v[176:179], v[36:39]
  ds_read_b64_tr_b16 v[136:137], v5 offset:36864
  ds_read_b64_tr_b16 v[138:139], v5 offset:38400
  s_waitcnt lgkmcnt(9)
  v_mfma_f32_16x16x32_bf16 v[32:35], v[116:119], v[164:167], v[32:35]
  v_mfma_f32_16x16x32_bf16 v[36:39], v[116:119], v[180:183], v[36:39]
  v_cvt_pk_bf16_f32 v16, v16, v17
  v_cvt_pk_bf16_f32 v17, v18, v19
  v_cvt_pk_bf16_f32 v18, v24, v25
  v_cvt_pk_bf16_f32 v19, v26, v27
  s_nop 1
  v_permlane16_swap_b32 v16, v18
  v_permlane16_swap_b32 v17, v19
  buffer_store_dwordx4 v[16:19], v8, s[20:23], s38 offen offset:0 sc1
  ds_read_b64_tr_b16 v[140:141], v14 offset:0
  s_waitcnt lgkmcnt(9)
  v_mfma_f32_16x16x16_bf16 v[32:35], v[120:121], v[184:185], v[32:35]
  v_mfma_f32_16x16x16_bf16 v[36:39], v[120:121], v[186:187], v[36:39]
  v_cvt_pk_bf16_f32 v20, v20, v21
  v_cvt_pk_bf16_f32 v21, v22, v23
  v_cvt_pk_bf16_f32 v22, v28, v29
  v_cvt_pk_bf16_f32 v23, v30, v31
  s_nop 1
  v_permlane16_swap_b32 v20, v22
  v_permlane16_swap_b32 v21, v23
  buffer_store_dwordx4 v[20:23], v8, s[20:23], s39 offen offset:0 sc1
  ds_read_b64_tr_b16 v[112:113], v2 offset:128
  ds_read_b64_tr_b16 v[114:115], v2 offset:1664
  s_waitcnt lgkmcnt(9)
  v_mfma_f32_16x16x32_bf16 v[40:43], v[124:127], v[152:155], 0
  v_mfma_f32_16x16x32_bf16 v[44:47], v[124:127], v[168:171], 0
  ds_read_b64_tr_b16 v[116:117], v2 offset:12416
  ds_read_b64_tr_b16 v[118:119], v2 offset:13952
  s_waitcnt lgkmcnt(9)
  v_mfma_f32_16x16x32_bf16 v[40:43], v[128:131], v[156:159], v[40:43]
  v_mfma_f32_16x16x32_bf16 v[44:47], v[128:131], v[172:175], v[44:47]
  ds_read_b64_tr_b16 v[120:121], v2 offset:24704
  ds_read_b64_tr_b16 v[122:123], v2 offset:26240
  s_waitcnt lgkmcnt(9)
  v_mfma_f32_16x16x32_bf16 v[40:43], v[132:135], v[160:163], v[40:43]
  v_mfma_f32_16x16x32_bf16 v[44:47], v[132:135], v[176:179], v[44:47]
  ds_read_b64_tr_b16 v[124:125], v2 offset:36992
  ds_read_b64_tr_b16 v[126:127], v2 offset:38528
  s_waitcnt lgkmcnt(9)
  v_mfma_f32_16x16x32_bf16 v[40:43], v[136:139], v[164:167], v[40:43]
  v_mfma_f32_16x16x32_bf16 v[44:47], v[136:139], v[180:183], v[44:47]
  ds_read_b64_tr_b16 v[128:129], v11 offset:128
  s_waitcnt lgkmcnt(9)
  v_mfma_f32_16x16x16_bf16 v[40:43], v[140:141], v[184:185], v[40:43]
  v_mfma_f32_16x16x16_bf16 v[44:47], v[140:141], v[186:187], v[44:47]
  ds_read_b64_tr_b16 v[132:133], v3 offset:128
  ds_read_b64_tr_b16 v[134:135], v3 offset:1664
  s_waitcnt lgkmcnt(9)
  v_mfma_f32_16x16x32_bf16 v[48:51], v[112:115], v[152:155], 0
  v_mfma_f32_16x16x32_bf16 v[52:55], v[112:115], v[168:171], 0
  ds_read_b64_tr_b16 v[136:137], v3 offset:12416
  ds_read_b64_tr_b16 v[138:139], v3 offset:13952
  s_waitcnt lgkmcnt(9)
  v_mfma_f32_16x16x32_bf16 v[48:51], v[116:119], v[156:159], v[48:51]
  v_mfma_f32_16x16x32_bf16 v[52:55], v[116:119], v[172:175], v[52:55]
  ds_read_b64_tr_b16 v[140:141], v3 offset:24704
  ds_read_b64_tr_b16 v[142:143], v3 offset:26240
  s_waitcnt lgkmcnt(9)
  v_mfma_f32_16x16x32_bf16 v[48:51], v[120:123], v[160:163], v[48:51]
  v_mfma_f32_16x16x32_bf16 v[52:55], v[120:123], v[176:179], v[52:55]
  ds_read_b64_tr_b16 v[112:113], v3 offset:36992
  ds_read_b64_tr_b16 v[114:115], v3 offset:38528
  s_waitcnt lgkmcnt(9)
  v_mfma_f32_16x16x32_bf16 v[48:51], v[124:127], v[164:167], v[48:51]
  v_mfma_f32_16x16x32_bf16 v[52:55], v[124:127], v[180:183], v[52:55]
  v_cvt_pk_bf16_f32 v32, v32, v33
  v_cvt_pk_bf16_f32 v33, v34, v35
  v_cvt_pk_bf16_f32 v34, v40, v41
  v_cvt_pk_bf16_f32 v35, v42, v43
  s_nop 1
  v_permlane16_swap_b32 v32, v34
  v_permlane16_swap_b32 v33, v35
  buffer_store_dwordx4 v[32:35], v8, s[20:23], s38 offen offset:1024 sc1
  ds_read_b64_tr_b16 v[116:117], v12 offset:128
  s_waitcnt lgkmcnt(9)
  v_mfma_f32_16x16x16_bf16 v[48:51], v[128:129], v[184:185], v[48:51]
  v_mfma_f32_16x16x16_bf16 v[52:55], v[128:129], v[186:187], v[52:55]
  v_cvt_pk_bf16_f32 v36, v36, v37
  v_cvt_pk_bf16_f32 v37, v38, v39
  v_cvt_pk_bf16_f32 v38, v44, v45
  v_cvt_pk_bf16_f32 v39, v46, v47
  s_nop 1
  v_permlane16_swap_b32 v36, v38
  v_permlane16_swap_b32 v37, v39
  buffer_store_dwordx4 v[36:39], v8, s[20:23], s39 offen offset:1024 sc1
  s_waitcnt lgkmcnt(7)
  v_mfma_f32_16x16x32_bf16 v[56:59], v[132:135], v[152:155], 0
  v_mfma_f32_16x16x32_bf16 v[60:63], v[132:135], v[168:171], 0
  s_waitcnt lgkmcnt(5)
  v_mfma_f32_16x16x32_bf16 v[56:59], v[136:139], v[156:159], v[56:59]
  v_mfma_f32_16x16x32_bf16 v[60:63], v[136:139], v[172:175], v[60:63]
  s_waitcnt lgkmcnt(3)
  v_mfma_f32_16x16x32_bf16 v[56:59], v[140:143], v[160:163], v[56:59]
  v_mfma_f32_16x16x32_bf16 v[60:63], v[140:143], v[176:179], v[60:63]
  s_waitcnt lgkmcnt(1)
  v_mfma_f32_16x16x32_bf16 v[56:59], v[112:115], v[164:167], v[56:59]
  v_mfma_f32_16x16x32_bf16 v[60:63], v[112:115], v[180:183], v[60:63]
  s_waitcnt lgkmcnt(0)
  v_mfma_f32_16x16x16_bf16 v[56:59], v[116:117], v[184:185], v[56:59]
  v_mfma_f32_16x16x16_bf16 v[60:63], v[116:117], v[186:187], v[60:63]
  s_nop 7
  v_cvt_pk_bf16_f32 v48, v48, v49
  v_cvt_pk_bf16_f32 v49, v50, v51
  v_cvt_pk_bf16_f32 v50, v56, v57
  v_cvt_pk_bf16_f32 v51, v58, v59
  s_nop 1
  v_permlane16_swap_b32 v48, v50
  v_permlane16_swap_b32 v49, v51
  buffer_store_dwordx4 v[48:51], v8, s[20:23], s38 offen offset:2048 sc1
  s_add_u32 s38, s38, 6144
  v_cvt_pk_bf16_f32 v52, v52, v53
  v_cvt_pk_bf16_f32 v53, v54, v55
  v_cvt_pk_bf16_f32 v54, v60, v61
  v_cvt_pk_bf16_f32 v55, v62, v63
  s_nop 1
  v_permlane16_swap_b32 v52, v54
  v_permlane16_swap_b32 v53, v55
  buffer_store_dwordx4 v[52:55], v8, s[20:23], s39 offen offset:2048 sc1
  s_add_u32 s39, s39, 6144
  s_lshl_b32 s33, s32, 7
  s_lshl_b32 s34, s31, 2
  s_add_u32 s33, s33, s34
  s_add_u32 s33, s33, 0
  s_waitcnt vmcnt(0)
  s_barrier
  s_cmp_lg_u32 s30, 0
  s_cbranch_scc1 L_done_1
  v_mov_b32 v3, s33
  v_mov_b32 v4, s98
  s_mov_b64 exec, 1
  buffer_store_dword v4, v3, s[72:75], 0 offen sc1
  s_mov_b64 exec, -1
  s_branch L_done_1
L_done_1:
L_done_1_x:
  s_endpgm
L_code_end:
.p2align 7
.type L_tab_gather,@object
L_tab_gather:
  .long 0,0,4,4,8,8,12,12,256,16,260,20,264,24,268,28
  .long 512,32,516,36,520,40,524,44,768,48,772,52,776,56,780,60
  .long 2048,64,2052,68,16,80,20,84,24,88,28,92,272,96,276,100
  .long 280,104,284,108,528,112,532,116,536,120,540,124,784,128,788,132
  .long 792,136,796,140,2064,144,2068,148,32,160,36,164,40,168,44,172
  .long 288,176,292,180,296,184,300,188,544,192,548,196,552,200,556,204
  .long 800,208,804,212,808,216,812,220,2080,224,2084,228,48,240,52,244
  .long 56,248,60,252,304,256,308,260,312,264,316,268,560,272,564,276
  .long 568,280,572,284,816,288,820,292,824,296,828,300,2096,304,2100,308
  .long 64,320,68,324,72,328,76,332,320,336,324,340,328,344,332,348
  .long 576,352,580,356,584,360,588,364,832,368,836,372,840,376,844,380
  .long 2112,384,2116,388,80,400,84,404,88,408,92,412,336,416,340,420
  .long 344,424,348,428,592,432,596,436,600,440,604,444,848,448,852,452
  .long 856,456,860,460,2128,464,2132,468,96,480,100,484,104,488,108,492
  .long 352,496,356,500,360,504,364,508,608,512,612,516,616,520,620,524
  .long 864,528,868,532,872,536,876,540,2144,544,2148,548,112,560,116,564
  .long 120,568,124,572,368,576,372,580,376,584,380,588,624,592,628,596
  .long 632,600,636,604,880,608,884,612,888,616,892,620,2160,624,2164,628
  .long 128,640,132,644,136,648,140,652,384,656,388,660,392,664,396,668
  .long 640,672,644,676,648,680,652,684,896,688,900,692,904,696,908,700
  .long 2176,704,2180,708,144,720,148,724,152,728,156,732,400,736,404,740
  .long 408,744,412,748,656,752,660,756,664,760,668,764,912,768,916,772
  .long 920,776,924,780,2192,784,2196,788,160,800,164,804,168,808,172,812
  .long 416,816,420,820,424,824,428,828,672,832,676,836,680,840,684,844
  .long 928,848,932,852,936,856,940,860,2208,864,2212,868,176,880,180,884
  .long 184,888,188,892,432,896,436,900,440,904,444,908,688,912,692,916
  .long 696,920,700,924,944,928,948,932,952,936,956,940,2224,944,2228,948
  .long 192,960,196,964,200,968,204,972,448,976,452,980,456,984,460,988
  .long 704,992,708,996,712,1000,716,1004,960,1008,964,1012,968,1016,972,1020
  .long 2240,1024,2244,1028,208,1040,212,1044,216,1048,220,1052,464,1056,468,1060
  .long 472,1064,476,1068,720,1072,724,1076,728,1080,732,1084,976,1088,980,1092
  .long 984,1096,988,1100,2256,1104,2260,1108,224,1120,228,1124,232,1128,236,1132
  .long 480,1136,484,1140,488,1144,492,1148,736,1152,740,1156,744,1160,748,1164
  .long 992,1168,996,1172,1000,1176,1004,1180,2272,1184,2276,1188,240,1200,244,1204
  .long 248,1208,252,1212,496,1216,500,1220,504,1224,508,1228,752,1232,756,1236
  .long 760,1240,764,1244,1008,1248,1012,1252,1016,1256,1020,1260,2288,1264,2292,1268
  .long 1024,1280,1028,1284,1032,1288,1036,1292,1280,1296,1284,1300,1288,1304,1292,1308
  .long 1536,1312,1540,1316,1544,1320,1548,1324,1792,1328,1796,1332,1800,1336,1804,1340
  .long 3072,1344,3076,1348,1040,1360,1044,1364,1048,1368,1052,1372,1296,1376,1300,1380
  .long 1304,1384,1308,1388,1552,1392,1556,1396,1560,1400,1564,1404,1808,1408,1812,1412
  .long 1816,1416,1820,1420,3088,1424,3092,1428,25600,1440,25604,1444,25608,1448,25612,1452
  .long 25616,1456,25620,1460,25624,1464,25628,1468,25632,1472,25636,1476,25640,1480,25644,1484
  .long 25648,1488,25652,1492,25656,1496,25660,1500,25664,1504,25668,1508,3112,1600,3116,1604
  .long 3360,1608,3364,1612,3368,1616,3372,1620,3616,1624,3620,1628,3624,1632,3628,1636
  .long 3872,1640,3876,1644,3880,1648,3884,1652,5152,1656,5156,1660,5160,1664,5164,1668
  .long 3128,1680,3132,1684,3376,1688,3380,1692,3384,1696,3388,1700,3632,1704,3636,1708
  .long 3640,1712,3644,1716,3888,1720,3892,1724,3896,1728,3900,1732,5168,1736,5172,1740
  .long 5176,1744,5180,1748,3144,1760,3148,1764,3392,1768,3396,1772,3400,1776,3404,1780
  .long 3648,1784,3652,1788,3656,1792,3660,1796,3904,1800,3908,1804,3912,1808,3916,1812
  .long 5184,1816,5188,1820,5192,1824,5196,1828,3160,1840,3164,1844,3408,1848,3412,1852
  .long 3416,1856,3420,1860,3664,1864,3668,1868,3672,1872,3676,1876,3920,1880,3924,1884
  .long 3928,1888,3932,1892,5200,1896,5204,1900,5208,1904,5212,1908,3176,1920,3180,1924
  .long 3424,1928,3428,1932,3432,1936,3436,1940,3680,1944,3684,1948,3688,1952,3692,1956
  .long 3936,1960,3940,1964,3944,1968,3948,1972,5216,1976,5220,1980,5224,1984,5228,1988
  .long 3192,2000,3196,2004,3440,2008,3444,2012,3448,2016,3452,2020,3696,2024,3700,2028
  .long 3704,2032,3708,2036,3952,2040,3956,2044,3960,2048,3964,2052,5232,2056,5236,2060
  .long 5240,2064,5244,2068,3208,2080,3212,2084,3456,2088,3460,2092,3464,2096,3468,2100
  .long 3712,2104,3716,2108,3720,2112,3724,2116,3968,2120,3972,2124,3976,2128,3980,2132
  .long 5248,2136,5252,2140,5256,2144,5260,2148,3224,2160,3228,2164,3472,2168,3476,2172
  .long 3480,2176,3484,2180,3728,2184,3732,2188,3736,2192,3740,2196,3984,2200,3988,2204
  .long 3992,2208,3996,2212,5264,2216,5268,2220,5272,2224,5276,2228,3240,2240,3244,2244
  .long 3488,2248,3492,2252,3496,2256,3500,2260,3744,2264,3748,2268,3752,2272,3756,2276
  .long 4000,2280,4004,2284,4008,2288,4012,2292,5280,2296,5284,2300,5288,2304,5292,2308
  .long 3256,2320,3260,2324,3504,2328,3508,2332,3512,2336,3516,2340,3760,2344,3764,2348
  .long 3768,2352,3772,2356,4016,2360,4020,2364,4024,2368,4028,2372,5296,2376,5300,2380
  .long 5304,2384,5308,2388,3272,2400,3276,2404,3520,2408,3524,2412,3528,2416,3532,2420
  .long 3776,2424,3780,2428,3784,2432,3788,2436,4032,2440,4036,2444,4040,2448,4044,2452
  .long 5312,2456,5316,2460,5320,2464,5324,2468,3288,2480,3292,2484,3536,2488,3540,2492
  .long 3544,2496,3548,2500,3792,2504,3796,2508,3800,2512,3804,2516,4048,2520,4052,2524
  .long 4056,2528,4060,2532,5328,2536,5332,2540,5336,2544,5340,2548,3304,2560,3308,2564
  .long 3552,2568,3556,2572,3560,2576,3564,2580,3808,2584,3812,2588,3816,2592,3820,2596
  .long 4064,2600,4068,2604,4072,2608,4076,2612,5344,2616,5348,2620,5352,2624,5356,2628
  .long 3320,2640,3324,2644,3568,2648,3572,2652,3576,2656,3580,2660,3824,2664,3828,2668
  .long 3832,2672,3836,2676,4080,2680,4084,2684,4088,2688,4092,2692,5360,2696,5364,2700
  .long 5368,2704,5372,2708,4104,2720,4108,2724,4352,2728,4356,2732,4360,2736,4364,2740
  .long 4608,2744,4612,2748,4616,2752,4620,2756,4864,2760,4868,2764,4872,2768,4876,2772
  .long 6144,2776,6148,2780,6152,2784,6156,2788,4120,2800,4124,2804,4368,2808,4372,2812
  .long 4376,2816,4380,2820,4624,2824,4628,2828,4632,2832,4636,2836,4880,2840,4884,2844
  .long 4888,2848,4892,2852,6160,2856,6164,2860,6168,2864,6172,2868,4136,2880,4140,2884
  .long 4384,2888,4388,2892,4392,2896,4396,2900,4640,2904,4644,2908,4648,2912,4652,2916
  .long 4896,2920,4900,2924,4904,2928,4908,2932,6176,2936,6180,2940,6184,2944,6188,2948
  .long 4152,2960,4156,2964,4400,2968,4404,2972,4408,2976,4412,2980,4656,2984,4660,2988
  .long 4664,2992,4668,2996,4912,3000,4916,3004,4920,3008,4924,3012,6192,3016,6196,3020
  .long 6200,3024,6204,3028,25672,3040,25676,3044,25680,3048,25684,3052,25688,3056,25692,3060
  .long 25696,3064,25700,3068,25704,3072,25708,3076,25712,3080,25716,3084,25720,3088,25724,3092
  .long 25728,3096,25732,3100,25736,3104,25740,3108,6464,3200,6468,3204,6472,3208,6476,3212
  .long 6720,3216,6724,3220,6728,3224,6732,3228,6976,3232,6980,3236,6984,3240,6988,3244
  .long 8256,3248,8260,3252,8264,3256,8268,3260,8512,3264,8516,3268,6480,3280,6484,3284
  .long 6488,3288,6492,3292,6736,3296,6740,3300,6744,3304,6748,3308,6992,3312,6996,3316
  .long 7000,3320,7004,3324,8272,3328,8276,3332,8280,3336,8284,3340,8528,3344,8532,3348
  .long 6496,3360,6500,3364,6504,3368,6508,3372,6752,3376,6756,3380,6760,3384,6764,3388
  .long 7008,3392,7012,3396,7016,3400,7020,3404,8288,3408,8292,3412,8296,3416,8300,3420
  .long 8544,3424,8548,3428,6512,3440,6516,3444,6520,3448,6524,3452,6768,3456,6772,3460
  .long 6776,3464,6780,3468,7024,3472,7028,3476,7032,3480,7036,3484,8304,3488,8308,3492
  .long 8312,3496,8316,3500,8560,3504,8564,3508,6528,3520,6532,3524,6536,3528,6540,3532
  .long 6784,3536,6788,3540,6792,3544,6796,3548,7040,3552,7044,3556,7048,3560,7052,3564
  .long 8320,3568,8324,3572,8328,3576,8332,3580,8576,3584,8580,3588,6544,3600,6548,3604
  .long 6552,3608,6556,3612,6800,3616,6804,3620,6808,3624,6812,3628,7056,3632,7060,3636
  .long 7064,3640,7068,3644,8336,3648,8340,3652,8344,3656,8348,3660,8592,3664,8596,3668
  .long 6560,3680,6564,3684,6568,3688,6572,3692,6816,3696,6820,3700,6824,3704,6828,3708
  .long 7072,3712,7076,3716,7080,3720,7084,3724,8352,3728,8356,3732,8360,3736,8364,3740
  .long 8608,3744,8612,3748,6576,3760,6580,3764,6584,3768,6588,3772,6832,3776,6836,3780
  .long 6840,3784,6844,3788,7088,3792,7092,3796,7096,3800,7100,3804,8368,3808,8372,3812
  .long 8376,3816,8380,3820,8624,3824,8628,3828,6592,3840,6596,3844,6600,3848,6604,3852
  .long 6848,3856,6852,3860,6856,3864,6860,3868,7104,3872,7108,3876,7112,3880,7116,3884
  .long 8384,3888,8388,3892,8392,3896,8396,3900,8640,3904,8644,3908,6608,3920,6612,3924
  .long 6616,3928,6620,3932,6864,3936,6868,3940,6872,3944,6876,3948,7120,3952,7124,3956
  .long 7128,3960,7132,3964,8400,3968,8404,3972,8408,3976,8412,3980,8656,3984,8660,3988
  .long 6624,4000,6628,4004,6632,4008,6636,4012,6880,4016,6884,4020,6888,4024,6892,4028
  .long 7136,4032,7140,4036,7144,4040,7148,4044,8416,4048,8420,4052,8424,4056,8428,4060
  .long 8672,4064,8676,4068,6640,4080,6644,4084,6648,4088,6652,4092,6896,4096,6900,4100
  .long 6904,4104,6908,4108,7152,4112,7156,4116,7160,4120,7164,4124,8432,4128,8436,4132
  .long 8440,4136,8444,4140,8688,4144,8692,4148,7424,4160,7428,4164,7432,4168,7436,4172
  .long 7680,4176,7684,4180,7688,4184,7692,4188,7936,4192,7940,4196,7944,4200,7948,4204
  .long 9216,4208,9220,4212,9224,4216,9228,4220,9472,4224,9476,4228,7440,4240,7444,4244
  .long 7448,4248,7452,4252,7696,4256,7700,4260,7704,4264,7708,4268,7952,4272,7956,4276
  .long 7960,4280,7964,4284,9232,4288,9236,4292,9240,4296,9244,4300,9488,4304,9492,4308
  .long 7456,4320,7460,4324,7464,4328,7468,4332,7712,4336,7716,4340,7720,4344,7724,4348
  .long 7968,4352,7972,4356,7976,4360,7980,4364,9248,4368,9252,4372,9256,4376,9260,4380
  .long 9504,4384,9508,4388,7472,4400,7476,4404,7480,4408,7484,4412,7728,4416,7732,4420
  .long 7736,4424,7740,4428,7984,4432,7988,4436,7992,4440,7996,4444,9264,4448,9268,4452
  .long 9272,4456,9276,4460,9520,4464,9524,4468,7488,4480,7492,4484,7496,4488,7500,4492
  .long 7744,4496,7748,4500,7752,4504,7756,4508,8000,4512,8004,4516,8008,4520,8012,4524
  .long 9280,4528,9284,4532,9288,4536,9292,4540,9536,4544,9540,4548,7504,4560,7508,4564
  .long 7512,4568,7516,4572,7760,4576,7764,4580,7768,4584,7772,4588,8016,4592,8020,4596
  .long 8024,4600,8028,4604,9296,4608,9300,4612,9304,4616,9308,4620,9552,4624,9556,4628
  .long 25744,4640,25748,4644,25752,4648,25756,4652,25760,4656,25764,4660,25768,4664,25772,4668
  .long 25776,4672,25780,4676,25784,4680,25788,4684,25792,4688,25796,4692,25800,4696,25804,4700
  .long 25808,4704,25812,4708,9576,4800,9580,4804,9824,4808,9828,4812,9832,4816,9836,4820
  .long 10080,4824,10084,4828,10088,4832,10092,4836,11360,4840,11364,4844,11368,4848,11372,4852
  .long 11616,4856,11620,4860,11624,4864,11628,4868,9592,4880,9596,4884,9840,4888,9844,4892
  .long 9848,4896,9852,4900,10096,4904,10100,4908,10104,4912,10108,4916,11376,4920,11380,4924
  .long 11384,4928,11388,4932,11632,4936,11636,4940,11640,4944,11644,4948,9608,4960,9612,4964
  .long 9856,4968,9860,4972,9864,4976,9868,4980,10112,4984,10116,4988,10120,4992,10124,4996
  .long 11392,5000,11396,5004,11400,5008,11404,5012,11648,5016,11652,5020,11656,5024,11660,5028
  .long 9624,5040,9628,5044,9872,5048,9876,5052,9880,5056,9884,5060,10128,5064,10132,5068
  .long 10136,5072,10140,5076,11408,5080,11412,5084,11416,5088,11420,5092,11664,5096,11668,5100
  .long 11672,5104,11676,5108,9640,5120,9644,5124,9888,5128,9892,5132,9896,5136,9900,5140
  .long 10144,5144,10148,5148,10152,5152,10156,5156,11424,5160,11428,5164,11432,5168,11436,5172
  .long 11680,5176,11684,5180,11688,5184,11692,5188,9656,5200,9660,5204,9904,5208,9908,5212
  .long 9912,5216,9916,5220,10160,5224,10164,5228,10168,5232,10172,5236,11440,5240,11444,5244
  .long 11448,5248,11452,5252,11696,5256,11700,5260,11704,5264,11708,5268,9672,5280,9676,5284
  .long 9920,5288,9924,5292,9928,5296,9932,5300,10176,5304,10180,5308,10184,5312,10188,5316
  .long 11456,5320,11460,5324,11464,5328,11468,5332,11712,5336,11716,5340,11720,5344,11724,5348
  .long 9688,5360,9692,5364,9936,5368,9940,5372,9944,5376,9948,5380,10192,5384,10196,5388
  .long 10200,5392,10204,5396,11472,5400,11476,5404,11480,5408,11484,5412,11728,5416,11732,5420
  .long 11736,5424,11740,5428,9704,5440,9708,5444,9952,5448,9956,5452,9960,5456,9964,5460
  .long 10208,5464,10212,5468,10216,5472,10220,5476,11488,5480,11492,5484,11496,5488,11500,5492
  .long 11744,5496,11748,5500,11752,5504,11756,5508,9720,5520,9724,5524,9968,5528,9972,5532
  .long 9976,5536,9980,5540,10224,5544,10228,5548,10232,5552,10236,5556,11504,5560,11508,5564
  .long 11512,5568,11516,5572,11760,5576,11764,5580,11768,5584,11772,5588,10504,5600,10508,5604
  .long 10752,5608,10756,5612,10760,5616,10764,5620,11008,5624,11012,5628,11016,5632,11020,5636
  .long 12288,5640,12292,5644,12296,5648,12300,5652,12544,5656,12548,5660,12552,5664,12556,5668
  .long 10520,5680,10524,5684,10768,5688,10772,5692,10776,5696,10780,5700,11024,5704,11028,5708
  .long 11032,5712,11036,5716,12304,5720,12308,5724,12312,5728,12316,5732,12560,5736,12564,5740
  .long 12568,5744,12572,5748,10536,5760,10540,5764,10784,5768,10788,5772,10792,5776,10796,5780
  .long 11040,5784,11044,5788,11048,5792,11052,5796,12320,5800,12324,5804,12328,5808,12332,5812
  .long 12576,5816,12580,5820,12584,5824,12588,5828,10552,5840,10556,5844,10800,5848,10804,5852
  .long 10808,5856,10812,5860,11056,5864,11060,5868,11064,5872,11068,5876,12336,5880,12340,5884
  .long 12344,5888,12348,5892,12592,5896,12596,5900,12600,5904,12604,5908,10568,5920,10572,5924
  .long 10816,5928,10820,5932,10824,5936,10828,5940,11072,5944,11076,5948,11080,5952,11084,5956
  .long 12352,5960,12356,5964,12360,5968,12364,5972,12608,5976,12612,5980,12616,5984,12620,5988
  .long 10584,6000,10588,6004,10832,6008,10836,6012,10840,6016,10844,6020,11088,6024,11092,6028
  .long 11096,6032,11100,6036,12368,6040,12372,6044,12376,6048,12380,6052,12624,6056,12628,6060
  .long 12632,6064,12636,6068,10600,6080,10604,6084,10848,6088,10852,6092,10856,6096,10860,6100
  .long 11104,6104,11108,6108,11112,6112,11116,6116,12384,6120,12388,6124,12392,6128,12396,6132
  .long 12640,6136,12644,6140,12648,6144,12652,6148,10616,6160,10620,6164,10864,6168,10868,6172
  .long 10872,6176,10876,6180,11120,6184,11124,6188,11128,6192,11132,6196,12400,6200,12404,6204
  .long 12408,6208,12412,6212,12656,6216,12660,6220,12664,6224,12668,6228,25816,6240,25820,6244
  .long 25824,6248,25828,6252,25832,6256,25836,6260,25840,6264,25844,6268,25848,6272,25852,6276
  .long 25856,6280,25860,6284,25864,6288,25868,6292,25872,6296,25876,6300,25880,6304,25884,6308
  .long 12928,6400,12932,6404,12936,6408,12940,6412,13184,6416,13188,6420,13192,6424,13196,6428
  .long 14464,6432,14468,6436,14472,6440,14476,6444,14720,6448,14724,6452,14728,6456,14732,6460
  .long 14976,6464,14980,6468,12944,6480,12948,6484,12952,6488,12956,6492,13200,6496,13204,6500
  .long 13208,6504,13212,6508,14480,6512,14484,6516,14488,6520,14492,6524,14736,6528,14740,6532
  .long 14744,6536,14748,6540,14992,6544,14996,6548,12960,6560,12964,6564,12968,6568,12972,6572
  .long 13216,6576,13220,6580,13224,6584,13228,6588,14496,6592,14500,6596,14504,6600,14508,6604
  .long 14752,6608,14756,6612,14760,6616,14764,6620,15008,6624,15012,6628,12976,6640,12980,6644
  .long 12984,6648,12988,6652,13232,6656,13236,6660,13240,6664,13244,6668,14512,6672,14516,6676
  .long 14520,6680,14524,6684,14768,6688,14772,6692,14776,6696,14780,6700,15024,6704,15028,6708
  .long 12992,6720,12996,6724,13000,6728,13004,6732,13248,6736,13252,6740,13256,6744,13260,6748
  .long 14528,6752,14532,6756,14536,6760,14540,6764,14784,6768,14788,6772,14792,6776,14796,6780
  .long 15040,6784,15044,6788,13008,6800,13012,6804,13016,6808,13020,6812,13264,6816,13268,6820
  .long 13272,6824,13276,6828,14544,6832,14548,6836,14552,6840,14556,6844,14800,6848,14804,6852
  .long 14808,6856,14812,6860,15056,6864,15060,6868,13024,6880,13028,6884,13032,6888,13036,6892
  .long 13280,6896,13284,6900,13288,6904,13292,6908,14560,6912,14564,6916,14568,6920,14572,6924
  .long 14816,6928,14820,6932,14824,6936,14828,6940,15072,6944,15076,6948,13040,6960,13044,6964
  .long 13048,6968,13052,6972,13296,6976,13300,6980,13304,6984,13308,6988,14576,6992,14580,6996
  .long 14584,7000,14588,7004,14832,7008,14836,7012,14840,7016,14844,7020,15088,7024,15092,7028
  .long 13824,7040,13828,7044,13832,7048,13836,7052,14080,7056,14084,7060,14088,7064,14092,7068
  .long 15360,7072,15364,7076,15368,7080,15372,7084,15616,7088,15620,7092,15624,7096,15628,7100
  .long 15872,7104,15876,7108,13840,7120,13844,7124,13848,7128,13852,7132,14096,7136,14100,7140
  .long 14104,7144,14108,7148,15376,7152,15380,7156,15384,7160,15388,7164,15632,7168,15636,7172
  .long 15640,7176,15644,7180,15888,7184,15892,7188,13856,7200,13860,7204,13864,7208,13868,7212
  .long 14112,7216,14116,7220,14120,7224,14124,7228,15392,7232,15396,7236,15400,7240,15404,7244
  .long 15648,7248,15652,7252,15656,7256,15660,7260,15904,7264,15908,7268,13872,7280,13876,7284
  .long 13880,7288,13884,7292,14128,7296,14132,7300,14136,7304,14140,7308,15408,7312,15412,7316
  .long 15416,7320,15420,7324,15664,7328,15668,7332,15672,7336,15676,7340,15920,7344,15924,7348
  .long 13888,7360,13892,7364,13896,7368,13900,7372,14144,7376,14148,7380,14152,7384,14156,7388
  .long 15424,7392,15428,7396,15432,7400,15436,7404,15680,7408,15684,7412,15688,7416,15692,7420
  .long 15936,7424,15940,7428,13904,7440,13908,7444,13912,7448,13916,7452,14160,7456,14164,7460
  .long 14168,7464,14172,7468,15440,7472,15444,7476,15448,7480,15452,7484,15696,7488,15700,7492
  .long 15704,7496,15708,7500,15952,7504,15956,7508,13920,7520,13924,7524,13928,7528,13932,7532
  .long 14176,7536,14180,7540,14184,7544,14188,7548,15456,7552,15460,7556,15464,7560,15468,7564
  .long 15712,7568,15716,7572,15720,7576,15724,7580,15968,7584,15972,7588,13936,7600,13940,7604
  .long 13944,7608,13948,7612,14192,7616,14196,7620,14200,7624,14204,7628,15472,7632,15476,7636
  .long 15480,7640,15484,7644,15728,7648,15732,7652,15736,7656,15740,7660,15984,7664,15988,7668
  .long 13952,7680,13956,7684,13960,7688,13964,7692,14208,7696,14212,7700,14216,7704,14220,7708
  .long 15488,7712,15492,7716,15496,7720,15500,7724,15744,7728,15748,7732,15752,7736,15756,7740
  .long 16000,7744,16004,7748,13968,7760,13972,7764,13976,7768,13980,7772,14224,7776,14228,7780
  .long 14232,7784,14236,7788,15504,7792,15508,7796,15512,7800,15516,7804,15760,7808,15764,7812
  .long 15768,7816,15772,7820,16016,7824,16020,7828,25888,7840,25892,7844,25896,7848,25900,7852
  .long 25904,7856,25908,7860,25912,7864,25916,7868,25920,7872,25924,7876,25928,7880,25932,7884
  .long 25936,7888,25940,7892,25944,7896,25948,7900,25952,7904,25956,7908,16040,8000,16044,8004
  .long 16288,8008,16292,8012,16296,8016,16300,8020,17568,8024,17572,8028,17576,8032,17580,8036
  .long 17824,8040,17828,8044,17832,8048,17836,8052,18080,8056,18084,8060,18088,8064,18092,8068
  .long 16056,8080,16060,8084,16304,8088,16308,8092,16312,8096,16316,8100,17584,8104,17588,8108
  .long 17592,8112,17596,8116,17840,8120,17844,8124,17848,8128,17852,8132,18096,8136,18100,8140
  .long 18104,8144,18108,8148,16072,8160,16076,8164,16320,8168,16324,8172,16328,8176,16332,8180
  .long 17600,8184,17604,8188,17608,8192,17612,8196,17856,8200,17860,8204,17864,8208,17868,8212
  .long 18112,8216,18116,8220,18120,8224,18124,8228,16088,8240,16092,8244,16336,8248,16340,8252
  .long 16344,8256,16348,8260,17616,8264,17620,8268,17624,8272,17628,8276,17872,8280,17876,8284
  .long 17880,8288,17884,8292,18128,8296,18132,8300,18136,8304,18140,8308,16104,8320,16108,8324
  .long 16352,8328,16356,8332,16360,8336,16364,8340,17632,8344,17636,8348,17640,8352,17644,8356
  .long 17888,8360,17892,8364,17896,8368,17900,8372,18144,8376,18148,8380,18152,8384,18156,8388
  .long 16120,8400,16124,8404,16368,8408,16372,8412,16376,8416,16380,8420,17648,8424,17652,8428
  .long 17656,8432,17660,8436,17904,8440,17908,8444,17912,8448,17916,8452,18160,8456,18164,8460
  .long 18168,8464,18172,8468,16904,8480,16908,8484,17152,8488,17156,8492,17160,8496,17164,8500
  .long 18432,8504,18436,8508,18440,8512,18444,8516,18688,8520,18692,8524,18696,8528,18700,8532
  .long 18944,8536,18948,8540,18952,8544,18956,8548,16920,8560,16924,8564,17168,8568,17172,8572
  .long 17176,8576,17180,8580,18448,8584,18452,8588,18456,8592,18460,8596,18704,8600,18708,8604
  .long 18712,8608,18716,8612,18960,8616,18964,8620,18968,8624,18972,8628,16936,8640,16940,8644
  .long 17184,8648,17188,8652,17192,8656,17196,8660,18464,8664,18468,8668,18472,8672,18476,8676
  .long 18720,8680,18724,8684,18728,8688,18732,8692,18976,8696,18980,8700,18984,8704,18988,8708
  .long 16952,8720,16956,8724,17200,8728,17204,8732,17208,8736,17212,8740,18480,8744,18484,8748
  .long 18488,8752,18492,8756,18736,8760,18740,8764,18744,8768,18748,8772,18992,8776,18996,8780
  .long 19000,8784,19004,8788,16968,8800,16972,8804,17216,8808,17220,8812,17224,8816,17228,8820
  .long 18496,8824,18500,8828,18504,8832,18508,8836,18752,8840,18756,8844,18760,8848,18764,8852
  .long 19008,8856,19012,8860,19016,8864,19020,8868,16984,8880,16988,8884,17232,8888,17236,8892
  .long 17240,8896,17244,8900,18512,8904,18516,8908,18520,8912,18524,8916,18768,8920,18772,8924
  .long 18776,8928,18780,8932,19024,8936,19028,8940,19032,8944,19036,8948,17000,8960,17004,8964
  .long 17248,8968,17252,8972,17256,8976,17260,8980,18528,8984,18532,8988,18536,8992,18540,8996
  .long 18784,9000,18788,9004,18792,9008,18796,9012,19040,9016,19044,9020,19048,9024,19052,9028
  .long 17016,9040,17020,9044,17264,9048,17268,9052,17272,9056,17276,9060,18544,9064,18548,9068
  .long 18552,9072,18556,9076,18800,9080,18804,9084,18808,9088,18812,9092,19056,9096,19060,9100
  .long 19064,9104,19068,9108,17032,9120,17036,9124,17280,9128,17284,9132,17288,9136,17292,9140
  .long 18560,9144,18564,9148,18568,9152,18572,9156,18816,9160,18820,9164,18824,9168,18828,9172
  .long 19072,9176,19076,9180,19080,9184,19084,9188,17048,9200,17052,9204,17296,9208,17300,9212
  .long 17304,9216,17308,9220,18576,9224,18580,9228,18584,9232,18588,9236,18832,9240,18836,9244
  .long 18840,9248,18844,9252,19088,9256,19092,9260,19096,9264,19100,9268,17064,9280,17068,9284
  .long 17312,9288,17316,9292,17320,9296,17324,9300,18592,9304,18596,9308,18600,9312,18604,9316
  .long 18848,9320,18852,9324,18856,9328,18860,9332,19104,9336,19108,9340,19112,9344,19116,9348
  .long 17080,9360,17084,9364,17328,9368,17332,9372,17336,9376,17340,9380,18608,9384,18612,9388
  .long 18616,9392,18620,9396,18864,9400,18868,9404,18872,9408,18876,9412,19120,9416,19124,9420
  .long 19128,9424,19132,9428,25960,9440,25964,9444,25968,9448,25972,9452,25976,9456,25980,9460
  .long 25984,9464,25988,9468,25992,9472,25996,9476,26000,9480,26004,9484,26008,9488,26012,9492
  .long 26016,9496,26020,9500,26024,9504,26028,9508,19392,9600,19396,9604,19400,9608,19404,9612
  .long 20672,9616,20676,9620,20680,9624,20684,9628,20928,9632,20932,9636,20936,9640,20940,9644
  .long 21184,9648,21188,9652,21192,9656,21196,9660,21440,9664,21444,9668,19408,9680,19412,9684
  .long 19416,9688,19420,9692,20688,9696,20692,9700,20696,9704,20700,9708,20944,9712,20948,9716
  .long 20952,9720,20956,9724,21200,9728,21204,9732,21208,9736,21212,9740,21456,9744,21460,9748
  .long 19424,9760,19428,9764,19432,9768,19436,9772,20704,9776,20708,9780,20712,9784,20716,9788
  .long 20960,9792,20964,9796,20968,9800,20972,9804,21216,9808,21220,9812,21224,9816,21228,9820
  .long 21472,9824,21476,9828,19440,9840,19444,9844,19448,9848,19452,9852,20720,9856,20724,9860
  .long 20728,9864,20732,9868,20976,9872,20980,9876,20984,9880,20988,9884,21232,9888,21236,9892
  .long 21240,9896,21244,9900,21488,9904,21492,9908,20224,9920,20228,9924,20232,9928,20236,9932
  .long 21504,9936,21508,9940,21512,9944,21516,9948,21760,9952,21764,9956,21768,9960,21772,9964
  .long 22016,9968,22020,9972,22024,9976,22028,9980,22272,9984,22276,9988,20240,10000,20244,10004
  .long 20248,10008,20252,10012,21520,10016,21524,10020,21528,10024,21532,10028,21776,10032,21780,10036
  .long 21784,10040,21788,10044,22032,10048,22036,10052,22040,10056,22044,10060,22288,10064,22292,10068
  .long 20256,10080,20260,10084,20264,10088,20268,10092,21536,10096,21540,10100,21544,10104,21548,10108
  .long 21792,10112,21796,10116,21800,10120,21804,10124,22048,10128,22052,10132,22056,10136,22060,10140
  .long 22304,10144,22308,10148,20272,10160,20276,10164,20280,10168,20284,10172,21552,10176,21556,10180
  .long 21560,10184,21564,10188,21808,10192,21812,10196,21816,10200,21820,10204,22064,10208,22068,10212
  .long 22072,10216,22076,10220,22320,10224,22324,10228,20288,10240,20292,10244,20296,10248,20300,10252
  .long 21568,10256,21572,10260,21576,10264,21580,10268,21824,10272,21828,10276,21832,10280,21836,10284
  .long 22080,10288,22084,10292,22088,10296,22092,10300,22336,10304,22340,10308,20304,10320,20308,10324
  .long 20312,10328,20316,10332,21584,10336,21588,10340,21592,10344,21596,10348,21840,10352,21844,10356
  .long 21848,10360,21852,10364,22096,10368,22100,10372,22104,10376,22108,10380,22352,10384,22356,10388
  .long 20320,10400,20324,10404,20328,10408,20332,10412,21600,10416,21604,10420,21608,10424,21612,10428
  .long 21856,10432,21860,10436,21864,10440,21868,10444,22112,10448,22116,10452,22120,10456,22124,10460
  .long 22368,10464,22372,10468,20336,10480,20340,10484,20344,10488,20348,10492,21616,10496,21620,10500
  .long 21624,10504,21628,10508,21872,10512,21876,10516,21880,10520,21884,10524,22128,10528,22132,10532
  .long 22136,10536,22140,10540,22384,10544,22388,10548,20352,10560,20356,10564,20360,10568,20364,10572
  .long 21632,10576,21636,10580,21640,10584,21644,10588,21888,10592,21892,10596,21896,10600,21900,10604
  .long 22144,10608,22148,10612,22152,10616,22156,10620,22400,10624,22404,10628,20368,10640,20372,10644
  .long 20376,10648,20380,10652,21648,10656,21652,10660,21656,10664,21660,10668,21904,10672,21908,10676
  .long 21912,10680,21916,10684,22160,10688,22164,10692,22168,10696,22172,10700,22416,10704,22420,10708
  .long 20384,10720,20388,10724,20392,10728,20396,10732,21664,10736,21668,10740,21672,10744,21676,10748
  .long 21920,10752,21924,10756,21928,10760,21932,10764,22176,10768,22180,10772,22184,10776,22188,10780
  .long 22432,10784,22436,10788,20400,10800,20404,10804,20408,10808,20412,10812,21680,10816,21684,10820
  .long 21688,10824,21692,10828,21936,10832,21940,10836,21944,10840,21948,10844,22192,10848,22196,10852
  .long 22200,10856,22204,10860,22448,10864,22452,10868,20416,10880,20420,10884,20424,10888,20428,10892
  .long 21696,10896,21700,10900,21704,10904,21708,10908,21952,10912,21956,10916,21960,10920,21964,10924
  .long 22208,10928,22212,10932,22216,10936,22220,10940,22464,10944,22468,10948,20432,10960,20436,10964
  .long 20440,10968,20444,10972,21712,10976,21716,10980,21720,10984,21724,10988,21968,10992,21972,10996
  .long 21976,11000,21980,11004,22224,11008,22228,11012,22232,11016,22236,11020,22480,11024,22484,11028
  .long 26032,11040,26036,11044,26040,11048,26044,11052,26048,11056,26052,11060,26056,11064,26060,11068
  .long 26064,11072,26068,11076,26072,11080,26076,11084,26080,11088,26084,11092,26088,11096,26092,11100
  .long 26096,11104,26100,11108,22504,11200,22508,11204,23776,11208,23780,11212,23784,11216,23788,11220
  .long 24032,11224,24036,11228,24040,11232,24044,11236,24288,11240,24292,11244,24296,11248,24300,11252
  .long 24544,11256,24548,11260,24552,11264,24556,11268,22520,11280,22524,11284,23792,11288,23796,11292
  .long 23800,11296,23804,11300,24048,11304,24052,11308,24056,11312,24060,11316,24304,11320,24308,11324
  .long 24312,11328,24316,11332,24560,11336,24564,11340,24568,11344,24572,11348,23304,11360,23308,11364
  .long 24576,11368,24580,11372,24584,11376,24588,11380,24832,11384,24836,11388,24840,11392,24844,11396
  .long 25088,11400,25092,11404,25096,11408,25100,11412,25344,11416,25348,11420,25352,11424,25356,11428
  .long 23320,11440,23324,11444,24592,11448,24596,11452,24600,11456,24604,11460,24848,11464,24852,11468
  .long 24856,11472,24860,11476,25104,11480,25108,11484,25112,11488,25116,11492,25360,11496,25364,11500
  .long 25368,11504,25372,11508,23336,11520,23340,11524,24608,11528,24612,11532,24616,11536,24620,11540
  .long 24864,11544,24868,11548,24872,11552,24876,11556,25120,11560,25124,11564,25128,11568,25132,11572
  .long 25376,11576,25380,11580,25384,11584,25388,11588,23352,11600,23356,11604,24624,11608,24628,11612
  .long 24632,11616,24636,11620,24880,11624,24884,11628,24888,11632,24892,11636,25136,11640,25140,11644
  .long 25144,11648,25148,11652,25392,11656,25396,11660,25400,11664,25404,11668,23368,11680,23372,11684
  .long 24640,11688,24644,11692,24648,11696,24652,11700,24896,11704,24900,11708,24904,11712,24908,11716
  .long 25152,11720,25156,11724,25160,11728,25164,11732,25408,11736,25412,11740,25416,11744,25420,11748
  .long 23384,11760,23388,11764,24656,11768,24660,11772,24664,11776,24668,11780,24912,11784,24916,11788
  .long 24920,11792,24924,11796,25168,11800,25172,11804,25176,11808,25180,11812,25424,11816,25428,11820
  .long 25432,11824,25436,11828,23400,11840,23404,11844,24672,11848,24676,11852,24680,11856,24684,11860
  .long 24928,11864,24932,11868,24936,11872,24940,11876,25184,11880,25188,11884,25192,11888,25196,11892
  .long 25440,11896,25444,11900,25448,11904,25452,11908,23416,11920,23420,11924,24688,11928,24692,11932
  .long 24696,11936,24700,11940,24944,11944,24948,11948,24952,11952,24956,11956,25200,11960,25204,11964
  .long 25208,11968,25212,11972,25456,11976,25460,11980,25464,11984,25468,11988,23432,12000,23436,12004
  .long 24704,12008,24708,12012,24712,12016,24716,12020,24960,12024,24964,12028,24968,12032,24972,12036
  .long 25216,12040,25220,12044,25224,12048,25228,12052,25472,12056,25476,12060,25480,12064,25484,12068
  .long 23448,12080,23452,12084,24720,12088,24724,12092,24728,12096,24732,12100,24976,12104,24980,12108
  .long 24984,12112,24988,12116,25232,12120,25236,12124,25240,12128,25244,12132,25488,12136,25492,12140
  .long 25496,12144,25500,12148,23464,12160,23468,12164,24736,12168,24740,12172,24744,12176,24748,12180
  .long 24992,12184,24996,12188,25000,12192,25004,12196,25248,12200,25252,12204,25256,12208,25260,12212
  .long 25504,12216,25508,12220,25512,12224,25516,12228,23480,12240,23484,12244,24752,12248,24756,12252
  .long 24760,12256,24764,12260,25008,12264,25012,12268,25016,12272,25020,12276,25264,12280,25268,12284
  .long 25272,12288,25276,12292,25520,12296,25524,12300,25528,12304,25532,12308,23496,12320,23500,12324
  .long 24768,12328,24772,12332,24776,12336,24780,12340,25024,12344,25028,12348,25032,12352,25036,12356
  .long 25280,12360,25284,12364,25288,12368,25292,12372,25536,12376,25540,12380,25544,12384,25548,12388
  .long 23512,12400,23516,12404,24784,12408,24788,12412,24792,12416,24796,12420,25040,12424,25044,12428
  .long 25048,12432,25052,12436,25296,12440,25300,12444,25304,12448,25308,12452,25552,12456,25556,12460
  .long 25560,12464,25564,12468,23528,12480,23532,12484,24800,12488,24804,12492,24808,12496,24812,12500
  .long 25056,12504,25060,12508,25064,12512,25068,12516,25312,12520,25316,12524,25320,12528,25324,12532
  .long 25568,12536,25572,12540,25576,12544,25580,12548,23544,12560,23548,12564,24816,12568,24820,12572
  .long 24824,12576,24828,12580,25072,12584,25076,12588,25080,12592,25084,12596,25328,12600,25332,12604
  .long 25336,12608,25340,12612,25584,12616,25588,12620,25592,12624,25596,12628,26104,12640,26108,12644
  .long 26112,12648,26116,12652,26120,12656,26124,12660,26128,12664,26132,12668,26136,12672,26140,12676
  .long 26144,12680,26148,12684,26152,12688,26156,12692,26160,12696,26164,12700,26168,12704,26172,12708
  .long 0,2147483632
.p2align 7
.type L_tab_pq,@object
L_tab_pq:
  .long 110592,110596,110848,110624,110896,110900,111152,110928,111200,111204,111456,111232,111504,111508,111760,111536
  .long 111808,111812,112064,111840,112112,112116,112368,112144,112416,112420,112672,112448,112720,112724,112976,112752
  .long 113024,113028,113280,113056,113328,113332,113584,113360,113632,113636,113888,113664,113936,113940,114192,113968
  .long 114240,114244,114496,114272,114544,114548,114800,114576,114848,114852,115104,114880,115152,115156,115408,115184
  .long 110600,110604,110628,110632,110904,110908,110932,110936,111208,111212,111236,111240,111512,111516,111540,111544
  .long 111816,111820,111844,111848,112120,112124,112148,112152,112424,112428,112452,112456,112728,112732,112756,112760
  .long 113032,113036,113060,113064,113336,113340,113364,113368,113640,113644,113668,113672,113944,113948,113972,113976
  .long 114248,114252,114276,114280,114552,114556,114580,114584,114856,114860,114884,114888,115160,115164,115188,115192
  .long 110608,110612,110636,110640,110912,110916,110940,110944,111216,111220,111244,111248,111520,111524,111548,111552
  .long 111824,111828,111852,111856,112128,112132,112156,112160,112432,112436,112460,112464,112736,112740,112764,112768
  .long 113040,113044,113068,113072,113344,113348,113372,113376,113648,113652,113676,113680,113952,113956,113980,113984
  .long 114256,114260,114284,114288,114560,114564,114588,114592,114864,114868,114892,114896,115168,115172,115196,115200
  .long 110616,110620,110644,110648,110920,110924,110948,110952,111224,111228,111252,111256,111528,111532,111556,111560
  .long 111832,111836,111860,111864,112136,112140,112164,112168,112440,112444,112468,112472,112744,112748,112772,112776
  .long 113048,113052,113076,113080,113352,113356,113380,113384,113656,113660,113684,113688,113960,113964,113988,113992
  .long 114264,114268,114292,114296,114568,114572,114596,114600,114872,114876,114900,114904,115176,115180,115204,115208
  .long 110652,110852,110680,110684,110956,111156,110984,110988,111260,111460,111288,111292,111564,111764,111592,111596
  .long 111868,112068,111896,111900,112172,112372,112200,112204,112476,112676,112504,112508,112780,112980,112808,112812
  .long 113084,113284,113112,113116,113388,113588,113416,113420,113692,113892,113720,113724,113996,114196,114024,114028
  .long 114300,114500,114328,114332,114604,114804,114632,114636,114908,115108,114936,114940,115212,115412,115240,115244
  .long 110656,110660,110856,110688,110960,110964,111160,110992,111264,111268,111464,111296,111568,111572,111768,111600
  .long 111872,111876,112072,111904,112176,112180,112376,112208,112480,112484,112680,112512,112784,112788,112984,112816
  .long 113088,113092,113288,113120,113392,113396,113592,113424,113696,113700,113896,113728,114000,114004,114200,114032
  .long 114304,114308,114504,114336,114608,114612,114808,114640,114912,114916,115112,114944,115216,115220,115416,115248
  .long 110664,110668,110692,110696,110968,110972,110996,111000,111272,111276,111300,111304,111576,111580,111604,111608
  .long 111880,111884,111908,111912,112184,112188,112212,112216,112488,112492,112516,112520,112792,112796,112820,112824
  .long 113096,113100,113124,113128,113400,113404,113428,113432,113704,113708,113732,113736,114008,114012,114036,114040
  .long 114312,114316,114340,114344,114616,114620,114644,114648,114920,114924,114948,114952,115224,115228,115252,115256
  .long 110672,110676,110700,110704,110976,110980,111004,111008,111280,111284,111308,111312,111584,111588,111612,111616
  .long 111888,111892,111916,111920,112192,112196,112220,112224,112496,112500,112524,112528,112800,112804,112828,112832
  .long 113104,113108,113132,113136,113408,113412,113436,113440,113712,113716,113740,113744,114016,114020,114044,114048
  .long 114320,114324,114348,114352,114624,114628,114652,114656,114928,114932,114956,114960,115232,115236,115260,115264
  .long 110708,110712,110736,110740,111012,111016,111040,111044,111316,111320,111344,111348,111620,111624,111648,111652
  .long 111924,111928,111952,111956,112228,112232,112256,112260,112532,112536,112560,112564,112836,112840,112864,112868
  .long 113140,113144,113168,113172,113444,113448,113472,113476,113748,113752,113776,113780,114052,114056,114080,114084
  .long 114356,114360,114384,114388,114660,114664,114688,114692,114964,114968,114992,114996,115268,115272,115296,115300
  .long 110716,110860,110744,110748,111020,111164,111048,111052,111324,111468,111352,111356,111628,111772,111656,111660
  .long 111932,112076,111960,111964,112236,112380,112264,112268,112540,112684,112568,112572,112844,112988,112872,112876
  .long 113148,113292,113176,113180,113452,113596,113480,113484,113756,113900,113784,113788,114060,114204,114088,114092
  .long 114364,114508,114392,114396,114668,114812,114696,114700,114972,115116,115000,115004,115276,115420,115304,115308
  .long 110720,110724,110864,110752,111024,111028,111168,111056,111328,111332,111472,111360,111632,111636,111776,111664
  .long 111936,111940,112080,111968,112240,112244,112384,112272,112544,112548,112688,112576,112848,112852,112992,112880
  .long 113152,113156,113296,113184,113456,113460,113600,113488,113760,113764,113904,113792,114064,114068,114208,114096
  .long 114368,114372,114512,114400,114672,114676,114816,114704,114976,114980,115120,115008,115280,115284,115424,115312
  .long 110728,110732,110756,110760,111032,111036,111060,111064,111336,111340,111364,111368,111640,111644,111668,111672
  .long 111944,111948,111972,111976,112248,112252,112276,112280,112552,112556,112580,112584,112856,112860,112884,112888
  .long 113160,113164,113188,113192,113464,113468,113492,113496,113768,113772,113796,113800,114072,114076,114100,114104
  .long 114376,114380,114404,114408,114680,114684,114708,114712,114984,114988,115012,115016,115288,115292,115316,115320
  .long 110764,110768,110792,110796,111068,111072,111096,111100,111372,111376,111400,111404,111676,111680,111704,111708
  .long 111980,111984,112008,112012,112284,112288,112312,112316,112588,112592,112616,112620,112892,112896,112920,112924
  .long 113196,113200,113224,113228,113500,113504,113528,113532,113804,113808,113832,113836,114108,114112,114136,114140
  .long 114412,114416,114440,114444,114716,114720,114744,114748,115020,115024,115048,115052,115324,115328,115352,115356
  .long 110772,110776,110800,110804,111076,111080,111104,111108,111380,111384,111408,111412,111684,111688,111712,111716
  .long 111988,111992,112016,112020,112292,112296,112320,112324,112596,112600,112624,112628,112900,112904,112928,112932
  .long 113204,113208,113232,113236,113508,113512,113536,113540,113812,113816,113840,113844,114116,114120,114144,114148
  .long 114420,114424,114448,114452,114724,114728,114752,114756,115028,115032,115056,115060,115332,115336,115360,115364
  .long 110780,110868,110808,110812,111084,111172,111112,111116,111388,111476,111416,111420,111692,111780,111720,111724
  .long 111996,112084,112024,112028,112300,112388,112328,112332,112604,112692,112632,112636,112908,112996,112936,112940
  .long 113212,113300,113240,113244,113516,113604,113544,113548,113820,113908,113848,113852,114124,114212,114152,114156
  .long 114428,114516,114456,114460,114732,114820,114760,114764,115036,115124,115064,115068,115340,115428,115368,115372
  .long 110784,110788,110872,110816,111088,111092,111176,111120,111392,111396,111480,111424,111696,111700,111784,111728
  .long 112000,112004,112088,112032,112304,112308,112392,112336,112608,112612,112696,112640,112912,112916,113000,112944
  .long 113216,113220,113304,113248,113520,113524,113608,113552,113824,113828,113912,113856,114128,114132,114216,114160
  .long 114432,114436,114520,114464,114736,114740,114824,114768,115040,115044,115128,115072,115344,115348,115432,115376
  .long 110820,110824,0,0,111124,111128,0,0,111428,111432,0,0,111732,111736,0,0
  .long 112036,112040,0,0,112340,112344,0,0,112644,112648,0,0,112948,112952,0,0
  .long 113252,113256,0,0,113556,113560,0,0,113860,113864,0,0,114164,114168,0,0
  .long 114468,114472,0,0,114772,114776,0,0,115076,115080,0,0,115380,115384,0,0
  .long 110828,110832,0,0,111132,111136,0,0,111436,111440,0,0,111740,111744,0,0
  .long 112044,112048,0,0,112348,112352,0,0,112652,112656,0,0,112956,112960,0,0
  .long 113260,113264,0,0,113564,113568,0,0,113868,113872,0,0,114172,114176,0,0
  .long 114476,114480,0,0,114780,114784,0,0,115084,115088,0,0,115388,115392,0,0
  .long 110836,110840,0,0,111140,111144,0,0,111444,111448,0,0,111748,111752,0,0
  .long 112052,112056,0,0,112356,112360,0,0,112660,112664,0,0,112964,112968,0,0
  .long 113268,113272,0,0,113572,113576,0,0,113876,113880,0,0,114180,114184,0,0
  .long 114484,114488,0,0,114788,114792,0,0,115092,115096,0,0,115396,115400,0,0
  .long 110844,110876,0,0,111148,111180,0,0,111452,111484,0,0,111756,111788,0,0
  .long 112060,112092,0,0,112364,112396,0,0,112668,112700,0,0,112972,113004,0,0
  .long 113276,113308,0,0,113580,113612,0,0,113884,113916,0,0,114188,114220,0,0
  .long 114492,114524,0,0,114796,114828,0,0,115100,115132,0,0,115404,115436,0,0
  .long 120320,120324,120576,120352,120624,120628,120880,120656,120928,120932,121184,120960,121232,121236,121488,121264
  .long 121536,121540,121792,121568,121840,121844,122096,121872,122144,122148,122400,122176,122448,122452,122704,122480
  .long 122752,122756,123008,122784,123056,123060,123312,123088,123360,123364,123616,123392,123664,123668,123920,123696
  .long 123968,123972,124224,124000,124272,124276,124528,124304,124576,124580,124832,124608,124880,124884,125136,124912
  .long 120328,120332,120356,120360,120632,120636,120660,120664,120936,120940,120964,120968,121240,121244,121268,121272
  .long 121544,121548,121572,121576,121848,121852,121876,121880,122152,122156,122180,122184,122456,122460,122484,122488
  .long 122760,122764,122788,122792,123064,123068,123092,123096,123368,123372,123396,123400,123672,123676,123700,123704
  .long 123976,123980,124004,124008,124280,124284,124308,124312,124584,124588,124612,124616,124888,124892,124916,124920
  .long 120336,120340,120364,120368,120640,120644,120668,120672,120944,120948,120972,120976,121248,121252,121276,121280
  .long 121552,121556,121580,121584,121856,121860,121884,121888,122160,122164,122188,122192,122464,122468,122492,122496
  .long 122768,122772,122796,122800,123072,123076,123100,123104,123376,123380,123404,123408,123680,123684,123708,123712
  .long 123984,123988,124012,124016,124288,124292,124316,124320,124592,124596,124620,124624,124896,124900,124924,124928
  .long 120344,120348,120372,120376,120648,120652,120676,120680,120952,120956,120980,120984,121256,121260,121284,121288
  .long 121560,121564,121588,121592,121864,121868,121892,121896,122168,122172,122196,122200,122472,122476,122500,122504
  .long 122776,122780,122804,122808,123080,123084,123108,123112,123384,123388,123412,123416,123688,123692,123716,123720
  .long 123992,123996,124020,124024,124296,124300,124324,124328,124600,124604,124628,124632,124904,124908,124932,124936
  .long 120380,120580,120408,120412,120684,120884,120712,120716,120988,121188,121016,121020,121292,121492,121320,121324
  .long 121596,121796,121624,121628,121900,122100,121928,121932,122204,122404,122232,122236,122508,122708,122536,122540
  .long 122812,123012,122840,122844,123116,123316,123144,123148,123420,123620,123448,123452,123724,123924,123752,123756
  .long 124028,124228,124056,124060,124332,124532,124360,124364,124636,124836,124664,124668,124940,125140,124968,124972
  .long 120384,120388,120584,120416,120688,120692,120888,120720,120992,120996,121192,121024,121296,121300,121496,121328
  .long 121600,121604,121800,121632,121904,121908,122104,121936,122208,122212,122408,122240,122512,122516,122712,122544
  .long 122816,122820,123016,122848,123120,123124,123320,123152,123424,123428,123624,123456,123728,123732,123928,123760
  .long 124032,124036,124232,124064,124336,124340,124536,124368,124640,124644,124840,124672,124944,124948,125144,124976
  .long 120392,120396,120420,120424,120696,120700,120724,120728,121000,121004,121028,121032,121304,121308,121332,121336
  .long 121608,121612,121636,121640,121912,121916,121940,121944,122216,122220,122244,122248,122520,122524,122548,122552
  .long 122824,122828,122852,122856,123128,123132,123156,123160,123432,123436,123460,123464,123736,123740,123764,123768
  .long 124040,124044,124068,124072,124344,124348,124372,124376,124648,124652,124676,124680,124952,124956,124980,124984
  .long 120400,120404,120428,120432,120704,120708,120732,120736,121008,121012,121036,121040,121312,121316,121340,121344
  .long 121616,121620,121644,121648,121920,121924,121948,121952,122224,122228,122252,122256,122528,122532,122556,122560
  .long 122832,122836,122860,122864,123136,123140,123164,123168,123440,123444,123468,123472,123744,123748,123772,123776
  .long 124048,124052,124076,124080,124352,124356,124380,124384,124656,124660,124684,124688,124960,124964,124988,124992
  .long 120436,120440,120464,120468,120740,120744,120768,120772,121044,121048,121072,121076,121348,121352,121376,121380
  .long 121652,121656,121680,121684,121956,121960,121984,121988,122260,122264,122288,122292,122564,122568,122592,122596
  .long 122868,122872,122896,122900,123172,123176,123200,123204,123476,123480,123504,123508,123780,123784,123808,123812
  .long 124084,124088,124112,124116,124388,124392,124416,124420,124692,124696,124720,124724,124996,125000,125024,125028
  .long 120444,120588,120472,120476,120748,120892,120776,120780,121052,121196,121080,121084,121356,121500,121384,121388
  .long 121660,121804,121688,121692,121964,122108,121992,121996,122268,122412,122296,122300,122572,122716,122600,122604
  .long 122876,123020,122904,122908,123180,123324,123208,123212,123484,123628,123512,123516,123788,123932,123816,123820
  .long 124092,124236,124120,124124,124396,124540,124424,124428,124700,124844,124728,124732,125004,125148,125032,125036
  .long 120448,120452,120592,120480,120752,120756,120896,120784,121056,121060,121200,121088,121360,121364,121504,121392
  .long 121664,121668,121808,121696,121968,121972,122112,122000,122272,122276,122416,122304,122576,122580,122720,122608
  .long 122880,122884,123024,122912,123184,123188,123328,123216,123488,123492,123632,123520,123792,123796,123936,123824
  .long 124096,124100,124240,124128,124400,124404,124544,124432,124704,124708,124848,124736,125008,125012,125152,125040
  .long 120456,120460,120484,120488,120760,120764,120788,120792,121064,121068,121092,121096,121368,121372,121396,121400
  .long 121672,121676,121700,121704,121976,121980,122004,122008,122280,122284,122308,122312,122584,122588,122612,122616
  .long 122888,122892,122916,122920,123192,123196,123220,123224,123496,123500,123524,123528,123800,123804,123828,123832
  .long 124104,124108,124132,124136,124408,124412,124436,124440,124712,124716,124740,124744,125016,125020,125044,125048
  .long 120492,120496,120520,120524,120796,120800,120824,120828,121100,121104,121128,121132,121404,121408,121432,121436
  .long 121708,121712,121736,121740,122012,122016,122040,122044,122316,122320,122344,122348,122620,122624,122648,122652
  .long 122924,122928,122952,122956,123228,123232,123256,123260,123532,123536,123560,123564,123836,123840,123864,123868
  .long 124140,124144,124168,124172,124444,124448,124472,124476,124748,124752,124776,124780,125052,125056,125080,125084
  .long 120500,120504,120528,120532,120804,120808,120832,120836,121108,121112,121136,121140,121412,121416,121440,121444
  .long 121716,121720,121744,121748,122020,122024,122048,122052,122324,122328,122352,122356,122628,122632,122656,122660
  .long 122932,122936,122960,122964,123236,123240,123264,123268,123540,123544,123568,123572,123844,123848,123872,123876
  .long 124148,124152,124176,124180,124452,124456,124480,124484,124756,124760,124784,124788,125060,125064,125088,125092
  .long 120508,120596,120536,120540,120812,120900,120840,120844,121116,121204,121144,121148,121420,121508,121448,121452
  .long 121724,121812,121752,121756,122028,122116,122056,122060,122332,122420,122360,122364,122636,122724,122664,122668
  .long 122940,123028,122968,122972,123244,123332,123272,123276,123548,123636,123576,123580,123852,123940,123880,123884
  .long 124156,124244,124184,124188,124460,124548,124488,124492,124764,124852,124792,124796,125068,125156,125096,125100
  .long 120512,120516,120600,120544,120816,120820,120904,120848,121120,121124,121208,121152,121424,121428,121512,121456
  .long 121728,121732,121816,121760,122032,122036,122120,122064,122336,122340,122424,122368,122640,122644,122728,122672
  .long 122944,122948,123032,122976,123248,123252,123336,123280,123552,123556,123640,123584,123856,123860,123944,123888
  .long 124160,124164,124248,124192,124464,124468,124552,124496,124768,124772,124856,124800,125072,125076,125160,125104
  .long 120548,120552,0,0,120852,120856,0,0,121156,121160,0,0,121460,121464,0,0
  .long 121764,121768,0,0,122068,122072,0,0,122372,122376,0,0,122676,122680,0,0
  .long 122980,122984,0,0,123284,123288,0,0,123588,123592,0,0,123892,123896,0,0
  .long 124196,124200,0,0,124500,124504,0,0,124804,124808,0,0,125108,125112,0,0
  .long 120556,120560,0,0,120860,120864,0,0,121164,121168,0,0,121468,121472,0,0
  .long 121772,121776,0,0,122076,122080,0,0,122380,122384,0,0,122684,122688,0,0
  .long 122988,122992,0,0,123292,123296,0,0,123596,123600,0,0,123900,123904,0,0
  .long 124204,124208,0,0,124508,124512,0,0,124812,124816,0,0,125116,125120,0,0
  .long 120564,120568,0,0,120868,120872,0,0,121172,121176,0,0,121476,121480,0,0
  .long 121780,121784,0,0,122084,122088,0,0,122388,122392,0,0,122692,122696,0,0
  .long 122996,123000,0,0,123300,123304,0,0,123604,123608,0,0,123908,123912,0,0
  .long 124212,124216,0,0,124516,124520,0,0,124820,124824,0,0,125124,125128,0,0
  .long 120572,120604,0,0,120876,120908,0,0,121180,121212,0,0,121484,121516,0,0
  .long 121788,121820,0,0,122092,122124,0,0,122396,122428,0,0,122700,122732,0,0
  .long 123004,123036,0,0,123308,123340,0,0,123612,123644,0,0,123916,123948,0,0
  .long 124220,124252,0,0,124524,124556,0,0,124828,124860,0,0,125132,125164,0,0
  .long 130048,130052,130304,130080,130352,130356,130608,130384,130656,130660,130912,130688,130960,130964,131216,130992
  .long 131264,131268,131520,131296,131568,131572,131824,131600,131872,131876,132128,131904,132176,132180,132432,132208
  .long 132480,132484,132736,132512,132784,132788,133040,132816,133088,133092,133344,133120,133392,133396,133648,133424
  .long 133696,133700,133952,133728,134000,134004,134256,134032,134304,134308,134560,134336,134608,134612,134864,134640
  .long 130056,130060,130084,130088,130360,130364,130388,130392,130664,130668,130692,130696,130968,130972,130996,131000
  .long 131272,131276,131300,131304,131576,131580,131604,131608,131880,131884,131908,131912,132184,132188,132212,132216
  .long 132488,132492,132516,132520,132792,132796,132820,132824,133096,133100,133124,133128,133400,133404,133428,133432
  .long 133704,133708,133732,133736,134008,134012,134036,134040,134312,134316,134340,134344,134616,134620,134644,134648
  .long 130064,130068,130092,130096,130368,130372,130396,130400,130672,130676,130700,130704,130976,130980,131004,131008
  .long 131280,131284,131308,131312,131584,131588,131612,131616,131888,131892,131916,131920,132192,132196,132220,132224
  .long 132496,132500,132524,132528,132800,132804,132828,132832,133104,133108,133132,133136,133408,133412,133436,133440
  .long 133712,133716,133740,133744,134016,134020,134044,134048,134320,134324,134348,134352,134624,134628,134652,134656
  .long 130072,130076,130100,130104,130376,130380,130404,130408,130680,130684,130708,130712,130984,130988,131012,131016
  .long 131288,131292,131316,131320,131592,131596,131620,131624,131896,131900,131924,131928,132200,132204,132228,132232
  .long 132504,132508,132532,132536,132808,132812,132836,132840,133112,133116,133140,133144,133416,133420,133444,133448
  .long 133720,133724,133748,133752,134024,134028,134052,134056,134328,134332,134356,134360,134632,134636,134660,134664
  .long 130108,130308,130136,130140,130412,130612,130440,130444,130716,130916,130744,130748,131020,131220,131048,131052
  .long 131324,131524,131352,131356,131628,131828,131656,131660,131932,132132,131960,131964,132236,132436,132264,132268
  .long 132540,132740,132568,132572,132844,133044,132872,132876,133148,133348,133176,133180,133452,133652,133480,133484
  .long 133756,133956,133784,133788,134060,134260,134088,134092,134364,134564,134392,134396,134668,134868,134696,134700
  .long 130112,130116,130312,130144,130416,130420,130616,130448,130720,130724,130920,130752,131024,131028,131224,131056
  .long 131328,131332,131528,131360,131632,131636,131832,131664,131936,131940,132136,131968,132240,132244,132440,132272
  .long 132544,132548,132744,132576,132848,132852,133048,132880,133152,133156,133352,133184,133456,133460,133656,133488
  .long 133760,133764,133960,133792,134064,134068,134264,134096,134368,134372,134568,134400,134672,134676,134872,134704
  .long 130120,130124,130148,130152,130424,130428,130452,130456,130728,130732,130756,130760,131032,131036,131060,131064
  .long 131336,131340,131364,131368,131640,131644,131668,131672,131944,131948,131972,131976,132248,132252,132276,132280
  .long 132552,132556,132580,132584,132856,132860,132884,132888,133160,133164,133188,133192,133464,133468,133492,133496
  .long 133768,133772,133796,133800,134072,134076,134100,134104,134376,134380,134404,134408,134680,134684,134708,134712
  .long 130128,130132,130156,130160,130432,130436,130460,130464,130736,130740,130764,130768,131040,131044,131068,131072
  .long 131344,131348,131372,131376,131648,131652,131676,131680,131952,131956,131980,131984,132256,132260,132284,132288
  .long 132560,132564,132588,132592,132864,132868,132892,132896,133168,133172,133196,133200,133472,133476,133500,133504
  .long 133776,133780,133804,133808,134080,134084,134108,134112,134384,134388,134412,134416,134688,134692,134716,134720
  .long 130164,130168,130192,130196,130468,130472,130496,130500,130772,130776,130800,130804,131076,131080,131104,131108
  .long 131380,131384,131408,131412,131684,131688,131712,131716,131988,131992,132016,132020,132292,132296,132320,132324
  .long 132596,132600,132624,132628,132900,132904,132928,132932,133204,133208,133232,133236,133508,133512,133536,133540
  .long 133812,133816,133840,133844,134116,134120,134144,134148,134420,134424,134448,134452,134724,134728,134752,134756
  .long 130172,130316,130200,130204,130476,130620,130504,130508,130780,130924,130808,130812,131084,131228,131112,131116
  .long 131388,131532,131416,131420,131692,131836,131720,131724,131996,132140,132024,132028,132300,132444,132328,132332
  .long 132604,132748,132632,132636,132908,133052,132936,132940,133212,133356,133240,133244,133516,133660,133544,133548
  .long 133820,133964,133848,133852,134124,134268,134152,134156,134428,134572,134456,134460,134732,134876,134760,134764
  .long 130176,130180,130320,130208,130480,130484,130624,130512,130784,130788,130928,130816,131088,131092,131232,131120
  .long 131392,131396,131536,131424,131696,131700,131840,131728,132000,132004,132144,132032,132304,132308,132448,132336
  .long 132608,132612,132752,132640,132912,132916,133056,132944,133216,133220,133360,133248,133520,133524,133664,133552
  .long 133824,133828,133968,133856,134128,134132,134272,134160,134432,134436,134576,134464,134736,134740,134880,134768
  .long 130184,130188,130212,130216,130488,130492,130516,130520,130792,130796,130820,130824,131096,131100,131124,131128
  .long 131400,131404,131428,131432,131704,131708,131732,131736,132008,132012,132036,132040,132312,132316,132340,132344
  .long 132616,132620,132644,132648,132920,132924,132948,132952,133224,133228,133252,133256,133528,133532,133556,133560
  .long 133832,133836,133860,133864,134136,134140,134164,134168,134440,134444,134468,134472,134744,134748,134772,134776
  .long 130220,130224,130248,130252,130524,130528,130552,130556,130828,130832,130856,130860,131132,131136,131160,131164
  .long 131436,131440,131464,131468,131740,131744,131768,131772,132044,132048,132072,132076,132348,132352,132376,132380
  .long 132652,132656,132680,132684,132956,132960,132984,132988,133260,133264,133288,133292,133564,133568,133592,133596
  .long 133868,133872,133896,133900,134172,134176,134200,134204,134476,134480,134504,134508,134780,134784,134808,134812
  .long 130228,130232,130256,130260,130532,130536,130560,130564,130836,130840,130864,130868,131140,131144,131168,131172
  .long 131444,131448,131472,131476,131748,131752,131776,131780,132052,132056,132080,132084,132356,132360,132384,132388
  .long 132660,132664,132688,132692,132964,132968,132992,132996,133268,133272,133296,133300,133572,133576,133600,133604
  .long 133876,133880,133904,133908,134180,134184,134208,134212,134484,134488,134512,134516,134788,134792,134816,134820
  .long 130236,130324,130264,130268,130540,130628,130568,130572,130844,130932,130872,130876,131148,131236,131176,131180
  .long 131452,131540,131480,131484,131756,131844,131784,131788,132060,132148,132088,132092,132364,132452,132392,132396
  .long 132668,132756,132696,132700,132972,133060,133000,133004,133276,133364,133304,133308,133580,133668,133608,133612
  .long 133884,133972,133912,133916,134188,134276,134216,134220,134492,134580,134520,134524,134796,134884,134824,134828
  .long 130240,130244,130328,130272,130544,130548,130632,130576,130848,130852,130936,130880,131152,131156,131240,131184
  .long 131456,131460,131544,131488,131760,131764,131848,131792,132064,132068,132152,132096,132368,132372,132456,132400
  .long 132672,132676,132760,132704,132976,132980,133064,133008,133280,133284,133368,133312,133584,133588,133672,133616
  .long 133888,133892,133976,133920,134192,134196,134280,134224,134496,134500,134584,134528,134800,134804,134888,134832
  .long 130276,130280,0,0,130580,130584,0,0,130884,130888,0,0,131188,131192,0,0
  .long 131492,131496,0,0,131796,131800,0,0,132100,132104,0,0,132404,132408,0,0
  .long 132708,132712,0,0,133012,133016,0,0,133316,133320,0,0,133620,133624,0,0
  .long 133924,133928,0,0,134228,134232,0,0,134532,134536,0,0,134836,134840,0,0
  .long 130284,130288,0,0,130588,130592,0,0,130892,130896,0,0,131196,131200,0,0
  .long 131500,131504,0,0,131804,131808,0,0,132108,132112,0,0,132412,132416,0,0
  .long 132716,132720,0,0,133020,133024,0,0,133324,133328,0,0,133628,133632,0,0
  .long 133932,133936,0,0,134236,134240,0,0,134540,134544,0,0,134844,134848,0,0
  .long 130292,130296,0,0,130596,130600,0,0,130900,130904,0,0,131204,131208,0,0
  .long 131508,131512,0,0,131812,131816,0,0,132116,132120,0,0,132420,132424,0,0
  .long 132724,132728,0,0,133028,133032,0,0,133332,133336,0,0,133636,133640,0,0
  .long 133940,133944,0,0,134244,134248,0,0,134548,134552,0,0,134852,134856,0,0
  .long 130300,130332,0,0,130604,130636,0,0,130908,130940,0,0,131212,131244,0,0
  .long 131516,131548,0,0,131820,131852,0,0,132124,132156,0,0,132428,132460,0,0
  .long 132732,132764,0,0,133036,133068,0,0,133340,133372,0,0,133644,133676,0,0
  .long 133948,133980,0,0,134252,134284,0,0,134556,134588,0,0,134860,134892,0,0
  .long 139776,139780,140032,139808,140080,140084,140336,140112,140384,140388,140640,140416,140688,140692,140944,140720
  .long 140992,140996,141248,141024,141296,141300,141552,141328,141600,141604,141856,141632,141904,141908,142160,141936
  .long 142208,142212,142464,142240,142512,142516,142768,142544,142816,142820,143072,142848,143120,143124,143376,143152
  .long 143424,143428,143680,143456,143728,143732,143984,143760,144032,144036,144288,144064,144336,144340,144592,144368
  .long 139784,139788,139812,139816,140088,140092,140116,140120,140392,140396,140420,140424,140696,140700,140724,140728
  .long 141000,141004,141028,141032,141304,141308,141332,141336,141608,141612,141636,141640,141912,141916,141940,141944
  .long 142216,142220,142244,142248,142520,142524,142548,142552,142824,142828,142852,142856,143128,143132,143156,143160
  .long 143432,143436,143460,143464,143736,143740,143764,143768,144040,144044,144068,144072,144344,144348,144372,144376
  .long 139792,139796,139820,139824,140096,140100,140124,140128,140400,140404,140428,140432,140704,140708,140732,140736
  .long 141008,141012,141036,141040,141312,141316,141340,141344,141616,141620,141644,141648,141920,141924,141948,141952
  .long 142224,142228,142252,142256,142528,142532,142556,142560,142832,142836,142860,142864,143136,143140,143164,143168
  .long 143440,143444,143468,143472,143744,143748,143772,143776,144048,144052,144076,144080,144352,144356,144380,144384
  .long 139800,139804,139828,139832,140104,140108,140132,140136,140408,140412,140436,140440,140712,140716,140740,140744
  .long 141016,141020,141044,141048,141320,141324,141348,141352,141624,141628,141652,141656,141928,141932,141956,141960
  .long 142232,142236,142260,142264,142536,142540,142564,142568,142840,142844,142868,142872,143144,143148,143172,143176
  .long 143448,143452,143476,143480,143752,143756,143780,143784,144056,144060,144084,144088,144360,144364,144388,144392
  .long 139836,140036,139864,139868,140140,140340,140168,140172,140444,140644,140472,140476,140748,140948,140776,140780
  .long 141052,141252,141080,141084,141356,141556,141384,141388,141660,141860,141688,141692,141964,142164,141992,141996
  .long 142268,142468,142296,142300,142572,142772,142600,142604,142876,143076,142904,142908,143180,143380,143208,143212
  .long 143484,143684,143512,143516,143788,143988,143816,143820,144092,144292,144120,144124,144396,144596,144424,144428
  .long 139840,139844,140040,139872,140144,140148,140344,140176,140448,140452,140648,140480,140752,140756,140952,140784
  .long 141056,141060,141256,141088,141360,141364,141560,141392,141664,141668,141864,141696,141968,141972,142168,142000
  .long 142272,142276,142472,142304,142576,142580,142776,142608,142880,142884,143080,142912,143184,143188,143384,143216
  .long 143488,143492,143688,143520,143792,143796,143992,143824,144096,144100,144296,144128,144400,144404,144600,144432
  .long 139848,139852,139876,139880,140152,140156,140180,140184,140456,140460,140484,140488,140760,140764,140788,140792
  .long 141064,141068,141092,141096,141368,141372,141396,141400,141672,141676,141700,141704,141976,141980,142004,142008
  .long 142280,142284,142308,142312,142584,142588,142612,142616,142888,142892,142916,142920,143192,143196,143220,143224
  .long 143496,143500,143524,143528,143800,143804,143828,143832,144104,144108,144132,144136,144408,144412,144436,144440
  .long 139856,139860,139884,139888,140160,140164,140188,140192,140464,140468,140492,140496,140768,140772,140796,140800
  .long 141072,141076,141100,141104,141376,141380,141404,141408,141680,141684,141708,141712,141984,141988,142012,142016
  .long 142288,142292,142316,142320,142592,142596,142620,142624,142896,142900,142924,142928,143200,143204,143228,143232
  .long 143504,143508,143532,143536,143808,143812,143836,143840,144112,144116,144140,144144,144416,144420,144444,144448
  .long 139892,139896,139920,139924,140196,140200,140224,140228,140500,140504,140528,140532,140804,140808,140832,140836
  .long 141108,141112,141136,141140,141412,141416,141440,141444,141716,141720,141744,141748,142020,142024,142048,142052
  .long 142324,142328,142352,142356,142628,142632,142656,142660,142932,142936,142960,142964,143236,143240,143264,143268
  .long 143540,143544,143568,143572,143844,143848,143872,143876,144148,144152,144176,144180,144452,144456,144480,144484
  .long 139900,140044,139928,139932,140204,140348,140232,140236,140508,140652,140536,140540,140812,140956,140840,140844
  .long 141116,141260,141144,141148,141420,141564,141448,141452,141724,141868,141752,141756,142028,142172,142056,142060
  .long 142332,142476,142360,142364,142636,142780,142664,142668,142940,143084,142968,142972,143244,143388,143272,143276
  .long 143548,143692,143576,143580,143852,143996,143880,143884,144156,144300,144184,144188,144460,144604,144488,144492
  .long 139904,139908,140048,139936,140208,140212,140352,140240,140512,140516,140656,140544,140816,140820,140960,140848
  .long 141120,141124,141264,141152,141424,141428,141568,141456,141728,141732,141872,141760,142032,142036,142176,142064
  .long 142336,142340,142480,142368,142640,142644,142784,142672,142944,142948,143088,142976,143248,143252,143392,143280
  .long 143552,143556,143696,143584,143856,143860,144000,143888,144160,144164,144304,144192,144464,144468,144608,144496
  .long 139912,139916,139940,139944,140216,140220,140244,140248,140520,140524,140548,140552,140824,140828,140852,140856
  .long 141128,141132,141156,141160,141432,141436,141460,141464,141736,141740,141764,141768,142040,142044,142068,142072
  .long 142344,142348,142372,142376,142648,142652,142676,142680,142952,142956,142980,142984,143256,143260,143284,143288
  .long 143560,143564,143588,143592,143864,143868,143892,143896,144168,144172,144196,144200,144472,144476,144500,144504
  .long 139948,139952,139976,139980,140252,140256,140280,140284,140556,140560,140584,140588,140860,140864,140888,140892
  .long 141164,141168,141192,141196,141468,141472,141496,141500,141772,141776,141800,141804,142076,142080,142104,142108
  .long 142380,142384,142408,142412,142684,142688,142712,142716,142988,142992,143016,143020,143292,143296,143320,143324
  .long 143596,143600,143624,143628,143900,143904,143928,143932,144204,144208,144232,144236,144508,144512,144536,144540
  .long 139956,139960,139984,139988,140260,140264,140288,140292,140564,140568,140592,140596,140868,140872,140896,140900
  .long 141172,141176,141200,141204,141476,141480,141504,141508,141780,141784,141808,141812,142084,142088,142112,142116
  .long 142388,142392,142416,142420,142692,142696,142720,142724,142996,143000,143024,143028,143300,143304,143328,143332
  .long 143604,143608,143632,143636,143908,143912,143936,143940,144212,144216,144240,144244,144516,144520,144544,144548
  .long 139964,140052,139992,139996,140268,140356,140296,140300,140572,140660,140600,140604,140876,140964,140904,140908
  .long 141180,141268,141208,141212,141484,141572,141512,141516,141788,141876,141816,141820,142092,142180,142120,142124
  .long 142396,142484,142424,142428,142700,142788,142728,142732,143004,143092,143032,143036,143308,143396,143336,143340
  .long 143612,143700,143640,143644,143916,144004,143944,143948,144220,144308,144248,144252,144524,144612,144552,144556
  .long 139968,139972,140056,140000,140272,140276,140360,140304,140576,140580,140664,140608,140880,140884,140968,140912
  .long 141184,141188,141272,141216,141488,141492,141576,141520,141792,141796,141880,141824,142096,142100,142184,142128
  .long 142400,142404,142488,142432,142704,142708,142792,142736,143008,143012,143096,143040,143312,143316,143400,143344
  .long 143616,143620,143704,143648,143920,143924,144008,143952,144224,144228,144312,144256,144528,144532,144616,144560
  .long 140004,140008,0,0,140308,140312,0,0,140612,140616,0,0,140916,140920,0,0
  .long 141220,141224,0,0,141524,141528,0,0,141828,141832,0,0,142132,142136,0,0
  .long 142436,142440,0,0,142740,142744,0,0,143044,143048,0,0,143348,143352,0,0
  .long 143652,143656,0,0,143956,143960,0,0,144260,144264,0,0,144564,144568,0,0
  .long 140012,140016,0,0,140316,140320,0,0,140620,140624,0,0,140924,140928,0,0
  .long 141228,141232,0,0,141532,141536,0,0,141836,141840,0,0,142140,142144,0,0
  .long 142444,142448,0,0,142748,142752,0,0,143052,143056,0,0,143356,143360,0,0
  .long 143660,143664,0,0,143964,143968,0,0,144268,144272,0,0,144572,144576,0,0
  .long 140020,140024,0,0,140324,140328,0,0,140628,140632,0,0,140932,140936,0,0
  .long 141236,141240,0,0,141540,141544,0,0,141844,141848,0,0,142148,142152,0,0
  .long 142452,142456,0,0,142756,142760,0,0,143060,143064,0,0,143364,143368,0,0
  .long 143668,143672,0,0,143972,143976,0,0,144276,144280,0,0,144580,144584,0,0
  .long 140028,140060,0,0,140332,140364,0,0,140636,140668,0,0,140940,140972,0,0
  .long 141244,141276,0,0,141548,141580,0,0,141852,141884,0,0,142156,142188,0,0
  .long 142460,142492,0,0,142764,142796,0,0,143068,143100,0,0,143372,143404,0,0
  .long 143676,143708,0,0,143980,144012,0,0,144284,144316,0,0,144588,144620,0,0
.p2align 7
.type L_tab_wo,@object
L_tab_wo:
  .long 0,26624,53344,82944,16,26640,53360,82960,32,26656,53312,82976,48,26672,53328,82992
  .long 64,26688,53280,83008,80,26704,53296,83024,96,26720,53248,83040,112,26736,53264,83056
  .long 128,26752,54240,83072,144,26768,54256,83088,160,26784,54208,83104,176,26800,54224,83120
  .long 192,26816,54176,83136,208,26832,54192,83152,224,26848,54144,83168,240,26864,54160,83184
  .long 256,27680,54368,83200,272,27696,54384,83216,288,27648,54336,83232,304,27664,54352,83248
  .long 320,27744,54304,83264,336,27760,54320,83280,352,27712,54272,83296,368,27728,54288,83312
  .long 1152,27808,54496,84096,1168,27824,54512,84112,1184,27776,54464,84128,1200,27792,54480,84144
  .long 1216,27872,54432,84160,1232,27888,54448,84176,1248,27840,54400,84192,1264,27856,54416,84208
  .long 1280,27936,55360,84224,1296,27952,55376,84240,1312,27904,55392,84256,1328,27920,55408,84272
  .long 1344,28000,55296,84288,1360,28016,55312,84304,1376,27968,55328,84320,1392,27984,55344,84336
  .long 1408,28832,55488,84352,1424,28848,55504,84368,1440,28800,55520,84384,1456,28816,55536,84400
  .long 1472,28896,55424,84416,1488,28912,55440,84432,1504,28864,55456,84448,1520,28880,55472,84464
  .long 2336,28960,55616,85280,2352,28976,55632,85296,2304,28928,55648,85248,2320,28944,55664,85264
  .long 2400,29024,55552,85344,2416,29040,55568,85360,2368,28992,55584,85312,2384,29008,55600,85328
  .long 2464,29088,56512,85408,2480,29104,56528,85424,2432,29056,56544,85376,2448,29072,56560,85392
  .long 2528,29152,56448,85472,2544,29168,56464,85488,2496,29120,56480,85440,2512,29136,56496,85456
  .long 109568,136288,18432,2147483632,109584,136304,18448,2147483632,109600,136256,18464,2147483632,109616,136272,18480,2147483632
  .long 109632,136224,18496,2147483632,109648,136240,18512,2147483632,109664,136192,18528,2147483632,109680,136208,18544,2147483632
  .long 109696,137184,18560,2147483632,109712,137200,18576,2147483632,109728,137152,18592,2147483632,109744,137168,18608,2147483632
  .long 109760,137120,18624,2147483632,109776,137136,18640,2147483632,109792,137088,18656,2147483632,109808,137104,18672,2147483632
  .long 110624,137312,18688,2147483632,110640,137328,18704,2147483632,110592,137280,18720,2147483632,110608,137296,18736,2147483632
  .long 110688,137248,18752,2147483632,110704,137264,18768,2147483632,110656,137216,18784,2147483632,110672,137232,18800,2147483632
  .long 110752,137440,19584,2147483632,110768,137456,19600,2147483632,110720,137408,19616,2147483632,110736,137424,19632,2147483632
  .long 110816,137376,19648,2147483632,110832,137392,19664,2147483632,110784,137344,19680,2147483632,110800,137360,19696,2147483632
  .long 110880,138304,19712,2147483632,110896,138320,19728,2147483632,110848,138336,19744,2147483632,110864,138352,19760,2147483632
  .long 110944,138240,19776,2147483632,110960,138256,19792,2147483632,110912,138272,19808,2147483632,110928,138288,19824,2147483632
  .long 111776,138432,19840,2147483632,111792,138448,19856,2147483632,111744,138464,19872,2147483632,111760,138480,19888,2147483632
  .long 111840,138368,19904,2147483632,111856,138384,19920,2147483632,111808,138400,19936,2147483632,111824,138416,19952,2147483632
  .long 111904,138560,39200,2147483632,111920,138576,39216,2147483632,111872,138592,39168,2147483632,111888,138608,39184,2147483632
  .long 111968,138496,39264,2147483632,111984,138512,39280,2147483632,111936,138528,39232,2147483632,111952,138544,39248,2147483632
  .long 112032,139456,39328,2147483632,112048,139472,39344,2147483632,112000,139488,39296,2147483632,112016,139504,39312,2147483632
  .long 112096,139392,39392,2147483632,112112,139408,39408,2147483632,112064,139424,39360,2147483632,112080,139440,39376,2147483632
  .long 2592,30016,56640,85536,2608,30032,56656,85552,2560,30048,56672,85504,2576,30064,56688,85520
  .long 2656,29952,56576,85600,2672,29968,56592,85616,2624,29984,56608,85568,2640,30000,56624,85584
  .long 3488,30144,56768,86432,3504,30160,56784,86448,3456,30176,56800,86400,3472,30192,56816,86416
  .long 3552,30080,56704,86496,3568,30096,56720,86512,3520,30112,56736,86464,3536,30128,56752,86480
  .long 3616,30272,57696,86560,3632,30288,57712,86576,3584,30304,57664,86528,3600,30320,57680,86544
  .long 3680,30208,57632,86624,3696,30224,57648,86640,3648,30240,57600,86592,3664,30256,57616,86608
  .long 3744,31168,57824,86688,3760,31184,57840,86704,3712,31200,57792,86656,3728,31216,57808,86672
  .long 3808,31104,57760,86752,3824,31120,57776,86768,3776,31136,57728,86720,3792,31152,57744,86736
  .long 4608,31296,57952,87552,4624,31312,57968,87568,4640,31328,57920,87584,4656,31344,57936,87600
  .long 4672,31232,57888,87616,4688,31248,57904,87632,4704,31264,57856,87648,4720,31280,57872,87664
  .long 4736,31424,58848,87680,4752,31440,58864,87696,4768,31456,58816,87712,4784,31472,58832,87728
  .long 4800,31360,58784,87744,4816,31376,58800,87760,4832,31392,58752,87776,4848,31408,58768,87792
  .long 4864,32352,58976,87808,4880,32368,58992,87824,4896,32320,58944,87840,4912,32336,58960,87856
  .long 4928,32288,58912,87872,4944,32304,58928,87888,4960,32256,58880,87904,4976,32272,58896,87920
  .long 5760,32480,59104,88704,5776,32496,59120,88720,5792,32448,59072,88736,5808,32464,59088,88752
  .long 5824,32416,59040,88768,5840,32432,59056,88784,5856,32384,59008,88800,5872,32400,59024,88816
  .long 112960,139584,39456,2147483632,112976,139600,39472,2147483632,112992,139616,39424,2147483632,113008,139632,39440,2147483632
  .long 112896,139520,39520,2147483632,112912,139536,39536,2147483632,112928,139552,39488,2147483632,112944,139568,39504,2147483632
  .long 113088,139712,40352,2147483632,113104,139728,40368,2147483632,113120,139744,40320,2147483632,113136,139760,40336,2147483632
  .long 113024,139648,40416,2147483632,113040,139664,40432,2147483632,113056,139680,40384,2147483632,113072,139696,40400,2147483632
  .long 113216,140640,40480,2147483632,113232,140656,40496,2147483632,113248,140608,40448,2147483632,113264,140624,40464,2147483632
  .long 113152,140576,40544,2147483632,113168,140592,40560,2147483632,113184,140544,40512,2147483632,113200,140560,40528,2147483632
  .long 114112,140768,40608,2147483632,114128,140784,40624,2147483632,114144,140736,40576,2147483632,114160,140752,40592,2147483632
  .long 114048,140704,40672,2147483632,114064,140720,40688,2147483632,114080,140672,40640,2147483632,114096,140688,40656,2147483632
  .long 114240,140896,59904,2147483632,114256,140912,59920,2147483632,114272,140864,59936,2147483632,114288,140880,59952,2147483632
  .long 114176,140832,59968,2147483632,114192,140848,59984,2147483632,114208,140800,60000,2147483632,114224,140816,60016,2147483632
  .long 114368,141792,60032,2147483632,114384,141808,60048,2147483632,114400,141760,60064,2147483632,114416,141776,60080,2147483632
  .long 114304,141728,60096,2147483632,114320,141744,60112,2147483632,114336,141696,60128,2147483632,114352,141712,60144,2147483632
  .long 115296,141920,60160,2147483632,115312,141936,60176,2147483632,115264,141888,60192,2147483632,115280,141904,60208,2147483632
  .long 115232,141856,60224,2147483632,115248,141872,60240,2147483632,115200,141824,60256,2147483632,115216,141840,60272,2147483632
  .long 115424,142048,61056,2147483632,115440,142064,61072,2147483632,115392,142016,61088,2147483632,115408,142032,61104,2147483632
  .long 115360,141984,61120,2147483632,115376,142000,61136,2147483632,115328,141952,61152,2147483632,115344,141968,61168,2147483632
  .long 5888,32608,62208,88832,5904,32624,62224,88848,5920,32576,62240,88864,5936,32592,62256,88880
  .long 5952,32544,62272,88896,5968,32560,62288,88912,5984,32512,62304,88928,6000,32528,62320,88944
  .long 6016,33504,62336,88960,6032,33520,62352,88976,6048,33472,62368,88992,6064,33488,62384,89008
  .long 6080,33440,62400,89024,6096,33456,62416,89040,6112,33408,62432,89056,6128,33424,62448,89072
  .long 6944,33632,62464,89888,6960,33648,62480,89904,6912,33600,62496,89856,6928,33616,62512,89872
  .long 7008,33568,62528,89952,7024,33584,62544,89968,6976,33536,62560,89920,6992,33552,62576,89936
  .long 7072,33760,63360,90016,7088,33776,63376,90032,7040,33728,63392,89984,7056,33744,63408,90000
  .long 7136,33696,63424,90080,7152,33712,63440,90096,7104,33664,63456,90048,7120,33680,63472,90064
  .long 7200,34624,63488,90144,7216,34640,63504,90160,7168,34656,63520,90112,7184,34672,63536,90128
  .long 7264,34560,63552,90208,7280,34576,63568,90224,7232,34592,63584,90176,7248,34608,63600,90192
  .long 8096,34752,63616,91040,8112,34768,63632,91056,8064,34784,63648,91008,8080,34800,63664,91024
  .long 8160,34688,63680,91104,8176,34704,63696,91120,8128,34720,63712,91072,8144,34736,63728,91088
  .long 8224,34880,64544,91168,8240,34896,64560,91184,8192,34912,64512,91136,8208,34928,64528,91152
  .long 8288,34816,64608,91232,8304,34832,64624,91248,8256,34848,64576,91200,8272,34864,64592,91216
  .long 8352,35776,64672,91296,8368,35792,64688,91312,8320,35808,64640,91264,8336,35824,64656,91280
  .long 8416,35712,64736,91360,8432,35728,64752,91376,8384,35744,64704,91328,8400,35760,64720,91344
  .long 115552,145152,61184,2147483632,115568,145168,61200,2147483632,115520,145184,61216,2147483632,115536,145200,61232,2147483632
  .long 115488,145216,61248,2147483632,115504,145232,61264,2147483632,115456,145248,61280,2147483632,115472,145264,61296,2147483632
  .long 116448,145280,61312,2147483632,116464,145296,61328,2147483632,116416,145312,61344,2147483632,116432,145328,61360,2147483632
  .long 116384,145344,61376,2147483632,116400,145360,61392,2147483632,116352,145376,61408,2147483632,116368,145392,61424,2147483632
  .long 116576,145408,80672,2147483632,116592,145424,80688,2147483632,116544,145440,80640,2147483632,116560,145456,80656,2147483632
  .long 116512,145472,80736,2147483632,116528,145488,80752,2147483632,116480,145504,80704,2147483632,116496,145520,80720,2147483632
  .long 116704,146304,80800,2147483632,116720,146320,80816,2147483632,116672,146336,80768,2147483632,116688,146352,80784,2147483632
  .long 116640,146368,80864,2147483632,116656,146384,80880,2147483632,116608,146400,80832,2147483632,116624,146416,80848,2147483632
  .long 117568,146432,80928,2147483632,117584,146448,80944,2147483632,117600,146464,80896,2147483632,117616,146480,80912,2147483632
  .long 117504,146496,80992,2147483632,117520,146512,81008,2147483632,117536,146528,80960,2147483632,117552,146544,80976,2147483632
  .long 117696,146560,81824,2147483632,117712,146576,81840,2147483632,117728,146592,81792,2147483632,117744,146608,81808,2147483632
  .long 117632,146624,81888,2147483632,117648,146640,81904,2147483632,117664,146656,81856,2147483632,117680,146672,81872,2147483632
  .long 117824,147488,81952,2147483632,117840,147504,81968,2147483632,117856,147456,81920,2147483632,117872,147472,81936,2147483632
  .long 117760,147552,82016,2147483632,117776,147568,82032,2147483632,117792,147520,81984,2147483632,117808,147536,82000,2147483632
  .long 118720,147616,82080,2147483632,118736,147632,82096,2147483632,118752,147584,82048,2147483632,118768,147600,82064,2147483632
  .long 118656,147680,82144,2147483632,118672,147696,82160,2147483632,118688,147648,82112,2147483632,118704,147664,82128,2147483632
  .long 9280,35904,64800,92224,9296,35920,64816,92240,9312,35936,64768,92256,9328,35952,64784,92272
  .long 9216,35840,64864,92160,9232,35856,64880,92176,9248,35872,64832,92192,9264,35888,64848,92208
  .long 9408,36032,65696,92352,9424,36048,65712,92368,9440,36064,65664,92384,9456,36080,65680,92400
  .long 9344,35968,65760,92288,9360,35984,65776,92304,9376,36000,65728,92320,9392,36016,65744,92336
  .long 9536,36960,65824,92480,9552,36976,65840,92496,9568,36928,65792,92512,9584,36944,65808,92528
  .long 9472,36896,65888,92416,9488,36912,65904,92432,9504,36864,65856,92448,9520,36880,65872,92464
  .long 10432,37088,65952,93376,10448,37104,65968,93392,10464,37056,65920,93408,10480,37072,65936,93424
  .long 10368,37024,66016,93312,10384,37040,66032,93328,10400,36992,65984,93344,10416,37008,66000,93360
  .long 10560,37216,66816,93504,10576,37232,66832,93520,10592,37184,66848,93536,10608,37200,66864,93552
  .long 10496,37152,66880,93440,10512,37168,66896,93456,10528,37120,66912,93472,10544,37136,66928,93488
  .long 10688,38112,66944,93632,10704,38128,66960,93648,10720,38080,66976,93664,10736,38096,66992,93680
  .long 10624,38048,67008,93568,10640,38064,67024,93584,10656,38016,67040,93600,10672,38032,67056,93616
  .long 11616,38240,67072,94560,11632,38256,67088,94576,11584,38208,67104,94528,11600,38224,67120,94544
  .long 11552,38176,67136,94496,11568,38192,67152,94512,11520,38144,67168,94464,11536,38160,67184,94480
  .long 11744,38368,67968,94688,11760,38384,67984,94704,11712,38336,68000,94656,11728,38352,68016,94672
  .long 11680,38304,68032,94624,11696,38320,68048,94640,11648,38272,68064,94592,11664,38288,68080,94608
  .long 118848,147744,101440,2147483632,118864,147760,101456,2147483632,118880,147712,101472,2147483632,118896,147728,101488,2147483632
  .long 118784,147808,101376,2147483632,118800,147824,101392,2147483632,118816,147776,101408,2147483632,118832,147792,101424,2147483632
  .long 118976,148640,101568,2147483632,118992,148656,101584,2147483632,119008,148608,101600,2147483632,119024,148624,101616,2147483632
  .long 118912,148704,101504,2147483632,118928,148720,101520,2147483632,118944,148672,101536,2147483632,118960,148688,101552,2147483632
  .long 119904,148768,101696,2147483632,119920,148784,101712,2147483632,119872,148736,101728,2147483632,119888,148752,101744,2147483632
  .long 119840,148832,101632,2147483632,119856,148848,101648,2147483632,119808,148800,101664,2147483632,119824,148816,101680,2147483632
  .long 120032,148896,102592,2147483632,120048,148912,102608,2147483632,120000,148864,102624,2147483632,120016,148880,102640,2147483632
  .long 119968,148960,102528,2147483632,119984,148976,102544,2147483632,119936,148928,102560,2147483632,119952,148944,102576,2147483632
  .long 120160,149760,102720,2147483632,120176,149776,102736,2147483632,120128,149792,102752,2147483632,120144,149808,102768,2147483632
  .long 120096,149824,102656,2147483632,120112,149840,102672,2147483632,120064,149856,102688,2147483632,120080,149872,102704,2147483632
  .long 121056,149888,102848,2147483632,121072,149904,102864,2147483632,121024,149920,102880,2147483632,121040,149936,102896,2147483632
  .long 120992,149952,102784,2147483632,121008,149968,102800,2147483632,120960,149984,102816,2147483632,120976,150000,102832,2147483632
  .long 121184,150016,122208,2147483632,121200,150032,122224,2147483632,121152,150048,122176,2147483632,121168,150064,122192,2147483632
  .long 121120,150080,122144,2147483632,121136,150096,122160,2147483632,121088,150112,122112,2147483632,121104,150128,122128,2147483632
  .long 121312,150912,122336,2147483632,121328,150928,122352,2147483632,121280,150944,122304,2147483632,121296,150960,122320,2147483632
  .long 121248,150976,122272,2147483632,121264,150992,122288,2147483632,121216,151008,122240,2147483632,121232,151024,122256,2147483632
  .long 11872,41472,68096,94816,11888,41488,68112,94832,11840,41504,68128,94784,11856,41520,68144,94800
  .long 11808,41536,68160,94752,11824,41552,68176,94768,11776,41568,68192,94720,11792,41584,68208,94736
  .long 12768,41600,68224,95712,12784,41616,68240,95728,12736,41632,68256,95680,12752,41648,68272,95696
  .long 12704,41664,68288,95648,12720,41680,68304,95664,12672,41696,68320,95616,12688,41712,68336,95632
  .long 12896,41728,69152,95840,12912,41744,69168,95856,12864,41760,69120,95808,12880,41776,69136,95824
  .long 12832,41792,69216,95776,12848,41808,69232,95792,12800,41824,69184,95744,12816,41840,69200,95760
  .long 13024,42624,69280,95968,13040,42640,69296,95984,12992,42656,69248,95936,13008,42672,69264,95952
  .long 12960,42688,69344,95904,12976,42704,69360,95920,12928,42720,69312,95872,12944,42736,69328,95888
  .long 13888,42752,69408,96832,13904,42768,69424,96848,13920,42784,69376,96864,13936,42800,69392,96880
  .long 13824,42816,69472,96768,13840,42832,69488,96784,13856,42848,69440,96800,13872,42864,69456,96816
  .long 14016,42880,70304,96960,14032,42896,70320,96976,14048,42912,70272,96992,14064,42928,70288,97008
  .long 13952,42944,70368,96896,13968,42960,70384,96912,13984,42976,70336,96928,14000,42992,70352,96944
  .long 14144,43808,70432,97088,14160,43824,70448,97104,14176,43776,70400,97120,14192,43792,70416,97136
  .long 14080,43872,70496,97024,14096,43888,70512,97040,14112,43840,70464,97056,14128,43856,70480,97072
  .long 15040,43936,70560,97984,15056,43952,70576,98000,15072,43904,70528,98016,15088,43920,70544,98032
  .long 14976,44000,70624,97920,14992,44016,70640,97936,15008,43968,70592,97952,15024,43984,70608,97968
  .long 124416,151040,122464,2147483632,124432,151056,122480,2147483632,124448,151072,122432,2147483632,124464,151088,122448,2147483632
  .long 124480,151104,122400,2147483632,124496,151120,122416,2147483632,124512,151136,122368,2147483632,124528,151152,122384,2147483632
  .long 124544,151168,123360,2147483632,124560,151184,123376,2147483632,124576,151200,123328,2147483632,124592,151216,123344,2147483632
  .long 124608,151232,123296,2147483632,124624,151248,123312,2147483632,124640,151264,123264,2147483632,124656,151280,123280,2147483632
  .long 124672,152096,123488,2147483632,124688,152112,123504,2147483632,124704,152064,123456,2147483632,124720,152080,123472,2147483632
  .long 124736,152160,123424,2147483632,124752,152176,123440,2147483632,124768,152128,123392,2147483632,124784,152144,123408,2147483632
  .long 125568,152224,123616,2147483632,125584,152240,123632,2147483632,125600,152192,123584,2147483632,125616,152208,123600,2147483632
  .long 125632,152288,123552,2147483632,125648,152304,123568,2147483632,125664,152256,123520,2147483632,125680,152272,123536,2147483632
  .long 125696,152352,142912,2147483632,125712,152368,142928,2147483632,125728,152320,142944,2147483632,125744,152336,142960,2147483632
  .long 125760,152416,142848,2147483632,125776,152432,142864,2147483632,125792,152384,142880,2147483632,125808,152400,142896,2147483632
  .long 125824,153248,143040,2147483632,125840,153264,143056,2147483632,125856,153216,143072,2147483632,125872,153232,143088,2147483632
  .long 125888,153312,142976,2147483632,125904,153328,142992,2147483632,125920,153280,143008,2147483632,125936,153296,143024,2147483632
  .long 126752,153376,143168,2147483632,126768,153392,143184,2147483632,126720,153344,143200,2147483632,126736,153360,143216,2147483632
  .long 126816,153440,143104,2147483632,126832,153456,143120,2147483632,126784,153408,143136,2147483632,126800,153424,143152,2147483632
  .long 126880,153504,144064,2147483632,126896,153520,144080,2147483632,126848,153472,144096,2147483632,126864,153488,144112,2147483632
  .long 126944,153568,144000,2147483632,126960,153584,144016,2147483632,126912,153536,144032,2147483632,126928,153552,144048,2147483632
  .long 15168,44064,71488,98112,15184,44080,71504,98128,15200,44032,71520,98144,15216,44048,71536,98160
  .long 15104,44128,71424,98048,15120,44144,71440,98064,15136,44096,71456,98080,15152,44112,71472,98096
  .long 15296,44960,71616,98240,15312,44976,71632,98256,15328,44928,71648,98272,15344,44944,71664,98288
  .long 15232,45024,71552,98176,15248,45040,71568,98192,15264,44992,71584,98208,15280,45008,71600,98224
  .long 16224,45088,71744,99168,16240,45104,71760,99184,16192,45056,71776,99136,16208,45072,71792,99152
  .long 16160,45152,71680,99104,16176,45168,71696,99120,16128,45120,71712,99072,16144,45136,71728,99088
  .long 16352,45216,72640,99296,16368,45232,72656,99312,16320,45184,72672,99264,16336,45200,72688,99280
  .long 16288,45280,72576,99232,16304,45296,72592,99248,16256,45248,72608,99200,16272,45264,72624,99216
  .long 16480,46080,72768,99424,16496,46096,72784,99440,16448,46112,72800,99392,16464,46128,72816,99408
  .long 16416,46144,72704,99360,16432,46160,72720,99376,16384,46176,72736,99328,16400,46192,72752,99344
  .long 17376,46208,72896,100320,17392,46224,72912,100336,17344,46240,72928,100288,17360,46256,72944,100304
  .long 17312,46272,72832,100256,17328,46288,72848,100272,17280,46304,72864,100224,17296,46320,72880,100240
  .long 17504,46336,73824,100448,17520,46352,73840,100464,17472,46368,73792,100416,17488,46384,73808,100432
  .long 17440,46400,73760,100384,17456,46416,73776,100400,17408,46432,73728,100352,17424,46448,73744,100368
  .long 17632,47232,73952,100576,17648,47248,73968,100592,17600,47264,73920,100544,17616,47280,73936,100560
  .long 17568,47296,73888,100512,17584,47312,73904,100528,17536,47328,73856,100480,17552,47344,73872,100496
  .long 127008,154432,144192,2147483632,127024,154448,144208,2147483632,126976,154464,144224,2147483632,126992,154480,144240,2147483632
  .long 127072,154368,144128,2147483632,127088,154384,144144,2147483632,127040,154400,144160,2147483632,127056,154416,144176,2147483632
  .long 127904,154560,144320,2147483632,127920,154576,144336,2147483632,127872,154592,144352,2147483632,127888,154608,144368,2147483632
  .long 127968,154496,144256,2147483632,127984,154512,144272,2147483632,127936,154528,144288,2147483632,127952,154544,144304,2147483632
  .long 128032,154688,163680,2147483632,128048,154704,163696,2147483632,128000,154720,163648,2147483632,128016,154736,163664,2147483632
  .long 128096,154624,163616,2147483632,128112,154640,163632,2147483632,128064,154656,163584,2147483632,128080,154672,163600,2147483632
  .long 128160,155584,163808,2147483632,128176,155600,163824,2147483632,128128,155616,163776,2147483632,128144,155632,163792,2147483632
  .long 128224,155520,163744,2147483632,128240,155536,163760,2147483632,128192,155552,163712,2147483632,128208,155568,163728,2147483632
  .long 129024,155712,163936,2147483632,129040,155728,163952,2147483632,129056,155744,163904,2147483632,129072,155760,163920,2147483632
  .long 129088,155648,163872,2147483632,129104,155664,163888,2147483632,129120,155680,163840,2147483632,129136,155696,163856,2147483632
  .long 129152,155840,164832,2147483632,129168,155856,164848,2147483632,129184,155872,164800,2147483632,129200,155888,164816,2147483632
  .long 129216,155776,164768,2147483632,129232,155792,164784,2147483632,129248,155808,164736,2147483632,129264,155824,164752,2147483632
  .long 129280,156768,164960,2147483632,129296,156784,164976,2147483632,129312,156736,164928,2147483632,129328,156752,164944,2147483632
  .long 129344,156704,164896,2147483632,129360,156720,164912,2147483632,129376,156672,164864,2147483632,129392,156688,164880,2147483632
  .long 130176,156896,165088,2147483632,130192,156912,165104,2147483632,130208,156864,165056,2147483632,130224,156880,165072,2147483632
  .long 130240,156832,165024,2147483632,130256,156848,165040,2147483632,130272,156800,164992,2147483632,130288,156816,165008,2147483632
  .long 20736,47360,74080,103680,20752,47376,74096,103696,20768,47392,74048,103712,20784,47408,74064,103728
  .long 20800,47424,74016,103744,20816,47440,74032,103760,20832,47456,73984,103776,20848,47472,74000,103792
  .long 20864,47488,74976,103808,20880,47504,74992,103824,20896,47520,74944,103840,20912,47536,74960,103856
  .long 20928,47552,74912,103872,20944,47568,74928,103888,20960,47584,74880,103904,20976,47600,74896,103920
  .long 20992,48416,75104,103936,21008,48432,75120,103952,21024,48384,75072,103968,21040,48400,75088,103984
  .long 21056,48480,75040,104000,21072,48496,75056,104016,21088,48448,75008,104032,21104,48464,75024,104048
  .long 21888,48544,75232,104832,21904,48560,75248,104848,21920,48512,75200,104864,21936,48528,75216,104880
  .long 21952,48608,75168,104896,21968,48624,75184,104912,21984,48576,75136,104928,22000,48592,75152,104944
  .long 22016,48672,76096,104960,22032,48688,76112,104976,22048,48640,76128,104992,22064,48656,76144,105008
  .long 22080,48736,76032,105024,22096,48752,76048,105040,22112,48704,76064,105056,22128,48720,76080,105072
  .long 22144,49568,76224,105088,22160,49584,76240,105104,22176,49536,76256,105120,22192,49552,76272,105136
  .long 22208,49632,76160,105152,22224,49648,76176,105168,22240,49600,76192,105184,22256,49616,76208,105200
  .long 23072,49696,76352,106016,23088,49712,76368,106032,23040,49664,76384,105984,23056,49680,76400,106000
  .long 23136,49760,76288,106080,23152,49776,76304,106096,23104,49728,76320,106048,23120,49744,76336,106064
  .long 23200,49824,77248,106144,23216,49840,77264,106160,23168,49792,77280,106112,23184,49808,77296,106128
  .long 23264,49888,77184,106208,23280,49904,77200,106224,23232,49856,77216,106176,23248,49872,77232,106192
  .long 130304,157024,2147483632,2147483632,130320,157040,2147483632,2147483632,130336,156992,2147483632,2147483632,130352,157008,2147483632,2147483632
  .long 130368,156960,2147483632,2147483632,130384,156976,2147483632,2147483632,130400,156928,2147483632,2147483632,130416,156944,2147483632,2147483632
  .long 130432,157920,2147483632,2147483632,130448,157936,2147483632,2147483632,130464,157888,2147483632,2147483632,130480,157904,2147483632,2147483632
  .long 130496,157856,2147483632,2147483632,130512,157872,2147483632,2147483632,130528,157824,2147483632,2147483632,130544,157840,2147483632,2147483632
  .long 131360,158048,2147483632,2147483632,131376,158064,2147483632,2147483632,131328,158016,2147483632,2147483632,131344,158032,2147483632,2147483632
  .long 131424,157984,2147483632,2147483632,131440,158000,2147483632,2147483632,131392,157952,2147483632,2147483632,131408,157968,2147483632,2147483632
  .long 131488,158176,2147483632,2147483632,131504,158192,2147483632,2147483632,131456,158144,2147483632,2147483632,131472,158160,2147483632,2147483632
  .long 131552,158112,2147483632,2147483632,131568,158128,2147483632,2147483632,131520,158080,2147483632,2147483632,131536,158096,2147483632,2147483632
  .long 131616,159040,2147483632,2147483632,131632,159056,2147483632,2147483632,131584,159072,2147483632,2147483632,131600,159088,2147483632,2147483632
  .long 131680,158976,2147483632,2147483632,131696,158992,2147483632,2147483632,131648,159008,2147483632,2147483632,131664,159024,2147483632,2147483632
  .long 132512,159168,2147483632,2147483632,132528,159184,2147483632,2147483632,132480,159200,2147483632,2147483632,132496,159216,2147483632,2147483632
  .long 132576,159104,2147483632,2147483632,132592,159120,2147483632,2147483632,132544,159136,2147483632,2147483632,132560,159152,2147483632,2147483632
  .long 132640,159296,2147483632,2147483632,132656,159312,2147483632,2147483632,132608,159328,2147483632,2147483632,132624,159344,2147483632,2147483632
  .long 132704,159232,2147483632,2147483632,132720,159248,2147483632,2147483632,132672,159264,2147483632,2147483632,132688,159280,2147483632,2147483632
  .long 132768,160192,2147483632,2147483632,132784,160208,2147483632,2147483632,132736,160224,2147483632,2147483632,132752,160240,2147483632,2147483632
  .long 132832,160128,2147483632,2147483632,132848,160144,2147483632,2147483632,132800,160160,2147483632,2147483632,132816,160176,2147483632,2147483632
  .long 23328,50752,77376,106272,23344,50768,77392,106288,23296,50784,77408,106240,23312,50800,77424,106256
  .long 23392,50688,77312,106336,23408,50704,77328,106352,23360,50720,77344,106304,23376,50736,77360,106320
  .long 24224,50880,77504,107168,24240,50896,77520,107184,24192,50912,77536,107136,24208,50928,77552,107152
  .long 24288,50816,77440,107232,24304,50832,77456,107248,24256,50848,77472,107200,24272,50864,77488,107216
  .long 24352,51008,78432,107296,24368,51024,78448,107312,24320,51040,78400,107264,24336,51056,78416,107280
  .long 24416,50944,78368,107360,24432,50960,78384,107376,24384,50976,78336,107328,24400,50992,78352,107344
  .long 24480,51904,78560,107424,24496,51920,78576,107440,24448,51936,78528,107392,24464,51952,78544,107408
  .long 24544,51840,78496,107488,24560,51856,78512,107504,24512,51872,78464,107456,24528,51888,78480,107472
  .long 25344,52032,78688,108288,25360,52048,78704,108304,25376,52064,78656,108320,25392,52080,78672,108336
  .long 25408,51968,78624,108352,25424,51984,78640,108368,25440,52000,78592,108384,25456,52016,78608,108400
  .long 25472,52160,79584,108416,25488,52176,79600,108432,25504,52192,79552,108448,25520,52208,79568,108464
  .long 25536,52096,79520,108480,25552,52112,79536,108496,25568,52128,79488,108512,25584,52144,79504,108528
  .long 25600,53088,79712,108544,25616,53104,79728,108560,25632,53056,79680,108576,25648,53072,79696,108592
  .long 25664,53024,79648,108608,25680,53040,79664,108624,25696,52992,79616,108640,25712,53008,79632,108656
  .long 26496,53216,79840,109440,26512,53232,79856,109456,26528,53184,79808,109472,26544,53200,79824,109488
  .long 26560,53152,79776,109504,26576,53168,79792,109520,26592,53120,79744,109536,26608,53136,79760,109552
  .long 133696,160320,2147483632,2147483632,133712,160336,2147483632,2147483632,133728,160352,2147483632,2147483632,133744,160368,2147483632,2147483632
  .long 133632,160256,2147483632,2147483632,133648,160272,2147483632,2147483632,133664,160288,2147483632,2147483632,133680,160304,2147483632,2147483632
  .long 133824,160448,2147483632,2147483632,133840,160464,2147483632,2147483632,133856,160480,2147483632,2147483632,133872,160496,2147483632,2147483632
  .long 133760,160384,2147483632,2147483632,133776,160400,2147483632,2147483632,133792,160416,2147483632,2147483632,133808,160432,2147483632,2147483632
  .long 133952,161376,2147483632,2147483632,133968,161392,2147483632,2147483632,133984,161344,2147483632,2147483632,134000,161360,2147483632,2147483632
  .long 133888,161312,2147483632,2147483632,133904,161328,2147483632,2147483632,133920,161280,2147483632,2147483632,133936,161296,2147483632,2147483632
  .long 134848,161504,2147483632,2147483632,134864,161520,2147483632,2147483632,134880,161472,2147483632,2147483632,134896,161488,2147483632,2147483632
  .long 134784,161440,2147483632,2147483632,134800,161456,2147483632,2147483632,134816,161408,2147483632,2147483632,134832,161424,2147483632,2147483632
  .long 134976,161632,2147483632,2147483632,134992,161648,2147483632,2147483632,135008,161600,2147483632,2147483632,135024,161616,2147483632,2147483632
  .long 134912,161568,2147483632,2147483632,134928,161584,2147483632,2147483632,134944,161536,2147483632,2147483632,134960,161552,2147483632,2147483632
  .long 135104,162528,2147483632,2147483632,135120,162544,2147483632,2147483632,135136,162496,2147483632,2147483632,135152,162512,2147483632,2147483632
  .long 135040,162464,2147483632,2147483632,135056,162480,2147483632,2147483632,135072,162432,2147483632,2147483632,135088,162448,2147483632,2147483632
  .long 136032,162656,2147483632,2147483632,136048,162672,2147483632,2147483632,136000,162624,2147483632,2147483632,136016,162640,2147483632,2147483632
  .long 135968,162592,2147483632,2147483632,135984,162608,2147483632,2147483632,135936,162560,2147483632,2147483632,135952,162576,2147483632,2147483632
  .long 136160,162784,2147483632,2147483632,136176,162800,2147483632,2147483632,136128,162752,2147483632,2147483632,136144,162768,2147483632,2147483632
  .long 136096,162720,2147483632,2147483632,136112,162736,2147483632,2147483632,136064,162688,2147483632,2147483632,136080,162704,2147483632,2147483632
L_text_end:
.section .rodata,"a"
.p2align 6
.amdhsa_kernel parallel_sum__linear_attn_block__mixer_token_mlp__prompt_kernel
  .amdhsa_next_free_vgpr 256
  .amdhsa_next_free_sgpr 102
  .amdhsa_accum_offset 256
  .amdhsa_group_segment_fixed_size 0
  .amdhsa_kernarg_size 88
  .amdhsa_user_sgpr_count 2
  .amdhsa_user_sgpr_kernarg_segment_ptr 1
  .amdhsa_system_sgpr_workgroup_id_x 1
.end_amdhsa_kernel
```
